```python
import torch

def _softmax(x, axis=-1):
    return torch.softmax(x, dim=axis)

def _gelu(x):
    return torch.nn.functional.gelu(x, approximate='tanh')

def _silu(x):
    return torch.nn.functional.silu(x)

def _sigmoid(x):
    return torch.sigmoid(x)

def _layernorm(x, axis=-1, eps=1e-05):
    m = x.mean(dim=axis, keepdim=True)
    v = x.var(dim=axis, keepdim=True, unbiased=False)
    return (x - m) / torch.sqrt(v + eps)

def _scatter_add(tgt, idx, src, axis=0):
    return tgt.clone().index_add_(axis, idx, src)

def _segment_sum(src, seg, n):
    out = torch.zeros((n,) + src.shape[1:], dtype=src.dtype)
    return out.index_add_(0, seg, src)

def _pad(x, pw):
    flat = tuple((v for pair in reversed(pw) for v in pair))
    return torch.nn.functional.pad(x, flat)
kernel_name = 'concat_heads__memory_aug_recurrent_mem_tr__memory_aug_recurrent_mem_tr__prompt'

def setup_inputs():

    _w = lambda a: (lambda t: t.to(torch.bfloat16) if t.is_floating_point() else t)(torch.as_tensor(a))

    def _A_setup():
        B, S, Dm = (1, 2048, 640)
        H, Dh = (32, 128)
        M, seg = (8, 32)
        seg = min(seg, S)
        S = S // seg * seg
        return {'x': _w((lambda *s: torch.randn(*s, dtype=torch.bfloat16) * 0.05)(B, S, Dm)), 'mem0': _w((lambda *s: torch.randn(*s, dtype=torch.bfloat16) * 0.4)(B, M, Dm)), 'Wq': _w((lambda *s: torch.randn(*s, dtype=torch.bfloat16) * 6.4)(Dm, H, Dh) * Dm ** (-0.5)), 'Wk': _w((lambda *s: torch.randn(*s, dtype=torch.bfloat16) * 6.4)(Dm, H, Dh) * Dm ** (-0.5)), 'Wv': _w((lambda *s: torch.randn(*s, dtype=torch.bfloat16) * 0.4)(Dm, H, Dh) * Dm ** (-0.5)), 'Wo': _w((lambda *s: torch.randn(*s, dtype=torch.bfloat16) * 0.4)(H, Dh, Dm) * (H * Dh) ** (-0.5)), 'seg_len': seg}
    _A_in = _A_setup()

    def _B_setup():
        B, S, Dm = (1, 2048, 640)
        H, Dh = (32, 128)
        M, seg = (8, 32)
        seg = min(seg, S)
        S = S // seg * seg
        return {'x': _w((lambda *s: torch.randn(*s, dtype=torch.bfloat16) * 0.05)(B, S, Dm)), 'mem0': _w((lambda *s: torch.randn(*s, dtype=torch.bfloat16) * 0.4)(B, M, Dm)), 'Wq': _w((lambda *s: torch.randn(*s, dtype=torch.bfloat16) * 6.4)(Dm, H, Dh) * Dm ** (-0.5)), 'Wk': _w((lambda *s: torch.randn(*s, dtype=torch.bfloat16) * 6.4)(Dm, H, Dh) * Dm ** (-0.5)), 'Wv': _w((lambda *s: torch.randn(*s, dtype=torch.bfloat16) * 0.4)(Dm, H, Dh) * Dm ** (-0.5)), 'Wo': _w((lambda *s: torch.randn(*s, dtype=torch.bfloat16) * 0.4)(H, Dh, Dm) * (H * Dh) ** (-0.5)), 'seg_len': seg}
    _B_in = _B_setup()
    return {'A_x': _A_in['x'], 'A_mem0': _A_in['mem0'], 'A_Wq': _A_in['Wq'], 'A_Wk': _A_in['Wk'], 'A_Wv': _A_in['Wv'], 'A_Wo': _A_in['Wo'], 'A_seg_len': _A_in['seg_len'], 'B_x': _B_in['x'], 'B_mem0': _B_in['mem0'], 'B_Wq': _B_in['Wq'], 'B_Wk': _B_in['Wk'], 'B_Wv': _B_in['Wv'], 'B_Wo': _B_in['Wo'], 'B_seg_len': _B_in['seg_len']}

def reference(A_x, A_mem0, A_Wq, A_Wk, A_Wv, A_Wo, A_seg_len, B_x, B_mem0, B_Wq, B_Wk, B_Wv, B_Wo, B_seg_len):

    def _A_ref(x, mem0, Wq, Wk, Wv, Wo, seg_len):
        B, S, Dm = x.shape
        H, Dh = (Wq.shape[1], Wq.shape[2])
        M = mem0.shape[1]
        scale = Dh ** (-0.5)
        n_seg = S // seg_len
        L = M + seg_len
        idx = torch.arange(L)
        mask = (idx[:, None] < M) | (idx[:, None] >= idx[None, :])
        mem = mem0
        outs = []
        for s in range(n_seg):
            xs = x[:, s * seg_len:(s + 1) * seg_len, :].clone()
            h = torch.concatenate([mem, xs], axis=1)
            q = torch.einsum('btd,dhe->bhte', h, Wq)
            k = torch.einsum('btd,dhe->bhte', h, Wk)
            v = torch.einsum('btd,dhe->bhte', h, Wv)
            scores = torch.einsum('bhqe,bhke->bhqk', q, k) * scale
            scores = torch.where(mask[None, None], scores, -1000000000.0)
            p = _softmax(scores, axis=-1)
            o = torch.einsum('bhqk,bhke->bhqe', p, v)
            o = torch.einsum('bhte,hed->btd', o, Wo)
            mem = o[:, :M, :].clone()
            outs.append(o[:, M:, :])
        return torch.concatenate(outs, axis=1)

    def _B_ref(x, mem0, Wq, Wk, Wv, Wo, seg_len):
        B, S, Dm = x.shape
        H, Dh = (Wq.shape[1], Wq.shape[2])
        M = mem0.shape[1]
        scale = Dh ** (-0.5)
        n_seg = S // seg_len
        L = M + seg_len
        idx = torch.arange(L)
        mask = (idx[:, None] < M) | (idx[:, None] >= idx[None, :])
        mem = mem0
        outs = []
        for s in range(n_seg):
            xs = x[:, s * seg_len:(s + 1) * seg_len, :].clone()
            h = torch.concatenate([mem, xs], axis=1)
            q = torch.einsum('btd,dhe->bhte', h, Wq)
            k = torch.einsum('btd,dhe->bhte', h, Wk)
            v = torch.einsum('btd,dhe->bhte', h, Wv)
            scores = torch.einsum('bhqe,bhke->bhqk', q, k) * scale
            scores = torch.where(mask[None, None], scores, -1000000000.0)
            p = _softmax(scores, axis=-1)
            o = torch.einsum('bhqk,bhke->bhqe', p, v)
            o = torch.einsum('bhte,hed->btd', o, Wo)
            mem = o[:, :M, :].clone()
            outs.append(o[:, M:, :])
        return torch.concatenate(outs, axis=1)
    a = _A_ref(A_x, A_mem0, A_Wq, A_Wk, A_Wv, A_Wo, A_seg_len)
    b = _B_ref(B_x, B_mem0, B_Wq, B_Wk, B_Wv, B_Wo, B_seg_len)
    return torch.concatenate([a, b], axis=-1)
```

```asm
; @launch grid=(256,1,1) block=(256,1,1) lds=163840
.amdgcn_target "amdgcn-amd-amdhsa--gfx950"
.text
.globl concat_heads__memory_aug_recurrent_mem_tr__memory_aug_recurrent_mem_tr__prompt_kernel
.p2align 8
.type concat_heads__memory_aug_recurrent_mem_tr__memory_aug_recurrent_mem_tr__prompt_kernel,@function
concat_heads__memory_aug_recurrent_mem_tr__memory_aug_recurrent_mem_tr__prompt_kernel:
  s_cmp_ge_u32 s2, 256
  s_cbranch_scc1 L_END
  s_load_dwordx2 s[24:25], s[0:1], 120
  s_load_dwordx16 s[64:79], s[0:1], 0
  s_load_dwordx16 s[80:95], s[0:1], 64
  s_load_dwordx2 s[96:97], s[0:1], 128
  s_getreg_b32 s12, hwreg(HW_REG_XCC_ID, 0, 4)
  s_waitcnt lgkmcnt(0)
  s_and_b32 s12, s12, 7
  s_lshl_b32 s13, s12, 2
  v_mov_b32 v3, s13
  v_mov_b32 v4, 1
  v_cmp_eq_u32 vcc, 0, v0
  s_nop 0
  s_and_saveexec_b64 s[14:15], vcc
  s_cbranch_execz NA_1
  global_atomic_add v5, v3, v4, s[24:25] sc0
  s_waitcnt vmcnt(0)
  v_mov_b32 v6, 0
  ds_write_b32 v6, v5
  s_waitcnt lgkmcnt(0)
NA_1:
  s_mov_b64 exec, s[14:15]
  s_barrier
  v_mov_b32 v6, 0
  ds_read_b32 v5, v6
  s_waitcnt lgkmcnt(0)
  v_readfirstlane_b32 s16, v5
  s_barrier
  s_lshl_b32 s17, s12, 5
  s_add_u32 s17, s17, s16
  s_cmp_lt_u32 s16, 32
  s_cbranch_scc1 SLOT_2
  v_and_b32 v6, 7, v0
  v_lshlrev_b32 v6, 2, v6
  s_mov_b32 s7, 0
OV_3:
  global_load_dword v5, v6, s[24:25] sc1
  s_add_u32 s7, s7, 1
  s_cmp_gt_u32 s7, 0x400000
  s_cbranch_scc1 OVX_4
  s_waitcnt vmcnt(0)
  s_mov_b32 s18, 0
  v_readlane_b32 s40, v5, 0
  v_readlane_b32 s41, v5, 1
  v_readlane_b32 s42, v5, 2
  v_readlane_b32 s43, v5, 3
  v_readlane_b32 s44, v5, 4
  v_readlane_b32 s45, v5, 5
  v_readlane_b32 s46, v5, 6
  v_readlane_b32 s47, v5, 7
  s_nop 1
  s_add_u32 s18, s18, s40
  s_add_u32 s18, s18, s41
  s_add_u32 s18, s18, s42
  s_add_u32 s18, s18, s43
  s_add_u32 s18, s18, s44
  s_add_u32 s18, s18, s45
  s_add_u32 s18, s18, s46
  s_add_u32 s18, s18, s47
  s_cmp_ge_u32 s18, 256
  s_cbranch_scc1 OVX_4
  s_sleep 2
  s_branch OV_3
OVX_4:
  s_waitcnt vmcnt(0)
  v_mov_b32 v3, 36
  v_mov_b32 v4, 1
  v_cmp_eq_u32 vcc, 0, v0
  s_nop 0
  s_and_saveexec_b64 s[14:15], vcc
  s_cbranch_execz NB_5
  global_atomic_add v5, v3, v4, s[24:25] sc0
  s_waitcnt vmcnt(0)
  v_mov_b32 v6, 0
  ds_write_b32 v6, v5
  s_waitcnt lgkmcnt(0)
NB_5:
  s_mov_b64 exec, s[14:15]
  s_barrier
  v_mov_b32 v6, 0
  ds_read_b32 v5, v6
  s_waitcnt lgkmcnt(0)
  v_readfirstlane_b32 s19, v5
  s_barrier
  s_mov_b32 s17, 255
  s_min_u32 s20, s40, 32
  s_sub_u32 s21, 32, s20
  s_add_u32 s22, s20, 0
  s_add_u32 s22, s22, s19
  s_cmp_lt_u32 s19, s21
  s_cselect_b32 s17, s22, s17
  s_cselect_b32 s19, 0x10000, s19
  s_cselect_b32 s21, 0, s21
  s_sub_u32 s19, s19, s21
  s_min_u32 s20, s41, 32
  s_sub_u32 s21, 32, s20
  s_add_u32 s22, s20, 32
  s_add_u32 s22, s22, s19
  s_cmp_lt_u32 s19, s21
  s_cselect_b32 s17, s22, s17
  s_cselect_b32 s19, 0x10000, s19
  s_cselect_b32 s21, 0, s21
  s_sub_u32 s19, s19, s21
  s_min_u32 s20, s42, 32
  s_sub_u32 s21, 32, s20
  s_add_u32 s22, s20, 64
  s_add_u32 s22, s22, s19
  s_cmp_lt_u32 s19, s21
  s_cselect_b32 s17, s22, s17
  s_cselect_b32 s19, 0x10000, s19
  s_cselect_b32 s21, 0, s21
  s_sub_u32 s19, s19, s21
  s_min_u32 s20, s43, 32
  s_sub_u32 s21, 32, s20
  s_add_u32 s22, s20, 96
  s_add_u32 s22, s22, s19
  s_cmp_lt_u32 s19, s21
  s_cselect_b32 s17, s22, s17
  s_cselect_b32 s19, 0x10000, s19
  s_cselect_b32 s21, 0, s21
  s_sub_u32 s19, s19, s21
  s_min_u32 s20, s44, 32
  s_sub_u32 s21, 32, s20
  s_add_u32 s22, s20, 128
  s_add_u32 s22, s22, s19
  s_cmp_lt_u32 s19, s21
  s_cselect_b32 s17, s22, s17
  s_cselect_b32 s19, 0x10000, s19
  s_cselect_b32 s21, 0, s21
  s_sub_u32 s19, s19, s21
  s_min_u32 s20, s45, 32
  s_sub_u32 s21, 32, s20
  s_add_u32 s22, s20, 160
  s_add_u32 s22, s22, s19
  s_cmp_lt_u32 s19, s21
  s_cselect_b32 s17, s22, s17
  s_cselect_b32 s19, 0x10000, s19
  s_cselect_b32 s21, 0, s21
  s_sub_u32 s19, s19, s21
  s_min_u32 s20, s46, 32
  s_sub_u32 s21, 32, s20
  s_add_u32 s22, s20, 192
  s_add_u32 s22, s22, s19
  s_cmp_lt_u32 s19, s21
  s_cselect_b32 s17, s22, s17
  s_cselect_b32 s19, 0x10000, s19
  s_cselect_b32 s21, 0, s21
  s_sub_u32 s19, s19, s21
  s_min_u32 s20, s47, 32
  s_sub_u32 s21, 32, s20
  s_add_u32 s22, s20, 224
  s_add_u32 s22, s22, s19
  s_cmp_lt_u32 s19, s21
  s_cselect_b32 s17, s22, s17
  s_cselect_b32 s19, 0x10000, s19
  s_cselect_b32 s21, 0, s21
  s_sub_u32 s19, s19, s21
SLOT_2:
  s_and_b32 s27, s17, 31
  s_lshr_b32 s29, s17, 5
  s_and_b32 s26, s29, 1
  s_mov_b32 s8, s96
  s_and_b32 s9, s97, 0xffff
  s_mov_b32 s10, 0x10000000
  s_mov_b32 s11, 0x20000
  v_lshrrev_b32 v1, 6, v0
  s_nop 0
  v_readfirstlane_b32 s28, v1
  v_and_b32 v2, 63, v0
  s_lshr_b32 s4, s29, 1
  s_cmp_eq_u32 s4, 1
  s_cbranch_scc1 L_KV
  s_cmp_eq_u32 s4, 2
  s_cbranch_scc1 L_QA
  s_cmp_eq_u32 s4, 3
  s_cbranch_scc1 L_WO
  v_mov_b32 v7, v2
  s_mul_i32 s4, s26, 56
  s_add_u32 s30, s0, s4
  s_addc_u32 s31, s1, 0
  v_lshlrev_b32 v0, 4, v7
  s_lshl_b32 s4, s26, 5
  s_add_u32 s4, s4, s27
  s_lshl_b32 s4, s4, 2
  s_add_u32 s4, s4, s28
  s_lshl_b32 s4, s4, 14
  s_add_u32 s39, s4, 159383552
  s_cmp_eq_u32 s26, 0
  s_cselect_b32 s4, s68, s82
  s_cselect_b32 s5, s69, s83
  s_mov_b32 s12, s4
  s_and_b32 s13, s5, 0xffff
  s_mov_b32 s14, 0x500000
  s_mov_b32 s15, 0x20000
  s_cmp_eq_u32 s26, 0
  s_cselect_b32 s4, s70, s84
  s_cselect_b32 s5, s71, s85
  s_mov_b32 s16, s4
  s_and_b32 s17, s5, 0xffff
  s_mov_b32 s18, 0x500000
  s_mov_b32 s19, 0x20000
  s_cmp_eq_u32 s26, 0
  s_cselect_b32 s4, s72, s86
  s_cselect_b32 s5, s73, s87
  s_mov_b32 s20, s4
  s_and_b32 s21, s5, 0xffff
  s_mov_b32 s22, 0x500000
  s_mov_b32 s23, 0x20000
  s_cmp_eq_u32 s26, 0
  s_cselect_b32 s4, s74, s88
  s_cselect_b32 s5, s75, s89
  s_mov_b32 s60, s4
  s_and_b32 s61, s5, 0xffff
  s_mov_b32 s62, 0x500000
  s_mov_b32 s63, 0x20000
  s_cmp_eq_u32 s26, 0
  s_cselect_b32 s4, s66, s80
  s_cselect_b32 s5, s67, s81
  s_mov_b32 s84, s4
  s_and_b32 s85, s5, 0xffff
  s_mov_b32 s86, 0x2800
  s_mov_b32 s87, 0x20000
  v_and_b32 v8, 15, v7
  v_lshrrev_b32 v9, 4, v7
  v_and_b32 v10, 2, v7
  v_cmp_ne_u32 s[44:45], 0, v10
  v_cmp_gt_u32 s[46:47], 8, v8
  v_cmp_gt_u32 s[48:49], 4, v8
  s_mul_i32 s56, s26, 786432
  s_add_u32 s56, s56, 163577856
  s_mul_i32 s57, s26, 49152
  s_add_u32 s57, s57, 165675008
  s_and_b32 s5, s28, 1
  s_cmp_lt_u32 s27, 16
  s_cselect_b32 s4, 2, 0
  s_cmp_eq_u32 s5, 0
  s_cselect_b32 s51, 1, s4
  s_cmp_ge_u32 s28, 2
  s_cselect_b32 s51, 0, s51
  s_bfe_u32 s4, s27, 0x20002
  s_lshl_b32 s4, s4, 8
  s_bfe_u32 s5, s27, 0x10001
  s_lshl_b32 s5, s5, 4
  s_add_u32 s4, s4, s5
  s_and_b32 s5, s27, 1
  s_lshl_b32 s5, s5, 3
  s_add_u32 s4, s4, s5
  s_lshr_b32 s5, s27, 4
  s_lshl_b32 s5, s5, 12
  s_add_u32 s5, s5, s4
  s_add_u32 s4, s4, 8192
  s_cmp_eq_u32 s51, 2
  s_cselect_b32 s53, s4, s5
  s_lshl_b32 s4, s27, 12
  s_add_u32 s4, s4, 262144
  s_lshl_b32 s5, s27, 13
  s_cmp_eq_u32 s51, 2
  s_cselect_b32 s52, s4, s5
  s_lshl_b32 s4, s26, 5
  s_add_u32 s4, s4, s27
  s_lshl_b32 s4, s4, 7
  s_add_u32 s58, s4, 166731776
  s_add_u32 s59, s4, 166723584
  v_mov_b32 v18, 0
  v_mov_b32 v19, 0
  s_mov_b64 exec, 1
  buffer_store_dword v18, v19, s[8:11], s58 offen sc1
  s_mov_b64 exec, -1
  s_cmp_eq_u32 s51, 0
  s_cbranch_scc1 CI_6
  v_mov_b32 v14, -1
  v_mov_b32 v15, -1
  v_mov_b32 v16, -1
  v_mov_b32 v17, -1
  s_add_u32 s5, s56, s52
  buffer_store_dwordx4 v[14:17], v0, s[8:11], s5 offen offset:0 sc1
  buffer_store_dwordx4 v[14:17], v0, s[8:11], s5 offen offset:1024 sc1
  buffer_store_dwordx4 v[14:17], v0, s[8:11], s5 offen offset:2048 sc1
  buffer_store_dwordx4 v[14:17], v0, s[8:11], s5 offen offset:3072 sc1
  s_cmp_eq_u32 s51, 2
  s_cbranch_scc1 CI2_7
  s_add_u32 s5, s5, 4096
  buffer_store_dwordx4 v[14:17], v0, s[8:11], s5 offen offset:0 sc1
  buffer_store_dwordx4 v[14:17], v0, s[8:11], s5 offen offset:1024 sc1
  buffer_store_dwordx4 v[14:17], v0, s[8:11], s5 offen offset:2048 sc1
  buffer_store_dwordx4 v[14:17], v0, s[8:11], s5 offen offset:3072 sc1
CI2_7:
  v_bfe_u32 v18, v7, 1, 3
  v_lshlrev_b32 v18, 10, v18
  v_lshrrev_b32 v19, 4, v7
  v_lshl_add_u32 v18, v19, 6, v18
  v_and_b32 v19, 1, v7
  v_lshl_add_u32 v18, v19, 5, v18
  s_cmp_eq_u32 s51, 2
  s_cselect_b64 exec, s[48:49], s[46:47]
  s_add_u32 s5, s57, s53
  buffer_store_dwordx2 v[14:15], v18, s[8:11], s5 offen sc1
  s_add_u32 s5, s57, s53
  s_add_u32 s5, s5, 16384
  buffer_store_dwordx2 v[14:15], v18, s[8:11], s5 offen sc1
  s_add_u32 s5, s57, s53
  s_add_u32 s5, s5, 32768
  buffer_store_dwordx2 v[14:15], v18, s[8:11], s5 offen sc1
  s_mov_b64 exec, -1
CI_6:
  v_bfe_u32 v10, v7, 1, 3
  v_mul_u32_u24 v10, 1280, v10
  v_lshl_add_u32 v10, v9, 5, v10
  v_and_b32 v11, 1, v7
  v_lshl_add_u32 v10, v11, 4, v10
  s_lshl_b32 s4, s28, 7
  s_add_u32 s5, s4, 0
  buffer_load_dwordx4 v[14:17], v10, s[84:87], s5 offen
  s_add_u32 s5, s4, 512
  buffer_load_dwordx4 v[18:21], v10, s[84:87], s5 offen
  s_add_u32 s5, s4, 1024
  buffer_load_dwordx4 v[22:25], v10, s[84:87], s5 offen
  s_and_b32 s4, s28, 1
  s_lshl_b32 s4, s4, 1
  s_lshr_b32 s5, s28, 1
  s_lshl_b32 s5, s5, 2
  s_or_b32 s4, s4, s5
  v_bfe_u32 v36, v7, 4, 1
  v_or_b32 v36, s4, v36
  v_lshlrev_b32 v36, 1, v36
  v_and_b32 v37, 15, v7
  v_xor_b32 v36, v36, v37
  v_lshlrev_b32 v36, 4, v36
  s_lshl_b32 s4, s28, 2
  v_lshrrev_b32 v37, 4, v7
  v_add_u32 v37, s4, v37
  v_lshl_add_u32 v30, v37, 13, v36
  v_mul_u32_u24 v37, 1280, v37
  v_add_u32 v31, v37, v36
  v_bfe_u32 v38, v7, 2, 1
  v_bfe_u32 v39, v7, 3, 1
  v_bfe_u32 v40, v7, 4, 1
  v_lshrrev_b32 v41, 5, v7
  v_lshl_or_b32 v36, v40, 1, v38
  v_lshl_or_b32 v36, v39, 2, v36
  v_lshl_or_b32 v37, v39, 3, v38
  v_lshl_or_b32 v37, v40, 2, v37
  v_lshl_or_b32 v37, v41, 4, v37
  v_lshlrev_b32 v37, 8, v37
  v_and_b32 v38, 3, v7
  v_lshl_add_u32 v37, v38, 3, v37
  s_lshl_b32 s4, s28, 1
  v_xor_b32 v38, s4, v36
  v_lshl_add_u32 v32, v38, 5, v37
  v_xor_b32 v33, 32, v32
  v_xor_b32 v38, s28, v36
  v_lshl_add_u32 v34, v38, 5, v37
  v_xor_b32 v35, 128, v34
  s_lshl_b32 s40, s27, 8
  s_mul_i32 s41, s27, 163840
  s_lshl_b32 s42, s28, 10
  s_add_u32 m0, s42, 16384
  s_add_u32 s5, s40, 0
  buffer_load_dwordx4 v30, s[12:15], s5 offen nt lds
  s_add_u32 m0, s42, 20480
  s_add_u32 s5, s40, 131072
  buffer_load_dwordx4 v30, s[12:15], s5 offen nt lds
  s_add_u32 m0, s42, 24576
  s_add_u32 s5, s40, 262144
  buffer_load_dwordx4 v30, s[12:15], s5 offen nt lds
  s_add_u32 m0, s42, 28672
  s_add_u32 s5, s40, 393216
  buffer_load_dwordx4 v30, s[12:15], s5 offen nt lds
  s_add_u32 m0, s42, 32768
  s_add_u32 s5, s40, 524288
  buffer_load_dwordx4 v30, s[12:15], s5 offen nt lds
  s_add_u32 m0, s42, 36864
  s_add_u32 s5, s40, 655360
  buffer_load_dwordx4 v30, s[12:15], s5 offen nt lds
  s_add_u32 m0, s42, 40960
  s_add_u32 s5, s40, 786432
  buffer_load_dwordx4 v30, s[12:15], s5 offen nt lds
  s_add_u32 m0, s42, 45056
  s_add_u32 s5, s40, 917504
  buffer_load_dwordx4 v30, s[12:15], s5 offen nt lds
  s_add_u32 m0, s42, 49152
  s_add_u32 s5, s40, 1048576
  buffer_load_dwordx4 v30, s[12:15], s5 offen nt lds
  s_add_u32 m0, s42, 53248
  s_add_u32 s5, s40, 1179648
  buffer_load_dwordx4 v30, s[12:15], s5 offen nt lds
  s_add_u32 m0, s42, 57344
  s_add_u32 s5, s40, 1310720
  buffer_load_dwordx4 v30, s[12:15], s5 offen nt lds
  s_add_u32 m0, s42, 61440
  s_add_u32 s5, s40, 1441792
  buffer_load_dwordx4 v30, s[12:15], s5 offen nt lds
  s_add_u32 m0, s42, 65536
  s_add_u32 s5, s40, 1572864
  buffer_load_dwordx4 v30, s[12:15], s5 offen nt lds
  s_add_u32 m0, s42, 69632
  s_add_u32 s5, s40, 1703936
  buffer_load_dwordx4 v30, s[12:15], s5 offen nt lds
  s_add_u32 m0, s42, 73728
  s_add_u32 s5, s40, 1835008
  buffer_load_dwordx4 v30, s[12:15], s5 offen nt lds
  s_add_u32 m0, s42, 77824
  s_add_u32 s5, s40, 1966080
  buffer_load_dwordx4 v30, s[12:15], s5 offen nt lds
  s_add_u32 m0, s42, 81920
  s_add_u32 s5, s40, 2097152
  buffer_load_dwordx4 v30, s[12:15], s5 offen nt lds
  s_add_u32 m0, s42, 86016
  s_add_u32 s5, s40, 2228224
  buffer_load_dwordx4 v30, s[12:15], s5 offen nt lds
  s_add_u32 m0, s42, 90112
  s_add_u32 s5, s40, 2359296
  buffer_load_dwordx4 v30, s[12:15], s5 offen nt lds
  s_add_u32 m0, s42, 94208
  s_add_u32 s5, s40, 2490368
  buffer_load_dwordx4 v30, s[12:15], s5 offen nt lds
  s_add_u32 m0, s42, 98304
  s_add_u32 s5, s40, 2621440
  buffer_load_dwordx4 v30, s[12:15], s5 offen nt lds
  s_add_u32 m0, s42, 102400
  s_add_u32 s5, s40, 2752512
  buffer_load_dwordx4 v30, s[12:15], s5 offen nt lds
  s_add_u32 m0, s42, 106496
  s_add_u32 s5, s40, 2883584
  buffer_load_dwordx4 v30, s[12:15], s5 offen nt lds
  s_add_u32 m0, s42, 110592
  s_add_u32 s5, s40, 3014656
  buffer_load_dwordx4 v30, s[12:15], s5 offen nt lds
  s_add_u32 m0, s42, 114688
  s_add_u32 s5, s40, 3145728
  buffer_load_dwordx4 v30, s[12:15], s5 offen nt lds
  s_add_u32 m0, s42, 118784
  s_add_u32 s5, s40, 3276800
  buffer_load_dwordx4 v30, s[12:15], s5 offen nt lds
  s_add_u32 m0, s42, 122880
  s_add_u32 s5, s40, 3407872
  buffer_load_dwordx4 v30, s[12:15], s5 offen nt lds
  s_add_u32 m0, s42, 126976
  s_add_u32 s5, s40, 3538944
  buffer_load_dwordx4 v30, s[12:15], s5 offen nt lds
  s_add_u32 m0, s42, 131072
  s_add_u32 s5, s40, 3670016
  buffer_load_dwordx4 v30, s[12:15], s5 offen nt lds
  s_add_u32 m0, s42, 135168
  s_add_u32 s5, s40, 3801088
  buffer_load_dwordx4 v30, s[12:15], s5 offen nt lds
  s_add_u32 m0, s42, 139264
  s_add_u32 s5, s40, 3932160
  buffer_load_dwordx4 v30, s[12:15], s5 offen nt lds
  s_add_u32 m0, s42, 143360
  s_add_u32 s5, s40, 4063232
  buffer_load_dwordx4 v30, s[12:15], s5 offen nt lds
  s_waitcnt vmcnt(28) lgkmcnt(0)
  s_barrier
  s_lshl_b32 s4, s28, 10
  v_add_u32 v11, s4, v0
  ds_write_b128 v11, v[14:17] offset:6144
  ds_write_b128 v11, v[18:21] offset:10240
  s_cmp_ge_u32 s28, 2
  s_cbranch_scc1 CH_M0_8
  ds_write_b128 v11, v[22:25] offset:14336
CH_M0_8:
  v_mov_b32 v10, 32
  v_mov_b32 v11, 1
  s_cmp_eq_u32 s28, 0
  s_cselect_b64 exec, 1, 0
  global_atomic_add v10, v11, s[24:25]
  s_mov_b64 exec, -1
  s_add_u32 m0, s42, 147456
  s_add_u32 s5, s40, 4194304
  buffer_load_dwordx4 v30, s[12:15], s5 offen nt lds
  s_add_u32 m0, s42, 151552
  s_add_u32 s5, s40, 4325376
  buffer_load_dwordx4 v30, s[12:15], s5 offen nt lds
  s_add_u32 m0, s42, 155648
  s_add_u32 s5, s40, 4456448
  buffer_load_dwordx4 v30, s[12:15], s5 offen nt lds
  s_add_u32 m0, s42, 159744
  s_add_u32 s5, s40, 4587520
  buffer_load_dwordx4 v30, s[12:15], s5 offen nt lds
  v_add_u32 v54, 16384, v32
  v_add_u32 v55, 16384, v33
  ds_read_b64_tr_b16 a[0:1], v54 offset:0
  ds_read_b64_tr_b16 a[2:3], v54 offset:512
  ds_read_b64_tr_b16 a[4:5], v54 offset:8192
  ds_read_b64_tr_b16 a[6:7], v54 offset:8704
  ds_read_b64_tr_b16 a[8:9], v55 offset:0
  ds_read_b64_tr_b16 a[10:11], v55 offset:512
  ds_read_b64_tr_b16 a[12:13], v55 offset:8192
  ds_read_b64_tr_b16 a[14:15], v55 offset:8704
  s_waitcnt vmcnt(29) lgkmcnt(0)
  s_barrier
  s_add_u32 m0, s42, 16384
  s_add_u32 s5, s40, 4718592
  buffer_load_dwordx4 v30, s[12:15], s5 offen nt lds
  s_add_u32 m0, s42, 20480
  s_add_u32 s5, s40, 4849664
  buffer_load_dwordx4 v30, s[12:15], s5 offen nt lds
  s_add_u32 m0, s42, 24576
  s_add_u32 s5, s40, 4980736
  buffer_load_dwordx4 v30, s[12:15], s5 offen nt lds
  s_add_u32 m0, s42, 28672
  s_add_u32 s5, s40, 5111808
  buffer_load_dwordx4 v30, s[12:15], s5 offen nt lds
  v_add_u32 v54, 32768, v32
  v_add_u32 v55, 32768, v33
  ds_read_b64_tr_b16 a[16:17], v54 offset:0
  ds_read_b64_tr_b16 a[18:19], v54 offset:512
  ds_read_b64_tr_b16 a[20:21], v54 offset:8192
  ds_read_b64_tr_b16 a[22:23], v54 offset:8704
  ds_read_b64_tr_b16 a[24:25], v55 offset:0
  ds_read_b64_tr_b16 a[26:27], v55 offset:512
  ds_read_b64_tr_b16 a[28:29], v55 offset:8192
  ds_read_b64_tr_b16 a[30:31], v55 offset:8704
  s_waitcnt vmcnt(29) lgkmcnt(0)
  s_barrier
  s_add_u32 m0, s42, 32768
  s_add_u32 s5, s40, 0
  buffer_load_dwordx4 v30, s[16:19], s5 offen lds
  s_add_u32 m0, s42, 36864
  s_add_u32 s5, s40, 131072
  buffer_load_dwordx4 v30, s[16:19], s5 offen lds
  s_add_u32 m0, s42, 40960
  s_add_u32 s5, s40, 262144
  buffer_load_dwordx4 v30, s[16:19], s5 offen lds
  s_add_u32 m0, s42, 45056
  s_add_u32 s5, s40, 393216
  buffer_load_dwordx4 v30, s[16:19], s5 offen lds
  v_add_u32 v54, 49152, v32
  v_add_u32 v55, 49152, v33
  ds_read_b64_tr_b16 a[32:33], v54 offset:0
  ds_read_b64_tr_b16 a[34:35], v54 offset:512
  ds_read_b64_tr_b16 a[36:37], v54 offset:8192
  ds_read_b64_tr_b16 a[38:39], v54 offset:8704
  ds_read_b64_tr_b16 a[40:41], v55 offset:0
  ds_read_b64_tr_b16 a[42:43], v55 offset:512
  ds_read_b64_tr_b16 a[44:45], v55 offset:8192
  ds_read_b64_tr_b16 a[46:47], v55 offset:8704
  s_waitcnt vmcnt(29) lgkmcnt(0)
  s_barrier
  s_add_u32 m0, s42, 49152
  s_add_u32 s5, s40, 524288
  buffer_load_dwordx4 v30, s[16:19], s5 offen lds
  s_add_u32 m0, s42, 53248
  s_add_u32 s5, s40, 655360
  buffer_load_dwordx4 v30, s[16:19], s5 offen lds
  s_add_u32 m0, s42, 57344
  s_add_u32 s5, s40, 786432
  buffer_load_dwordx4 v30, s[16:19], s5 offen lds
  s_add_u32 m0, s42, 61440
  s_add_u32 s5, s40, 917504
  buffer_load_dwordx4 v30, s[16:19], s5 offen lds
  v_add_u32 v54, 65536, v32
  v_add_u32 v55, 65536, v33
  ds_read_b64_tr_b16 a[48:49], v54 offset:0
  ds_read_b64_tr_b16 a[50:51], v54 offset:512
  ds_read_b64_tr_b16 a[52:53], v54 offset:8192
  ds_read_b64_tr_b16 a[54:55], v54 offset:8704
  ds_read_b64_tr_b16 a[56:57], v55 offset:0
  ds_read_b64_tr_b16 a[58:59], v55 offset:512
  ds_read_b64_tr_b16 a[60:61], v55 offset:8192
  ds_read_b64_tr_b16 a[62:63], v55 offset:8704
  s_waitcnt vmcnt(29) lgkmcnt(0)
  s_barrier
  s_add_u32 m0, s42, 65536
  s_add_u32 s5, s40, 1048576
  buffer_load_dwordx4 v30, s[16:19], s5 offen lds
  s_add_u32 m0, s42, 69632
  s_add_u32 s5, s40, 1179648
  buffer_load_dwordx4 v30, s[16:19], s5 offen lds
  s_add_u32 m0, s42, 73728
  s_add_u32 s5, s40, 1310720
  buffer_load_dwordx4 v30, s[16:19], s5 offen lds
  s_add_u32 m0, s42, 77824
  s_add_u32 s5, s40, 1441792
  buffer_load_dwordx4 v30, s[16:19], s5 offen lds
  v_add_u32 v54, 81920, v32
  v_add_u32 v55, 81920, v33
  ds_read_b64_tr_b16 a[64:65], v54 offset:0
  ds_read_b64_tr_b16 a[66:67], v54 offset:512
  ds_read_b64_tr_b16 a[68:69], v54 offset:8192
  ds_read_b64_tr_b16 a[70:71], v54 offset:8704
  ds_read_b64_tr_b16 a[72:73], v55 offset:0
  ds_read_b64_tr_b16 a[74:75], v55 offset:512
  ds_read_b64_tr_b16 a[76:77], v55 offset:8192
  ds_read_b64_tr_b16 a[78:79], v55 offset:8704
  s_waitcnt vmcnt(29) lgkmcnt(0)
  s_barrier
  s_add_u32 m0, s42, 81920
  s_add_u32 s5, s40, 1572864
  buffer_load_dwordx4 v30, s[16:19], s5 offen lds
  s_add_u32 m0, s42, 86016
  s_add_u32 s5, s40, 1703936
  buffer_load_dwordx4 v30, s[16:19], s5 offen lds
  s_add_u32 m0, s42, 90112
  s_add_u32 s5, s40, 1835008
  buffer_load_dwordx4 v30, s[16:19], s5 offen lds
  s_add_u32 m0, s42, 94208
  s_add_u32 s5, s40, 1966080
  buffer_load_dwordx4 v30, s[16:19], s5 offen lds
  v_add_u32 v54, 98304, v32
  v_add_u32 v55, 98304, v33
  ds_read_b64_tr_b16 a[80:81], v54 offset:0
  ds_read_b64_tr_b16 a[82:83], v54 offset:512
  ds_read_b64_tr_b16 a[84:85], v54 offset:8192
  ds_read_b64_tr_b16 a[86:87], v54 offset:8704
  ds_read_b64_tr_b16 a[88:89], v55 offset:0
  ds_read_b64_tr_b16 a[90:91], v55 offset:512
  ds_read_b64_tr_b16 a[92:93], v55 offset:8192
  ds_read_b64_tr_b16 a[94:95], v55 offset:8704
  s_waitcnt vmcnt(29) lgkmcnt(0)
  s_barrier
  s_add_u32 m0, s42, 98304
  s_add_u32 s5, s40, 2097152
  buffer_load_dwordx4 v30, s[16:19], s5 offen lds
  s_add_u32 m0, s42, 102400
  s_add_u32 s5, s40, 2228224
  buffer_load_dwordx4 v30, s[16:19], s5 offen lds
  s_add_u32 m0, s42, 106496
  s_add_u32 s5, s40, 2359296
  buffer_load_dwordx4 v30, s[16:19], s5 offen lds
  s_add_u32 m0, s42, 110592
  s_add_u32 s5, s40, 2490368
  buffer_load_dwordx4 v30, s[16:19], s5 offen lds
  v_add_u32 v54, 114688, v32
  v_add_u32 v55, 114688, v33
  ds_read_b64_tr_b16 a[96:97], v54 offset:0
  ds_read_b64_tr_b16 a[98:99], v54 offset:512
  ds_read_b64_tr_b16 a[100:101], v54 offset:8192
  ds_read_b64_tr_b16 a[102:103], v54 offset:8704
  ds_read_b64_tr_b16 a[104:105], v55 offset:0
  ds_read_b64_tr_b16 a[106:107], v55 offset:512
  ds_read_b64_tr_b16 a[108:109], v55 offset:8192
  ds_read_b64_tr_b16 a[110:111], v55 offset:8704
  s_waitcnt vmcnt(29) lgkmcnt(0)
  s_barrier
  s_add_u32 m0, s42, 114688
  s_add_u32 s5, s40, 2621440
  buffer_load_dwordx4 v30, s[16:19], s5 offen lds
  s_add_u32 m0, s42, 118784
  s_add_u32 s5, s40, 2752512
  buffer_load_dwordx4 v30, s[16:19], s5 offen lds
  s_add_u32 m0, s42, 122880
  s_add_u32 s5, s40, 2883584
  buffer_load_dwordx4 v30, s[16:19], s5 offen lds
  s_add_u32 m0, s42, 126976
  s_add_u32 s5, s40, 3014656
  buffer_load_dwordx4 v30, s[16:19], s5 offen lds
  v_add_u32 v54, 131072, v32
  v_add_u32 v55, 131072, v33
  ds_read_b64_tr_b16 a[112:113], v54 offset:0
  ds_read_b64_tr_b16 a[114:115], v54 offset:512
  ds_read_b64_tr_b16 a[116:117], v54 offset:8192
  ds_read_b64_tr_b16 a[118:119], v54 offset:8704
  ds_read_b64_tr_b16 a[120:121], v55 offset:0
  ds_read_b64_tr_b16 a[122:123], v55 offset:512
  ds_read_b64_tr_b16 a[124:125], v55 offset:8192
  ds_read_b64_tr_b16 a[126:127], v55 offset:8704
  s_waitcnt vmcnt(28) lgkmcnt(0)
  s_barrier
  s_add_u32 m0, s42, 131072
  s_add_u32 s5, s40, 3145728
  buffer_load_dwordx4 v30, s[16:19], s5 offen lds
  s_add_u32 m0, s42, 135168
  s_add_u32 s5, s40, 3276800
  buffer_load_dwordx4 v30, s[16:19], s5 offen lds
  s_add_u32 m0, s42, 139264
  s_add_u32 s5, s40, 3407872
  buffer_load_dwordx4 v30, s[16:19], s5 offen lds
  s_add_u32 m0, s42, 143360
  s_add_u32 s5, s40, 3538944
  buffer_load_dwordx4 v30, s[16:19], s5 offen lds
  v_add_u32 v54, 147456, v32
  v_add_u32 v55, 147456, v33
  ds_read_b64_tr_b16 a[128:129], v54 offset:0
  ds_read_b64_tr_b16 a[130:131], v54 offset:512
  ds_read_b64_tr_b16 a[132:133], v54 offset:8192
  ds_read_b64_tr_b16 a[134:135], v54 offset:8704
  ds_read_b64_tr_b16 a[136:137], v55 offset:0
  ds_read_b64_tr_b16 a[138:139], v55 offset:512
  ds_read_b64_tr_b16 a[140:141], v55 offset:8192
  ds_read_b64_tr_b16 a[142:143], v55 offset:8704
  s_waitcnt vmcnt(28) lgkmcnt(0)
  s_barrier
  s_add_u32 m0, s42, 147456
  s_add_u32 s5, s40, 3670016
  buffer_load_dwordx4 v30, s[16:19], s5 offen lds
  s_add_u32 m0, s42, 151552
  s_add_u32 s5, s40, 3801088
  buffer_load_dwordx4 v30, s[16:19], s5 offen lds
  s_add_u32 m0, s42, 155648
  s_add_u32 s5, s40, 3932160
  buffer_load_dwordx4 v30, s[16:19], s5 offen lds
  s_add_u32 m0, s42, 159744
  s_add_u32 s5, s40, 4063232
  buffer_load_dwordx4 v30, s[16:19], s5 offen lds
  v_add_u32 v54, 16384, v32
  v_add_u32 v55, 16384, v33
  ds_read_b64_tr_b16 v[38:39], v54 offset:0
  ds_read_b64_tr_b16 v[40:41], v54 offset:512
  ds_read_b64_tr_b16 v[42:43], v54 offset:8192
  ds_read_b64_tr_b16 v[44:45], v54 offset:8704
  ds_read_b64_tr_b16 v[46:47], v55 offset:0
  ds_read_b64_tr_b16 v[48:49], v55 offset:512
  ds_read_b64_tr_b16 v[50:51], v55 offset:8192
  ds_read_b64_tr_b16 v[52:53], v55 offset:8704
  s_waitcnt lgkmcnt(0)
  s_add_u32 s5, s39, 4096
  buffer_store_dwordx4 v[38:41], v0, s[8:11], s5 offen
  s_add_u32 s5, s39, 5120
  buffer_store_dwordx4 v[42:45], v0, s[8:11], s5 offen
  s_add_u32 s5, s39, 6144
  buffer_store_dwordx4 v[46:49], v0, s[8:11], s5 offen
  s_add_u32 s5, s39, 7168
  buffer_store_dwordx4 v[50:53], v0, s[8:11], s5 offen
  s_nop 1
  s_waitcnt vmcnt(32) lgkmcnt(0)
  s_barrier
  s_add_u32 m0, s42, 16384
  s_add_u32 s5, s40, 4194304
  buffer_load_dwordx4 v30, s[16:19], s5 offen lds
  s_add_u32 m0, s42, 20480
  s_add_u32 s5, s40, 4325376
  buffer_load_dwordx4 v30, s[16:19], s5 offen lds
  s_add_u32 m0, s42, 24576
  s_add_u32 s5, s40, 4456448
  buffer_load_dwordx4 v30, s[16:19], s5 offen lds
  s_add_u32 m0, s42, 28672
  s_add_u32 s5, s40, 4587520
  buffer_load_dwordx4 v30, s[16:19], s5 offen lds
  v_add_u32 v54, 32768, v32
  v_add_u32 v55, 32768, v33
  ds_read_b64_tr_b16 a[144:145], v54 offset:0
  ds_read_b64_tr_b16 a[146:147], v54 offset:512
  ds_read_b64_tr_b16 a[148:149], v54 offset:8192
  ds_read_b64_tr_b16 a[150:151], v54 offset:8704
  ds_read_b64_tr_b16 a[152:153], v55 offset:0
  ds_read_b64_tr_b16 a[154:155], v55 offset:512
  ds_read_b64_tr_b16 a[156:157], v55 offset:8192
  ds_read_b64_tr_b16 a[158:159], v55 offset:8704
  s_waitcnt vmcnt(32) lgkmcnt(0)
  s_barrier
  s_add_u32 m0, s42, 32768
  s_add_u32 s5, s40, 4718592
  buffer_load_dwordx4 v30, s[16:19], s5 offen lds
  s_add_u32 m0, s42, 36864
  s_add_u32 s5, s40, 4849664
  buffer_load_dwordx4 v30, s[16:19], s5 offen lds
  s_add_u32 m0, s42, 40960
  s_add_u32 s5, s40, 4980736
  buffer_load_dwordx4 v30, s[16:19], s5 offen lds
  s_add_u32 m0, s42, 45056
  s_add_u32 s5, s40, 5111808
  buffer_load_dwordx4 v30, s[16:19], s5 offen lds
  v_add_u32 v54, 49152, v32
  v_add_u32 v55, 49152, v33
  ds_read_b64_tr_b16 a[160:161], v54 offset:0
  ds_read_b64_tr_b16 a[162:163], v54 offset:512
  ds_read_b64_tr_b16 a[164:165], v54 offset:8192
  ds_read_b64_tr_b16 a[166:167], v54 offset:8704
  ds_read_b64_tr_b16 a[168:169], v55 offset:0
  ds_read_b64_tr_b16 a[170:171], v55 offset:512
  ds_read_b64_tr_b16 a[172:173], v55 offset:8192
  ds_read_b64_tr_b16 a[174:175], v55 offset:8704
  s_waitcnt vmcnt(32) lgkmcnt(0)
  s_barrier
  s_add_u32 m0, s42, 49152
  s_add_u32 s5, s40, 0
  buffer_load_dwordx4 v30, s[20:23], s5 offen lds
  s_add_u32 m0, s42, 53248
  s_add_u32 s5, s40, 131072
  buffer_load_dwordx4 v30, s[20:23], s5 offen lds
  s_add_u32 m0, s42, 57344
  s_add_u32 s5, s40, 262144
  buffer_load_dwordx4 v30, s[20:23], s5 offen lds
  s_add_u32 m0, s42, 61440
  s_add_u32 s5, s40, 393216
  buffer_load_dwordx4 v30, s[20:23], s5 offen lds
  v_add_u32 v54, 65536, v32
  v_add_u32 v55, 65536, v33
  ds_read_b64_tr_b16 a[176:177], v54 offset:0
  ds_read_b64_tr_b16 a[178:179], v54 offset:512
  ds_read_b64_tr_b16 a[180:181], v54 offset:8192
  ds_read_b64_tr_b16 a[182:183], v54 offset:8704
  ds_read_b64_tr_b16 a[184:185], v55 offset:0
  ds_read_b64_tr_b16 a[186:187], v55 offset:512
  ds_read_b64_tr_b16 a[188:189], v55 offset:8192
  ds_read_b64_tr_b16 a[190:191], v55 offset:8704
  s_waitcnt vmcnt(32) lgkmcnt(0)
  s_barrier
  s_add_u32 m0, s42, 65536
  s_add_u32 s5, s40, 3145728
  buffer_load_dwordx4 v30, s[20:23], s5 offen lds
  s_add_u32 m0, s42, 69632
  s_add_u32 s5, s40, 3276800
  buffer_load_dwordx4 v30, s[20:23], s5 offen lds
  s_add_u32 m0, s42, 73728
  s_add_u32 s5, s40, 3407872
  buffer_load_dwordx4 v30, s[20:23], s5 offen lds
  s_add_u32 m0, s42, 77824
  s_add_u32 s5, s40, 3538944
  buffer_load_dwordx4 v30, s[20:23], s5 offen lds
  v_add_u32 v54, 81920, v32
  v_add_u32 v55, 81920, v33
  ds_read_b64_tr_b16 a[192:193], v54 offset:0
  ds_read_b64_tr_b16 a[194:195], v54 offset:512
  ds_read_b64_tr_b16 a[196:197], v54 offset:8192
  ds_read_b64_tr_b16 a[198:199], v54 offset:8704
  ds_read_b64_tr_b16 a[200:201], v55 offset:0
  ds_read_b64_tr_b16 a[202:203], v55 offset:512
  ds_read_b64_tr_b16 a[204:205], v55 offset:8192
  ds_read_b64_tr_b16 a[206:207], v55 offset:8704
  s_waitcnt vmcnt(32) lgkmcnt(0)
  s_barrier
  s_add_u32 m0, s42, 81920
  s_add_u32 s5, s40, 3670016
  buffer_load_dwordx4 v30, s[20:23], s5 offen lds
  s_add_u32 m0, s42, 86016
  s_add_u32 s5, s40, 3801088
  buffer_load_dwordx4 v30, s[20:23], s5 offen lds
  s_add_u32 m0, s42, 90112
  s_add_u32 s5, s40, 3932160
  buffer_load_dwordx4 v30, s[20:23], s5 offen lds
  s_add_u32 m0, s42, 94208
  s_add_u32 s5, s40, 4063232
  buffer_load_dwordx4 v30, s[20:23], s5 offen lds
  v_add_u32 v54, 98304, v32
  v_add_u32 v55, 98304, v33
  ds_read_b64_tr_b16 a[208:209], v54 offset:0
  ds_read_b64_tr_b16 a[210:211], v54 offset:512
  ds_read_b64_tr_b16 a[212:213], v54 offset:8192
  ds_read_b64_tr_b16 a[214:215], v54 offset:8704
  ds_read_b64_tr_b16 a[216:217], v55 offset:0
  ds_read_b64_tr_b16 a[218:219], v55 offset:512
  ds_read_b64_tr_b16 a[220:221], v55 offset:8192
  ds_read_b64_tr_b16 a[222:223], v55 offset:8704
  s_waitcnt vmcnt(32) lgkmcnt(0)
  s_barrier
  s_add_u32 m0, s42, 98304
  s_add_u32 s5, s40, 4194304
  buffer_load_dwordx4 v30, s[20:23], s5 offen lds
  s_add_u32 m0, s42, 102400
  s_add_u32 s5, s40, 4325376
  buffer_load_dwordx4 v30, s[20:23], s5 offen lds
  s_add_u32 m0, s42, 106496
  s_add_u32 s5, s40, 4456448
  buffer_load_dwordx4 v30, s[20:23], s5 offen lds
  s_add_u32 m0, s42, 110592
  s_add_u32 s5, s40, 4587520
  buffer_load_dwordx4 v30, s[20:23], s5 offen lds
  v_add_u32 v54, 114688, v32
  v_add_u32 v55, 114688, v33
  ds_read_b64_tr_b16 a[224:225], v54 offset:0
  ds_read_b64_tr_b16 a[226:227], v54 offset:512
  ds_read_b64_tr_b16 a[228:229], v54 offset:8192
  ds_read_b64_tr_b16 a[230:231], v54 offset:8704
  ds_read_b64_tr_b16 a[232:233], v55 offset:0
  ds_read_b64_tr_b16 a[234:235], v55 offset:512
  ds_read_b64_tr_b16 a[236:237], v55 offset:8192
  ds_read_b64_tr_b16 a[238:239], v55 offset:8704
  s_waitcnt vmcnt(32) lgkmcnt(0)
  s_barrier
  s_add_u32 m0, s42, 114688
  s_add_u32 s5, s40, 4718592
  buffer_load_dwordx4 v30, s[20:23], s5 offen lds
  s_add_u32 m0, s42, 118784
  s_add_u32 s5, s40, 4849664
  buffer_load_dwordx4 v30, s[20:23], s5 offen lds
  s_add_u32 m0, s42, 122880
  s_add_u32 s5, s40, 4980736
  buffer_load_dwordx4 v30, s[20:23], s5 offen lds
  s_add_u32 m0, s42, 126976
  s_add_u32 s5, s40, 5111808
  buffer_load_dwordx4 v30, s[20:23], s5 offen lds
  v_add_u32 v54, 131072, v32
  v_add_u32 v55, 131072, v33
  ds_read_b64_tr_b16 a[240:241], v54 offset:0
  ds_read_b64_tr_b16 a[242:243], v54 offset:512
  ds_read_b64_tr_b16 a[244:245], v54 offset:8192
  ds_read_b64_tr_b16 a[246:247], v54 offset:8704
  ds_read_b64_tr_b16 a[248:249], v55 offset:0
  ds_read_b64_tr_b16 a[250:251], v55 offset:512
  ds_read_b64_tr_b16 a[252:253], v55 offset:8192
  ds_read_b64_tr_b16 a[254:255], v55 offset:8704
  s_waitcnt vmcnt(32) lgkmcnt(0)
  s_barrier
  s_add_u32 m0, s42, 131072
  s_add_u32 s5, s41, 0
  buffer_load_dwordx4 v31, s[60:63], s5 offen nt lds
  s_add_u32 m0, s42, 135168
  s_add_u32 s5, s41, 20480
  buffer_load_dwordx4 v31, s[60:63], s5 offen nt lds
  s_add_u32 m0, s42, 139264
  s_add_u32 s5, s41, 40960
  buffer_load_dwordx4 v31, s[60:63], s5 offen nt lds
  s_add_u32 m0, s42, 143360
  s_add_u32 s5, s41, 61440
  buffer_load_dwordx4 v31, s[60:63], s5 offen nt lds
  v_add_u32 v54, 147456, v32
  v_add_u32 v55, 147456, v33
  ds_read_b64_tr_b16 v[80:81], v54 offset:0
  ds_read_b64_tr_b16 v[82:83], v54 offset:512
  ds_read_b64_tr_b16 v[84:85], v54 offset:8192
  ds_read_b64_tr_b16 v[86:87], v54 offset:8704
  ds_read_b64_tr_b16 v[88:89], v55 offset:0
  ds_read_b64_tr_b16 v[90:91], v55 offset:512
  ds_read_b64_tr_b16 v[92:93], v55 offset:8192
  ds_read_b64_tr_b16 v[94:95], v55 offset:8704
  s_waitcnt vmcnt(28) lgkmcnt(0)
  s_barrier
  s_add_u32 m0, s42, 147456
  s_add_u32 s5, s41, 81920
  buffer_load_dwordx4 v31, s[60:63], s5 offen nt lds
  s_add_u32 m0, s42, 151552
  s_add_u32 s5, s41, 102400
  buffer_load_dwordx4 v31, s[60:63], s5 offen nt lds
  s_add_u32 m0, s42, 155648
  s_add_u32 s5, s41, 122880
  buffer_load_dwordx4 v31, s[60:63], s5 offen nt lds
  s_add_u32 m0, s42, 159744
  s_add_u32 s5, s41, 143360
  buffer_load_dwordx4 v31, s[60:63], s5 offen nt lds
  v_add_u32 v54, 16384, v32
  v_add_u32 v55, 16384, v33
  ds_read_b64_tr_b16 v[96:97], v54 offset:0
  ds_read_b64_tr_b16 v[98:99], v54 offset:512
  ds_read_b64_tr_b16 v[100:101], v54 offset:8192
  ds_read_b64_tr_b16 v[102:103], v54 offset:8704
  ds_read_b64_tr_b16 v[104:105], v55 offset:0
  ds_read_b64_tr_b16 v[106:107], v55 offset:512
  ds_read_b64_tr_b16 v[108:109], v55 offset:8192
  ds_read_b64_tr_b16 v[110:111], v55 offset:8704
  s_waitcnt vmcnt(28) lgkmcnt(0)
  s_barrier
  s_add_u32 m0, s42, 16384
  s_add_u32 s5, s41, 82176
  buffer_load_dwordx4 v31, s[60:63], s5 offen nt lds
  s_add_u32 m0, s42, 20480
  s_add_u32 s5, s41, 102656
  buffer_load_dwordx4 v31, s[60:63], s5 offen nt lds
  s_add_u32 m0, s42, 24576
  s_add_u32 s5, s41, 123136
  buffer_load_dwordx4 v31, s[60:63], s5 offen nt lds
  s_add_u32 m0, s42, 28672
  s_add_u32 s5, s41, 143616
  buffer_load_dwordx4 v31, s[60:63], s5 offen nt lds
  v_add_u32 v54, 32768, v32
  v_add_u32 v55, 32768, v33
  ds_read_b64_tr_b16 v[38:39], v54 offset:0
  ds_read_b64_tr_b16 v[40:41], v54 offset:512
  ds_read_b64_tr_b16 v[42:43], v54 offset:8192
  ds_read_b64_tr_b16 v[44:45], v54 offset:8704
  ds_read_b64_tr_b16 v[46:47], v55 offset:0
  ds_read_b64_tr_b16 v[48:49], v55 offset:512
  ds_read_b64_tr_b16 v[50:51], v55 offset:8192
  ds_read_b64_tr_b16 v[52:53], v55 offset:8704
  s_waitcnt lgkmcnt(0)
  s_add_u32 s5, s39, 0
  buffer_store_dwordx4 v[38:41], v0, s[8:11], s5 offen
  s_add_u32 s5, s39, 1024
  buffer_store_dwordx4 v[42:45], v0, s[8:11], s5 offen
  s_add_u32 s5, s39, 2048
  buffer_store_dwordx4 v[46:49], v0, s[8:11], s5 offen
  s_add_u32 s5, s39, 3072
  buffer_store_dwordx4 v[50:53], v0, s[8:11], s5 offen
  s_nop 1
  s_waitcnt vmcnt(32) lgkmcnt(0)
  s_barrier
  s_add_u32 m0, s42, 32768
  s_add_u32 s5, s41, 512
  buffer_load_dwordx4 v31, s[60:63], s5 offen nt lds
  s_add_u32 m0, s42, 36864
  s_add_u32 s5, s41, 20992
  buffer_load_dwordx4 v31, s[60:63], s5 offen nt lds
  s_add_u32 m0, s42, 40960
  s_add_u32 s5, s41, 41472
  buffer_load_dwordx4 v31, s[60:63], s5 offen nt lds
  s_add_u32 m0, s42, 45056
  s_add_u32 s5, s41, 61952
  buffer_load_dwordx4 v31, s[60:63], s5 offen nt lds
  v_add_u32 v54, 49152, v32
  v_add_u32 v55, 49152, v33
  ds_read_b64_tr_b16 v[112:113], v54 offset:0
  ds_read_b64_tr_b16 v[114:115], v54 offset:512
  ds_read_b64_tr_b16 v[116:117], v54 offset:8192
  ds_read_b64_tr_b16 v[118:119], v54 offset:8704
  ds_read_b64_tr_b16 v[120:121], v55 offset:0
  ds_read_b64_tr_b16 v[122:123], v55 offset:512
  ds_read_b64_tr_b16 v[124:125], v55 offset:8192
  ds_read_b64_tr_b16 v[126:127], v55 offset:8704
  s_waitcnt vmcnt(32) lgkmcnt(0)
  s_barrier
  s_add_u32 m0, s42, 49152
  s_add_u32 s5, s41, 82688
  buffer_load_dwordx4 v31, s[60:63], s5 offen nt lds
  s_add_u32 m0, s42, 53248
  s_add_u32 s5, s41, 103168
  buffer_load_dwordx4 v31, s[60:63], s5 offen nt lds
  s_add_u32 m0, s42, 57344
  s_add_u32 s5, s41, 123648
  buffer_load_dwordx4 v31, s[60:63], s5 offen nt lds
  s_add_u32 m0, s42, 61440
  s_add_u32 s5, s41, 144128
  buffer_load_dwordx4 v31, s[60:63], s5 offen nt lds
  v_add_u32 v54, 65536, v32
  v_add_u32 v55, 65536, v33
  ds_read_b64_tr_b16 v[128:129], v54 offset:0
  ds_read_b64_tr_b16 v[130:131], v54 offset:512
  ds_read_b64_tr_b16 v[132:133], v54 offset:8192
  ds_read_b64_tr_b16 v[134:135], v54 offset:8704
  ds_read_b64_tr_b16 v[136:137], v55 offset:0
  ds_read_b64_tr_b16 v[138:139], v55 offset:512
  ds_read_b64_tr_b16 v[140:141], v55 offset:8192
  ds_read_b64_tr_b16 v[142:143], v55 offset:8704
  s_waitcnt vmcnt(32) lgkmcnt(0)
  s_barrier
  s_add_u32 m0, s42, 65536
  s_add_u32 s5, s41, 82944
  buffer_load_dwordx4 v31, s[60:63], s5 offen nt lds
  s_add_u32 m0, s42, 69632
  s_add_u32 s5, s41, 103424
  buffer_load_dwordx4 v31, s[60:63], s5 offen nt lds
  s_add_u32 m0, s42, 73728
  s_add_u32 s5, s41, 123904
  buffer_load_dwordx4 v31, s[60:63], s5 offen nt lds
  s_add_u32 m0, s42, 77824
  s_add_u32 s5, s41, 144384
  buffer_load_dwordx4 v31, s[60:63], s5 offen nt lds
  v_add_u32 v54, 81920, v32
  v_add_u32 v55, 81920, v33
  ds_read_b64_tr_b16 v[144:145], v54 offset:0
  ds_read_b64_tr_b16 v[146:147], v54 offset:512
  ds_read_b64_tr_b16 v[148:149], v54 offset:8192
  ds_read_b64_tr_b16 v[150:151], v54 offset:8704
  ds_read_b64_tr_b16 v[152:153], v55 offset:0
  ds_read_b64_tr_b16 v[154:155], v55 offset:512
  ds_read_b64_tr_b16 v[156:157], v55 offset:8192
  ds_read_b64_tr_b16 v[158:159], v55 offset:8704
  s_waitcnt vmcnt(32) lgkmcnt(0)
  s_barrier
  s_add_u32 m0, s42, 81920
  s_add_u32 s5, s40, 2621440
  buffer_load_dwordx4 v30, s[20:23], s5 offen lds
  s_add_u32 m0, s42, 86016
  s_add_u32 s5, s40, 2752512
  buffer_load_dwordx4 v30, s[20:23], s5 offen lds
  s_add_u32 m0, s42, 90112
  s_add_u32 s5, s40, 2883584
  buffer_load_dwordx4 v30, s[20:23], s5 offen lds
  s_add_u32 m0, s42, 94208
  s_add_u32 s5, s40, 3014656
  buffer_load_dwordx4 v30, s[20:23], s5 offen lds
  v_add_u32 v54, 98304, v32
  v_add_u32 v55, 98304, v33
  ds_read_b64_tr_b16 v[160:161], v54 offset:0
  ds_read_b64_tr_b16 v[162:163], v54 offset:512
  ds_read_b64_tr_b16 v[164:165], v54 offset:8192
  ds_read_b64_tr_b16 v[166:167], v54 offset:8704
  ds_read_b64_tr_b16 v[168:169], v55 offset:0
  ds_read_b64_tr_b16 v[170:171], v55 offset:512
  ds_read_b64_tr_b16 v[172:173], v55 offset:8192
  ds_read_b64_tr_b16 v[174:175], v55 offset:8704
  s_waitcnt vmcnt(32) lgkmcnt(0)
  s_barrier
  s_add_u32 m0, s42, 98304
  s_add_u32 s5, s41, 256
  buffer_load_dwordx4 v31, s[60:63], s5 offen nt lds
  s_add_u32 m0, s42, 102400
  s_add_u32 s5, s41, 20736
  buffer_load_dwordx4 v31, s[60:63], s5 offen nt lds
  s_add_u32 m0, s42, 106496
  s_add_u32 s5, s41, 41216
  buffer_load_dwordx4 v31, s[60:63], s5 offen nt lds
  s_add_u32 m0, s42, 110592
  s_add_u32 s5, s41, 61696
  buffer_load_dwordx4 v31, s[60:63], s5 offen nt lds
  v_add_u32 v54, 114688, v32
  v_add_u32 v55, 114688, v33
  ds_read_b64_tr_b16 v[176:177], v54 offset:0
  ds_read_b64_tr_b16 v[178:179], v54 offset:512
  ds_read_b64_tr_b16 v[180:181], v54 offset:8192
  ds_read_b64_tr_b16 v[182:183], v54 offset:8704
  ds_read_b64_tr_b16 v[184:185], v55 offset:0
  ds_read_b64_tr_b16 v[186:187], v55 offset:512
  ds_read_b64_tr_b16 v[188:189], v55 offset:8192
  ds_read_b64_tr_b16 v[190:191], v55 offset:8704
  s_waitcnt vmcnt(32) lgkmcnt(0)
  s_barrier
  s_add_u32 m0, s42, 114688
  s_add_u32 s5, s41, 82432
  buffer_load_dwordx4 v31, s[60:63], s5 offen nt lds
  s_add_u32 m0, s42, 118784
  s_add_u32 s5, s41, 102912
  buffer_load_dwordx4 v31, s[60:63], s5 offen nt lds
  s_add_u32 m0, s42, 122880
  s_add_u32 s5, s41, 123392
  buffer_load_dwordx4 v31, s[60:63], s5 offen nt lds
  s_add_u32 m0, s42, 126976
  s_add_u32 s5, s41, 143872
  buffer_load_dwordx4 v31, s[60:63], s5 offen nt lds
  v_add_u32 v54, 131072, v34
  v_add_u32 v55, 131072, v35
  ds_read_b64_tr_b16 v[192:193], v54 offset:0
  ds_read_b64_tr_b16 v[194:195], v54 offset:512
  ds_read_b64_tr_b16 v[196:197], v54 offset:8192
  ds_read_b64_tr_b16 v[198:199], v54 offset:8704
  ds_read_b64_tr_b16 v[200:201], v55 offset:0
  ds_read_b64_tr_b16 v[202:203], v55 offset:512
  ds_read_b64_tr_b16 v[204:205], v55 offset:8192
  ds_read_b64_tr_b16 v[206:207], v55 offset:8704
  s_waitcnt vmcnt(32) lgkmcnt(0)
  s_barrier
  s_add_u32 m0, s42, 131072
  s_add_u32 s5, s41, 768
  buffer_load_dwordx4 v31, s[60:63], s5 offen nt lds
  s_add_u32 m0, s42, 135168
  s_add_u32 s5, s41, 21248
  buffer_load_dwordx4 v31, s[60:63], s5 offen nt lds
  s_add_u32 m0, s42, 139264
  s_add_u32 s5, s41, 41728
  buffer_load_dwordx4 v31, s[60:63], s5 offen nt lds
  s_add_u32 m0, s42, 143360
  s_add_u32 s5, s41, 62208
  buffer_load_dwordx4 v31, s[60:63], s5 offen nt lds
  v_add_u32 v54, 147456, v34
  v_add_u32 v55, 147456, v35
  ds_read_b64_tr_b16 v[38:39], v54 offset:0
  ds_read_b64_tr_b16 v[40:41], v54 offset:512
  ds_read_b64_tr_b16 v[42:43], v54 offset:8192
  ds_read_b64_tr_b16 v[44:45], v54 offset:8704
  ds_read_b64_tr_b16 v[46:47], v55 offset:0
  ds_read_b64_tr_b16 v[48:49], v55 offset:512
  ds_read_b64_tr_b16 v[50:51], v55 offset:8192
  ds_read_b64_tr_b16 v[52:53], v55 offset:8704
  s_waitcnt lgkmcnt(0)
  s_add_u32 s5, s39, 8192
  buffer_store_dwordx4 v[38:41], v0, s[8:11], s5 offen
  s_add_u32 s5, s39, 9216
  buffer_store_dwordx4 v[42:45], v0, s[8:11], s5 offen
  s_add_u32 s5, s39, 10240
  buffer_store_dwordx4 v[46:49], v0, s[8:11], s5 offen
  s_add_u32 s5, s39, 11264
  buffer_store_dwordx4 v[50:53], v0, s[8:11], s5 offen
  s_nop 1
  s_waitcnt vmcnt(36) lgkmcnt(0)
  s_barrier
  s_add_u32 m0, s42, 147456
  s_add_u32 s5, s41, 1024
  buffer_load_dwordx4 v31, s[60:63], s5 offen nt lds
  s_add_u32 m0, s42, 151552
  s_add_u32 s5, s41, 21504
  buffer_load_dwordx4 v31, s[60:63], s5 offen nt lds
  s_add_u32 m0, s42, 155648
  s_add_u32 s5, s41, 41984
  buffer_load_dwordx4 v31, s[60:63], s5 offen nt lds
  s_add_u32 m0, s42, 159744
  s_add_u32 s5, s41, 62464
  buffer_load_dwordx4 v31, s[60:63], s5 offen nt lds
  v_add_u32 v54, 16384, v34
  v_add_u32 v55, 16384, v35
  ds_read_b64_tr_b16 v[208:209], v54 offset:0
  ds_read_b64_tr_b16 v[210:211], v54 offset:512
  ds_read_b64_tr_b16 v[212:213], v54 offset:8192
  ds_read_b64_tr_b16 v[214:215], v54 offset:8704
  ds_read_b64_tr_b16 v[216:217], v55 offset:0
  ds_read_b64_tr_b16 v[218:219], v55 offset:512
  ds_read_b64_tr_b16 v[220:221], v55 offset:8192
  ds_read_b64_tr_b16 v[222:223], v55 offset:8704
  s_waitcnt vmcnt(32) lgkmcnt(0)
  s_barrier
  s_add_u32 m0, s42, 16384
  s_add_u32 s5, s40, 524288
  buffer_load_dwordx4 v30, s[20:23], s5 offen lds
  s_add_u32 m0, s42, 20480
  s_add_u32 s5, s40, 655360
  buffer_load_dwordx4 v30, s[20:23], s5 offen lds
  s_add_u32 m0, s42, 24576
  s_add_u32 s5, s40, 786432
  buffer_load_dwordx4 v30, s[20:23], s5 offen lds
  s_add_u32 m0, s42, 28672
  s_add_u32 s5, s40, 917504
  buffer_load_dwordx4 v30, s[20:23], s5 offen lds
  v_add_u32 v54, 32768, v34
  v_add_u32 v55, 32768, v35
  ds_read_b64_tr_b16 v[224:225], v54 offset:0
  ds_read_b64_tr_b16 v[226:227], v54 offset:512
  ds_read_b64_tr_b16 v[228:229], v54 offset:8192
  ds_read_b64_tr_b16 v[230:231], v54 offset:8704
  ds_read_b64_tr_b16 v[232:233], v55 offset:0
  ds_read_b64_tr_b16 v[234:235], v55 offset:512
  ds_read_b64_tr_b16 v[236:237], v55 offset:8192
  ds_read_b64_tr_b16 v[238:239], v55 offset:8704
  s_waitcnt vmcnt(32) lgkmcnt(0)
  s_barrier
  s_add_u32 m0, s42, 32768
  s_add_u32 s5, s40, 1048576
  buffer_load_dwordx4 v30, s[20:23], s5 offen lds
  s_add_u32 m0, s42, 36864
  s_add_u32 s5, s40, 1179648
  buffer_load_dwordx4 v30, s[20:23], s5 offen lds
  s_add_u32 m0, s42, 40960
  s_add_u32 s5, s40, 1310720
  buffer_load_dwordx4 v30, s[20:23], s5 offen lds
  s_add_u32 m0, s42, 45056
  s_add_u32 s5, s40, 1441792
  buffer_load_dwordx4 v30, s[20:23], s5 offen lds
  v_add_u32 v54, 49152, v34
  v_add_u32 v55, 49152, v35
  ds_read_b64_tr_b16 v[240:241], v54 offset:0
  ds_read_b64_tr_b16 v[242:243], v54 offset:512
  ds_read_b64_tr_b16 v[244:245], v54 offset:8192
  ds_read_b64_tr_b16 v[246:247], v54 offset:8704
  ds_read_b64_tr_b16 v[248:249], v55 offset:0
  ds_read_b64_tr_b16 v[250:251], v55 offset:512
  ds_read_b64_tr_b16 v[252:253], v55 offset:8192
  ds_read_b64_tr_b16 v[254:255], v55 offset:8704
  s_waitcnt vmcnt(32) lgkmcnt(0)
  s_barrier
  v_mov_b32 v26, 32
  s_lshl_b32 s4, s26, 2
  v_mov_b32 v27, s4
  global_load_dword v28, v26, s[24:25] sc1
  global_load_dword v29, v27, s[24:25] sc1
  s_add_u32 m0, s42, 49152
  s_add_u32 s5, s40, 1572864
  buffer_load_dwordx4 v30, s[20:23], s5 offen lds
  s_add_u32 m0, s42, 53248
  s_add_u32 s5, s40, 1703936
  buffer_load_dwordx4 v30, s[20:23], s5 offen lds
  s_add_u32 m0, s42, 57344
  s_add_u32 s5, s40, 1835008
  buffer_load_dwordx4 v30, s[20:23], s5 offen lds
  s_add_u32 m0, s42, 61440
  s_add_u32 s5, s40, 1966080
  buffer_load_dwordx4 v30, s[20:23], s5 offen lds
  v_add_u32 v54, 65536, v34
  v_add_u32 v55, 65536, v35
  ds_read_b64_tr_b16 v[38:39], v54 offset:0
  ds_read_b64_tr_b16 v[40:41], v54 offset:512
  ds_read_b64_tr_b16 v[42:43], v54 offset:8192
  ds_read_b64_tr_b16 v[44:45], v54 offset:8704
  ds_read_b64_tr_b16 v[46:47], v55 offset:0
  ds_read_b64_tr_b16 v[48:49], v55 offset:512
  ds_read_b64_tr_b16 v[50:51], v55 offset:8192
  ds_read_b64_tr_b16 v[52:53], v55 offset:8704
  s_waitcnt lgkmcnt(0)
  s_add_u32 s5, s39, 12288
  buffer_store_dwordx4 v[38:41], v0, s[8:11], s5 offen
  s_add_u32 s5, s39, 13312
  buffer_store_dwordx4 v[42:45], v0, s[8:11], s5 offen
  s_add_u32 s5, s39, 14336
  buffer_store_dwordx4 v[46:49], v0, s[8:11], s5 offen
  s_add_u32 s5, s39, 15360
  buffer_store_dwordx4 v[50:53], v0, s[8:11], s5 offen
  s_nop 1
  s_waitcnt vmcnt(38) lgkmcnt(0)
  s_barrier
  s_add_u32 m0, s42, 65536
  s_add_u32 s5, s40, 2097152
  buffer_load_dwordx4 v30, s[20:23], s5 offen lds
  s_add_u32 m0, s42, 69632
  s_add_u32 s5, s40, 2228224
  buffer_load_dwordx4 v30, s[20:23], s5 offen lds
  s_add_u32 m0, s42, 73728
  s_add_u32 s5, s40, 2359296
  buffer_load_dwordx4 v30, s[20:23], s5 offen lds
  s_add_u32 m0, s42, 77824
  s_add_u32 s5, s40, 2490368
  buffer_load_dwordx4 v30, s[20:23], s5 offen lds
  v_add_u32 v54, 81920, v32
  v_add_u32 v55, 81920, v33
  ds_read_b64_tr_b16 v[38:39], v54 offset:0
  ds_read_b64_tr_b16 v[40:41], v54 offset:512
  ds_read_b64_tr_b16 v[42:43], v54 offset:8192
  ds_read_b64_tr_b16 v[44:45], v54 offset:8704
  ds_read_b64_tr_b16 v[46:47], v55 offset:0
  ds_read_b64_tr_b16 v[48:49], v55 offset:512
  ds_read_b64_tr_b16 v[50:51], v55 offset:8192
  ds_read_b64_tr_b16 v[52:53], v55 offset:8704
  s_waitcnt lgkmcnt(0)
  s_barrier
  s_lshl_b32 s4, s28, 12
  v_add_u32 v54, s4, v0
  v_add_u32 v54, 81920, v54
  ds_write_b128 v54, v[38:41] offset:0
  ds_write_b128 v54, v[42:45] offset:1024
  ds_write_b128 v54, v[46:49] offset:2048
  ds_write_b128 v54, v[50:53] offset:3072
  s_waitcnt vmcnt(38) lgkmcnt(0)
  s_barrier
  v_add_u32 v54, 98304, v34
  v_add_u32 v55, 98304, v35
  ds_read_b64_tr_b16 v[38:39], v54 offset:0
  ds_read_b64_tr_b16 v[40:41], v54 offset:512
  ds_read_b64_tr_b16 v[42:43], v54 offset:8192
  ds_read_b64_tr_b16 v[44:45], v54 offset:8704
  ds_read_b64_tr_b16 v[46:47], v55 offset:0
  ds_read_b64_tr_b16 v[48:49], v55 offset:512
  ds_read_b64_tr_b16 v[50:51], v55 offset:8192
  ds_read_b64_tr_b16 v[52:53], v55 offset:8704
  s_waitcnt lgkmcnt(0)
  s_barrier
  s_lshl_b32 s4, s28, 12
  v_add_u32 v54, s4, v0
  v_add_u32 v54, 98304, v54
  ds_write_b128 v54, v[38:41] offset:0
  ds_write_b128 v54, v[42:45] offset:1024
  ds_write_b128 v54, v[46:49] offset:2048
  ds_write_b128 v54, v[50:53] offset:3072
  s_waitcnt vmcnt(34) lgkmcnt(0)
  s_barrier
  v_add_u32 v54, 114688, v34
  v_add_u32 v55, 114688, v35
  ds_read_b64_tr_b16 v[38:39], v54 offset:0
  ds_read_b64_tr_b16 v[40:41], v54 offset:512
  ds_read_b64_tr_b16 v[42:43], v54 offset:8192
  ds_read_b64_tr_b16 v[44:45], v54 offset:8704
  ds_read_b64_tr_b16 v[46:47], v55 offset:0
  ds_read_b64_tr_b16 v[48:49], v55 offset:512
  ds_read_b64_tr_b16 v[50:51], v55 offset:8192
  ds_read_b64_tr_b16 v[52:53], v55 offset:8704
  s_waitcnt lgkmcnt(0)
  s_barrier
  s_lshl_b32 s4, s28, 12
  v_add_u32 v54, s4, v0
  v_add_u32 v54, 114688, v54
  ds_write_b128 v54, v[38:41] offset:0
  ds_write_b128 v54, v[42:45] offset:1024
  ds_write_b128 v54, v[46:49] offset:2048
  ds_write_b128 v54, v[50:53] offset:3072
  s_waitcnt vmcnt(30) lgkmcnt(0)
  s_barrier
  v_add_u32 v54, 131072, v34
  v_add_u32 v55, 131072, v35
  ds_read_b64_tr_b16 v[38:39], v54 offset:0
  ds_read_b64_tr_b16 v[40:41], v54 offset:512
  ds_read_b64_tr_b16 v[42:43], v54 offset:8192
  ds_read_b64_tr_b16 v[44:45], v54 offset:8704
  ds_read_b64_tr_b16 v[46:47], v55 offset:0
  ds_read_b64_tr_b16 v[48:49], v55 offset:512
  ds_read_b64_tr_b16 v[50:51], v55 offset:8192
  ds_read_b64_tr_b16 v[52:53], v55 offset:8704
  s_waitcnt lgkmcnt(0)
  s_barrier
  s_lshl_b32 s4, s28, 12
  v_add_u32 v54, s4, v0
  v_add_u32 v54, 131072, v54
  ds_write_b128 v54, v[38:41] offset:0
  ds_write_b128 v54, v[42:45] offset:1024
  ds_write_b128 v54, v[46:49] offset:2048
  ds_write_b128 v54, v[50:53] offset:3072
  s_waitcnt vmcnt(22) lgkmcnt(0)
  s_barrier
  v_add_u32 v54, 147456, v34
  v_add_u32 v55, 147456, v35
  ds_read_b64_tr_b16 v[38:39], v54 offset:0
  ds_read_b64_tr_b16 v[40:41], v54 offset:512
  ds_read_b64_tr_b16 v[42:43], v54 offset:8192
  ds_read_b64_tr_b16 v[44:45], v54 offset:8704
  ds_read_b64_tr_b16 v[46:47], v55 offset:0
  ds_read_b64_tr_b16 v[48:49], v55 offset:512
  ds_read_b64_tr_b16 v[50:51], v55 offset:8192
  ds_read_b64_tr_b16 v[52:53], v55 offset:8704
  s_waitcnt lgkmcnt(0)
  s_barrier
  s_lshl_b32 s4, s28, 12
  v_add_u32 v54, s4, v0
  v_add_u32 v54, 147456, v54
  ds_write_b128 v54, v[38:41] offset:0
  ds_write_b128 v54, v[42:45] offset:1024
  ds_write_b128 v54, v[46:49] offset:2048
  ds_write_b128 v54, v[50:53] offset:3072
  s_waitcnt vmcnt(18) lgkmcnt(0)
  s_barrier
  v_add_u32 v54, 16384, v32
  v_add_u32 v55, 16384, v33
  ds_read_b64_tr_b16 v[38:39], v54 offset:0
  ds_read_b64_tr_b16 v[40:41], v54 offset:512
  ds_read_b64_tr_b16 v[42:43], v54 offset:8192
  ds_read_b64_tr_b16 v[44:45], v54 offset:8704
  ds_read_b64_tr_b16 v[46:47], v55 offset:0
  ds_read_b64_tr_b16 v[48:49], v55 offset:512
  ds_read_b64_tr_b16 v[50:51], v55 offset:8192
  ds_read_b64_tr_b16 v[52:53], v55 offset:8704
  s_waitcnt lgkmcnt(0)
  s_barrier
  s_lshl_b32 s4, s28, 12
  v_add_u32 v54, s4, v0
  v_add_u32 v54, 16384, v54
  ds_write_b128 v54, v[38:41] offset:0
  ds_write_b128 v54, v[42:45] offset:1024
  ds_write_b128 v54, v[46:49] offset:2048
  ds_write_b128 v54, v[50:53] offset:3072
  s_waitcnt vmcnt(14) lgkmcnt(0)
  s_barrier
  v_add_u32 v54, 32768, v32
  v_add_u32 v55, 32768, v33
  ds_read_b64_tr_b16 v[38:39], v54 offset:0
  ds_read_b64_tr_b16 v[40:41], v54 offset:512
  ds_read_b64_tr_b16 v[42:43], v54 offset:8192
  ds_read_b64_tr_b16 v[44:45], v54 offset:8704
  ds_read_b64_tr_b16 v[46:47], v55 offset:0
  ds_read_b64_tr_b16 v[48:49], v55 offset:512
  ds_read_b64_tr_b16 v[50:51], v55 offset:8192
  ds_read_b64_tr_b16 v[52:53], v55 offset:8704
  s_waitcnt lgkmcnt(0)
  s_barrier
  s_lshl_b32 s4, s28, 12
  v_add_u32 v54, s4, v0
  v_add_u32 v54, 32768, v54
  ds_write_b128 v54, v[38:41] offset:0
  ds_write_b128 v54, v[42:45] offset:1024
  ds_write_b128 v54, v[46:49] offset:2048
  ds_write_b128 v54, v[50:53] offset:3072
  s_waitcnt vmcnt(8) lgkmcnt(0)
  s_barrier
  v_add_u32 v54, 49152, v32
  v_add_u32 v55, 49152, v33
  ds_read_b64_tr_b16 v[38:39], v54 offset:0
  ds_read_b64_tr_b16 v[40:41], v54 offset:512
  ds_read_b64_tr_b16 v[42:43], v54 offset:8192
  ds_read_b64_tr_b16 v[44:45], v54 offset:8704
  ds_read_b64_tr_b16 v[46:47], v55 offset:0
  ds_read_b64_tr_b16 v[48:49], v55 offset:512
  ds_read_b64_tr_b16 v[50:51], v55 offset:8192
  ds_read_b64_tr_b16 v[52:53], v55 offset:8704
  s_waitcnt lgkmcnt(0)
  s_barrier
  s_lshl_b32 s4, s28, 12
  v_add_u32 v54, s4, v0
  v_add_u32 v54, 49152, v54
  ds_write_b128 v54, v[38:41] offset:0
  ds_write_b128 v54, v[42:45] offset:1024
  ds_write_b128 v54, v[46:49] offset:2048
  ds_write_b128 v54, v[50:53] offset:3072
  s_waitcnt vmcnt(0) lgkmcnt(0)
  s_barrier
  v_add_u32 v54, 65536, v32
  v_add_u32 v55, 65536, v33
  ds_read_b64_tr_b16 v[38:39], v54 offset:0
  ds_read_b64_tr_b16 v[40:41], v54 offset:512
  ds_read_b64_tr_b16 v[42:43], v54 offset:8192
  ds_read_b64_tr_b16 v[44:45], v54 offset:8704
  ds_read_b64_tr_b16 v[46:47], v55 offset:0
  ds_read_b64_tr_b16 v[48:49], v55 offset:512
  ds_read_b64_tr_b16 v[50:51], v55 offset:8192
  ds_read_b64_tr_b16 v[52:53], v55 offset:8704
  s_waitcnt lgkmcnt(0)
  s_barrier
  s_lshl_b32 s4, s28, 12
  v_add_u32 v54, s4, v0
  v_add_u32 v54, 65536, v54
  ds_write_b128 v54, v[38:41] offset:0
  ds_write_b128 v54, v[42:45] offset:1024
  ds_write_b128 v54, v[46:49] offset:2048
  ds_write_b128 v54, v[50:53] offset:3072
  s_waitcnt vmcnt(0) lgkmcnt(0)
  s_barrier
  v_readfirstlane_b32 s4, v28
  v_readfirstlane_b32 s98, v29
  s_cmp_ge_u32 s4, 256
  s_cbranch_scc1 CH_INITOK_9
  v_mov_b32 v27, 32
  s_mov_b32 s7, 0
IW_10:
  global_load_dword v26, v27, s[24:25] sc1
  s_add_u32 s7, s7, 1
  s_cmp_gt_u32 s7, 0x400000
  s_cbranch_scc1 IWX_11
  s_waitcnt vmcnt(0)
  v_readfirstlane_b32 s6, v26
  s_nop 0
  s_cmp_ge_u32 s6, 256
  s_cbranch_scc1 IWX_11
  s_sleep 2
  s_branch IW_10
IWX_11:
  s_waitcnt vmcnt(0)
  s_lshl_b32 s4, s26, 2
  v_mov_b32 v27, s4
  global_load_dword v29, v27, s[24:25] sc1
  s_waitcnt vmcnt(0)
  v_readfirstlane_b32 s98, v29
CH_INITOK_9:
  s_nop 0
  s_mov_b32 s99, s98
  v_and_b32 v8, 15, v7
  v_lshrrev_b32 v9, 4, v7
  v_and_b32 v10, 1, v7
  v_cmp_ne_u32 vcc, 0, v10
  v_mov_b32 v11, 0x44444444
  v_mov_b32 v2, 0xeeeeeeee
  v_cndmask_b32 v2, v11, v2, vcc
  s_lshl_b32 s4, s28, 12
  s_add_u32 s4, s4, 16384
  v_add_u32 v1, s4, v0
  s_lshl_b32 s4, s28, 10
  v_lshlrev_b32 v10, 5, v8
  v_lshl_add_u32 v10, v9, 3, v10
  v_add_u32 v3, s4, v10
  v_bfe_u32 v10, v7, 2, 2
  v_lshl_add_u32 v10, v9, 3, v10
  v_lshlrev_b32 v10, 5, v10
  v_and_b32 v11, 3, v7
  v_lshl_add_u32 v10, v11, 3, v10
  v_add_u32 v4, s4, v10
  v_lshrrev_b32 v10, 2, v8
  v_lshlrev_b32 v10, 1, v10
  v_and_b32 v11, 1, v8
  v_or_b32 v10, v10, v11
  v_lshlrev_b32 v10, 1, v10
  v_lshrrev_b32 v11, 1, v9
  v_or_b32 v10, v10, v11
  v_lshlrev_b32 v10, 4, v10
  v_and_b32 v11, 1, v9
  v_lshl_add_u32 v10, v11, 3, v10
  s_lshr_b32 s4, s28, 1
  s_lshl_b32 s4, s4, 10
  s_and_b32 s5, s28, 1
  s_lshl_b32 s5, s5, 9
  s_add_u32 s4, s4, s5
  v_add_u32 v5, s4, v10
  v_lshrrev_b32 v10, 2, v8
  v_lshlrev_b32 v10, 13, v10
  v_and_b32 v11, 3, v8
  v_lshl_add_u32 v11, v9, 2, v11
  v_lshl_add_u32 v6, v11, 4, v10
  s_mov_b32 s50, 0x3e0293ee
  s_lshl_b32 s4, s28, 15
  s_lshl_b32 s5, s27, 8
  s_add_u32 s54, s4, s5
  s_lshl_b32 s4, s28, 14
  s_lshl_b32 s5, s27, 7
  s_add_u32 s55, s4, s5
  s_add_u32 s55, s55, 262144
  s_cmp_eq_u32 s51, 2
  s_cselect_b64 s[90:91], s[48:49], s[46:47]
  s_cmp_eq_u32 s51, 0
  s_cselect_b64 s[90:91], 0, s[90:91]
  s_cmp_lt_u32 s27, 16
  s_cselect_b64 s[92:93], -1, 0
  s_cmp_eq_u32 s28, 3
  s_cselect_b64 s[94:95], 1, 0
  s_mov_b32 s17, 0
  v_bfe_u32 v14, v7, 1, 3
  v_cmp_eq_u32 s[20:21], 0, v14
  v_cmp_eq_u32 s[22:23], 1, v14
  v_cmp_eq_u32 s[40:41], 2, v14
  v_cmp_eq_u32 s[42:43], 3, v14
  s_lshl_b32 s4, s27, 13
  s_lshl_b32 s5, s28, 11
  s_add_u32 s89, s4, s5
  s_lshl_b32 s4, s27, 12
  s_lshl_b32 s5, s28, 10
  s_add_u32 s4, s4, s5
  s_add_u32 s96, s4, 262144
  s_lshl_b32 s4, s28, 11
  s_add_u32 s97, s4, 524288
  s_mov_b32 s18, -1
  s_mov_b32 s19, 0
  s_lshl_b32 s4, s26, 11
  s_add_u32 s4, s4, s27
  s_lshl_b32 s33, s4, 14
  s_lshl_b32 s5, s28, 11
  s_add_u32 s33, s33, s5
  s_lshl_b32 s34, s4, 12
  s_lshl_b32 s5, s28, 10
  s_add_u32 s34, s34, s5
  s_add_u32 s34, s34, 67108864
  s_mov_b32 s32, 0
  s_mov_b32 s62, 0
  s_lshl_b32 s4, s28, 10
  s_add_u32 s63, s4, 12288
  s_mov_b32 s35, s56
  s_add_u32 s36, s56, 393216
  s_add_u32 s37, s57, 16384
  s_mov_b32 s38, s57
  s_mov_b32 s88, s57
  s_add_u32 s12, s39, 4096
  s_add_u32 s13, s39, 8192
  s_add_u32 s14, s39, 12288
  s_add_u32 s15, s33, 8192
  s_add_u32 s5, s39, 0
  buffer_load_dwordx4 v[48:51], v0, s[8:11], s5 offen
  buffer_load_dwordx4 v[52:55], v0, s[8:11], s5 offen offset:1024
  s_waitcnt vmcnt(0)
  s_mov_b32 s61, 1
  s_mov_b32 s7, 0
  v_mov_b32 v9, 0
CH_KV0_13:
  buffer_load_dword v8, v9, s[8:11], s59 offen sc1
  s_add_u32 s7, s7, 1
  s_cmp_gt_u32 s7, 0x40000
  s_cbranch_scc1 CH_KV0X_14
  s_waitcnt vmcnt(0)
  v_readfirstlane_b32 s6, v8
  s_nop 0
  s_cmp_ge_u32 s6, s61
  s_cbranch_scc1 CH_KV0X_14
  s_sleep 1
  s_branch CH_KV0_13
CH_KV0X_14:
  s_waitcnt vmcnt(0)
  s_mov_b32 s62, s6
  s_mov_b32 s60, s99
  s_cmp_lt_u32 s60, 32
  s_cbranch_scc1 CH_SAFE_15
CH_LOOP_16:
  ds_read_b128 v[28:31], v0 offset:6144
  ds_read_b128 v[32:35], v0 offset:7168
  v_mov_b64 v[8:9], 0
  v_mov_b64 v[10:11], 0
  v_mov_b64 v[12:13], 0
  v_mov_b64 v[14:15], 0
  v_mov_b64 v[16:17], 0
  v_mov_b64 v[18:19], 0
  v_mov_b64 v[24:25], 0
  v_mov_b64 v[26:27], 0
  ds_read_b128 v[20:23], v0 offset:8192
  s_waitcnt lgkmcnt(2)
  v_smfmac_f32_16x16x64_bf16 v[16:19], v[28:31], a[144:151], v2
  v_smfmac_f32_16x16x64_bf16 v[24:27], v[28:31], a[152:159], v2
  buffer_load_dwordx4 v[56:59], v0, s[8:11], s39 offen offset:2048
  v_smfmac_f32_16x16x64_bf16 v[8:11], v[28:31], a[0:7], v2
  v_smfmac_f32_16x16x64_bf16 v[12:15], v[28:31], a[8:15], v2
  ds_read_b128 v[28:31], v0 offset:9216
  s_waitcnt lgkmcnt(2)
  v_smfmac_f32_16x16x64_bf16 v[16:19], v[32:35], a[160:167], v2
  v_smfmac_f32_16x16x64_bf16 v[24:27], v[32:35], a[168:175], v2
  buffer_load_dwordx4 v[60:63], v0, s[8:11], s39 offen offset:3072
  v_smfmac_f32_16x16x64_bf16 v[8:11], v[32:35], a[16:23], v2
  v_smfmac_f32_16x16x64_bf16 v[12:15], v[32:35], a[24:31], v2
  ds_read_b128 v[32:35], v0 offset:10240
  s_waitcnt lgkmcnt(2)
  v_smfmac_f32_16x16x64_bf16 v[16:19], v[20:23], a[176:183], v2
  v_smfmac_f32_16x16x64_bf16 v[24:27], v[20:23], a[184:191], v2
  buffer_load_dwordx4 v[64:67], v0, s[8:11], s12 offen offset:0
  v_smfmac_f32_16x16x64_bf16 v[8:11], v[20:23], a[32:39], v2
  v_smfmac_f32_16x16x64_bf16 v[12:15], v[20:23], a[40:47], v2
  ds_read_b128 v[20:23], v0 offset:11264
  s_waitcnt lgkmcnt(2)
  v_smfmac_f32_16x16x64_bf16 v[16:19], v[28:31], a[192:199], v2
  v_smfmac_f32_16x16x64_bf16 v[24:27], v[28:31], a[200:207], v2
  buffer_load_dwordx4 v[68:71], v0, s[8:11], s12 offen offset:1024
  v_smfmac_f32_16x16x64_bf16 v[8:11], v[28:31], a[48:55], v2
  v_smfmac_f32_16x16x64_bf16 v[12:15], v[28:31], a[56:63], v2
  ds_read_b128 v[28:31], v0 offset:12288
  s_waitcnt lgkmcnt(2)
  v_smfmac_f32_16x16x64_bf16 v[16:19], v[32:35], a[208:215], v2
  v_smfmac_f32_16x16x64_bf16 v[24:27], v[32:35], a[216:223], v2
  buffer_load_dwordx4 v[72:75], v0, s[8:11], s12 offen offset:2048
  v_smfmac_f32_16x16x64_bf16 v[8:11], v[32:35], a[64:71], v2
  v_smfmac_f32_16x16x64_bf16 v[12:15], v[32:35], a[72:79], v2
  ds_read_b128 v[32:35], v0 offset:13312
  s_waitcnt lgkmcnt(2)
  v_smfmac_f32_16x16x64_bf16 v[16:19], v[20:23], a[224:231], v2
  v_smfmac_f32_16x16x64_bf16 v[24:27], v[20:23], a[232:239], v2
  buffer_load_dwordx4 v[76:79], v0, s[8:11], s12 offen offset:3072
  v_smfmac_f32_16x16x64_bf16 v[8:11], v[20:23], a[80:87], v2
  v_smfmac_f32_16x16x64_bf16 v[12:15], v[20:23], a[88:95], v2
  ds_read_b128 v[20:23], v0 offset:14336
  s_waitcnt lgkmcnt(2)
  v_smfmac_f32_16x16x64_bf16 v[16:19], v[28:31], a[240:247], v2
  v_smfmac_f32_16x16x64_bf16 v[24:27], v[28:31], a[248:255], v2
  v_smfmac_f32_16x16x64_bf16 v[8:11], v[28:31], a[96:103], v2
  v_smfmac_f32_16x16x64_bf16 v[12:15], v[28:31], a[104:111], v2
  ds_read_b128 v[28:31], v0 offset:15360
  s_waitcnt lgkmcnt(2)
  v_smfmac_f32_16x16x64_bf16 v[16:19], v[32:35], v[80:87], v2
  v_smfmac_f32_16x16x64_bf16 v[24:27], v[32:35], v[88:95], v2
  buffer_load_dwordx4 v[36:39], v0, s[8:11], s33 offen offset:0 nt
  v_smfmac_f32_16x16x64_bf16 v[8:11], v[32:35], a[112:119], v2
  v_smfmac_f32_16x16x64_bf16 v[12:15], v[32:35], a[120:127], v2
  s_waitcnt lgkmcnt(1)
  v_smfmac_f32_16x16x64_bf16 v[16:19], v[20:23], v[96:103], v2
  v_smfmac_f32_16x16x64_bf16 v[24:27], v[20:23], v[104:111], v2
  buffer_load_dwordx4 v[40:43], v0, s[8:11], s33 offen offset:1024 nt
  v_smfmac_f32_16x16x64_bf16 v[8:11], v[20:23], a[128:135], v2
  v_smfmac_f32_16x16x64_bf16 v[12:15], v[20:23], a[136:143], v2
  s_waitcnt vmcnt(8) lgkmcnt(0)
  v_smfmac_f32_16x16x64_bf16 v[16:19], v[28:31], v[48:55], v2
  s_waitcnt vmcnt(6)
  v_smfmac_f32_16x16x64_bf16 v[24:27], v[28:31], v[56:63], v2
  v_mov_b64 v[48:49], 0
  v_mov_b64 v[50:51], 0
  v_mov_b64 v[52:53], 0
  v_mov_b64 v[54:55], 0
  buffer_load_dwordx4 v[56:59], v0, s[8:11], s15 offen nt
  s_waitcnt vmcnt(5)
  v_smfmac_f32_16x16x64_bf16 v[8:11], v[28:31], v[64:71], v2
  s_waitcnt vmcnt(3)
  v_smfmac_f32_16x16x64_bf16 v[12:15], v[28:31], v[72:79], v2
  v_smfmac_f32_16x16x64_bf16 v[48:51], v[28:31], v[176:183], v2
  v_smfmac_f32_16x16x64_bf16 v[52:55], v[28:31], v[184:191], v2
  ds_read_b128 v[28:31], v0 offset:12288
  v_add_f32 v16, v16, v17
  v_add_f32 v18, v18, v19
  v_cvt_pk_bf16_f32 v64, v16, v18
  v_add_f32 v24, v24, v25
  v_add_f32 v26, v26, v27
  v_cvt_pk_bf16_f32 v66, v24, v26
  buffer_load_dwordx4 v[60:63], v0, s[8:11], s15 offen offset:1024 nt
  v_smfmac_f32_16x16x64_bf16 v[48:51], v[20:23], v[160:167], v2
  v_smfmac_f32_16x16x64_bf16 v[52:55], v[20:23], v[168:175], v2
  ds_read_b128 v[20:23], v0 offset:6144
  v_add_f32 v8, v8, v9
  v_add_f32 v10, v10, v11
  v_cvt_pk_bf16_f32 v65, v8, v10
  ds_write_b64 v3, v[64:65] offset:0
  v_add_f32 v12, v12, v13
  v_add_f32 v14, v14, v15
  v_cvt_pk_bf16_f32 v67, v12, v14
  ds_write_b64 v3, v[66:67] offset:512
  v_lshlrev_b32 v77, 3, v0
  s_add_u32 s5, s33, s97
  s_add_u32 s6, s32, 2
  s_cmp_ge_u32 s62, s6
  s_cselect_b64 exec, s[18:19], 0
  buffer_load_dword v76, v77, s[8:11], s5 offen
  s_mov_b64 exec, -1
  v_smfmac_f32_16x16x64_bf16 v[48:51], v[32:35], v[144:151], v2
  v_smfmac_f32_16x16x64_bf16 v[52:55], v[32:35], v[152:159], v2
  ds_read_b128 v[32:35], v0 offset:7168
  v_mov_b32 v68, v64
  v_mov_b32 v70, v66
  buffer_load_dword v77, off, s[8:11], s59 sc1
  s_waitcnt lgkmcnt(1)
  s_barrier
  ds_read_b64_tr_b16 v[8:9], v4 offset:0
  ds_read_b64_tr_b16 v[10:11], v4 offset:128
  v_xor_b32 v69, 1024, v4
  ds_read_b64_tr_b16 v[12:13], v69 offset:0
  ds_read_b64_tr_b16 v[14:15], v69 offset:128
  v_xor_b32 v69, 2048, v4
  ds_read_b64_tr_b16 v[16:17], v69 offset:0
  ds_read_b64_tr_b16 v[18:19], v69 offset:128
  s_sub_u32 s5, s34, 131072
  s_cmp_lg_u32 s32, 0
  s_cselect_b64 exec, -1, 0
  buffer_store_dwordx4 v[44:47], v0, s[8:11], s5 offen sc1
  s_mov_b64 exec, -1
  v_xor_b32 v69, 3072, v4
  ds_read_b64_tr_b16 v[64:65], v69 offset:0
  ds_read_b64_tr_b16 v[66:67], v69 offset:128
  v_smfmac_f32_16x16x64_bf16 v[48:51], v[28:31], v[128:135], v2
  v_smfmac_f32_16x16x64_bf16 v[52:55], v[28:31], v[136:143], v2
  ds_read_b128 v[28:31], v0 offset:8192
  s_sub_u32 s6, s32, 1
  s_max_i32 s6, s6, 0
  v_mov_b32 v69, s6
  s_cmp_le_u32 s32, 60
  s_cselect_b64 exec, s[94:95], 0
  buffer_store_dword v69, v0, s[8:11], s58 offen sc1
  s_mov_b64 exec, -1
  s_waitcnt vmcnt(7) lgkmcnt(7)
  v_mfma_f32_16x16x32_bf16 v[24:27], v[36:39], v[8:11], 0
  s_waitcnt vmcnt(6)
  v_mfma_f32_16x16x32_bf16 v[44:47], v[40:43], v[8:11], 0
  v_mfma_f32_16x16x32_bf16 v[72:75], v[8:11], v[8:11], 0
  s_waitcnt lgkmcnt(5)
  v_mfma_f32_16x16x32_bf16 v[72:75], v[12:15], v[12:15], v[72:75]
  s_waitcnt lgkmcnt(3)
  v_mfma_f32_16x16x32_bf16 v[72:75], v[16:19], v[16:19], v[72:75]
  s_waitcnt lgkmcnt(1)
  v_mfma_f32_16x16x32_bf16 v[72:75], v[64:67], v[64:67], v[72:75]
  v_smfmac_f32_16x16x64_bf16 v[48:51], v[20:23], v[112:119], v2
  v_smfmac_f32_16x16x64_bf16 v[52:55], v[20:23], v[120:127], v2
  ds_read_b128 v[8:11], v1 offset:0
  ds_read_b128 v[12:15], v1 offset:1024
  ds_read_b128 v[16:19], v1 offset:2048
  ds_read_b128 v[20:23], v1 offset:3072
  s_mov_b64 vcc, s[44:45]
  v_add_u32 v69, s63, v0
  v_cndmask_b32_dpp v24, v44, v24, vcc quad_perm:[2,3,2,3] row_mask:0xf bank_mask:0xf
  v_cndmask_b32_dpp v25, v45, v25, vcc quad_perm:[2,3,2,3] row_mask:0xf bank_mask:0xf
  v_cndmask_b32_dpp v26, v46, v26, vcc quad_perm:[2,3,2,3] row_mask:0xf bank_mask:0xf
  v_cndmask_b32_dpp v27, v47, v27, vcc quad_perm:[2,3,2,3] row_mask:0xf bank_mask:0xf
  ds_write_b128 v69, v[24:27]
  s_waitcnt lgkmcnt(3)
  v_smfmac_f32_16x16x64_bf16 v[48:51], v[32:35], v[8:15], v2
  ds_read_b128 v[8:11], v1 offset:16384
  ds_read_b128 v[12:15], v1 offset:17408
  s_waitcnt lgkmcnt(3)
  v_smfmac_f32_16x16x64_bf16 v[52:55], v[32:35], v[16:23], v2
  ds_read_b128 v[16:19], v1 offset:18432
  ds_read_b128 v[20:23], v1 offset:19456
  ds_read_b128 v[32:35], v0 offset:9216
  s_waitcnt lgkmcnt(5)
  s_barrier
  v_xor_b32 v44, 1024, v69
  ds_read_b128 v[44:47], v44
  v_xor_b32 v36, 2048, v69
  ds_read_b128 v[36:39], v36
  v_xor_b32 v40, 3072, v69
  ds_read_b128 v[40:43], v40
  v_mov_b32 v75, 0xff800000
  v_cndmask_b32 v72, v75, v72, vcc
  v_cndmask_b32 v73, v75, v73, vcc
  v_max_f32 v74, v72, v73
  s_waitcnt lgkmcnt(6)
  v_smfmac_f32_16x16x64_bf16 v[48:51], v[28:31], v[8:15], v2
  ds_read_b128 v[8:11], v1 offset:32768
  ds_read_b128 v[12:15], v1 offset:33792
  s_waitcnt lgkmcnt(6)
  v_smfmac_f32_16x16x64_bf16 v[52:55], v[28:31], v[16:23], v2
  ds_read_b128 v[16:19], v1 offset:34816
  ds_read_b128 v[20:23], v1 offset:35840
  ds_read_b128 v[28:31], v0 offset:10240
  s_waitcnt lgkmcnt(7)
  v_pk_add_f32 v[24:25], v[24:25], v[44:45]
  v_pk_add_f32 v[26:27], v[26:27], v[46:47]
  s_waitcnt lgkmcnt(5)
  v_pk_add_f32 v[36:37], v[36:37], v[40:41]
  v_pk_add_f32 v[38:39], v[38:39], v[42:43]
  v_pk_add_f32 v[24:25], v[24:25], v[36:37]
  v_pk_add_f32 v[26:27], v[26:27], v[38:39]
  v_max3_f32 v74, v74, v24, v25
  v_max3_f32 v74, v74, v26, v27
  s_waitcnt lgkmcnt(3)
  v_smfmac_f32_16x16x64_bf16 v[48:51], v[32:35], v[8:15], v2
  ds_read_b128 v[8:11], v1 offset:49152
  ds_read_b128 v[12:15], v1 offset:50176
  s_waitcnt lgkmcnt(3)
  v_smfmac_f32_16x16x64_bf16 v[52:55], v[32:35], v[16:23], v2
  ds_read_b128 v[16:19], v1 offset:51200
  ds_read_b128 v[20:23], v1 offset:52224
  ds_read_b128 v[32:35], v0 offset:11264
  v_max_f32_dpp v74, v74, v74 quad_perm:[2,3,0,1] row_mask:0xf bank_mask:0xf
  v_mov_b32 v75, v74
  s_nop 1
  v_permlane16_swap_b32 v74, v75
  v_max_f32 v74, v74, v75
  v_mov_b32 v75, v74
  s_waitcnt lgkmcnt(3)
  v_smfmac_f32_16x16x64_bf16 v[48:51], v[28:31], v[8:15], v2
  v_add_u32 v36, 65536, v1
  ds_read_b128 v[8:11], v36 offset:0
  ds_read_b128 v[12:15], v36 offset:1024
  v_permlane32_swap_b32 v74, v75
  v_max_f32 v74, v74, v75
  v_mul_f32 v74, s50, v74
  s_waitcnt lgkmcnt(3)
  v_smfmac_f32_16x16x64_bf16 v[52:55], v[28:31], v[16:23], v2
  ds_read_b128 v[16:19], v36 offset:2048
  ds_read_b128 v[20:23], v36 offset:3072
  v_fma_f32 v24, v24, s50, -v74
  v_fma_f32 v25, v25, s50, -v74
  v_fma_f32 v26, v26, s50, -v74
  v_fma_f32 v27, v27, s50, -v74
  v_fma_f32 v72, v72, s50, -v74
  v_fma_f32 v73, v73, s50, -v74
  v_exp_f32 v24, v24
  v_exp_f32 v25, v25
  v_exp_f32 v26, v26
  v_exp_f32 v27, v27
  v_exp_f32 v72, v72
  v_exp_f32 v73, v73
  s_waitcnt lgkmcnt(2)
  v_smfmac_f32_16x16x64_bf16 v[48:51], v[32:35], v[8:15], v2
  s_waitcnt lgkmcnt(0)
  v_smfmac_f32_16x16x64_bf16 v[52:55], v[32:35], v[16:23], v2
  buffer_load_dwordx4 v[8:11], v0, s[8:11], s13 offen offset:0
  v_cvt_pk_bf16_f32 v28, v24, v25
  v_cvt_pk_bf16_f32 v29, v26, v27
  v_mov_b32 v64, 0
  v_cvt_pk_bf16_f32 v65, v72, v73
  v_mov_b32_dpp v30, v28 quad_perm:[0,1,0,1] row_mask:0xf bank_mask:0xf
  v_mov_b32_dpp v31, v29 quad_perm:[0,1,0,1] row_mask:0xf bank_mask:0xf
  v_mov_b32 v40, 0x3f803f80
  v_mov_b32 v41, 0x3f803f80
  v_mov_b32 v42, 0x3f803f80
  v_mov_b32 v43, 0x3f803f80
  buffer_load_dwordx4 v[12:15], v0, s[8:11], s13 offen offset:1024
  s_waitcnt vmcnt(7)
  v_mfma_f32_16x16x32_bf16 v[32:35], v[56:59], v[28:31], 0
  s_waitcnt vmcnt(6)
  v_mfma_f32_16x16x32_bf16 v[36:39], v[60:63], v[28:31], 0
  v_mfma_f32_16x16x32_bf16 v[44:47], v[40:43], v[28:31], 0
  v_add_f32 v48, v48, v49
  v_add_f32 v50, v50, v51
  v_cvt_pk_bf16_f32 v69, v48, v50
  v_add_f32 v52, v52, v53
  v_add_f32 v54, v54, v55
  v_cvt_pk_bf16_f32 v71, v52, v54
  v_mfma_f32_16x16x16_bf16 v[44:47], v[40:41], v[64:65], v[44:47]
  buffer_load_dwordx4 v[16:19], v0, s[8:11], s13 offen offset:2048
  v_mfma_f32_16x16x16_bf16 v[32:35], v[68:69], v[64:65], v[32:35]
  v_mfma_f32_16x16x16_bf16 v[36:39], v[70:71], v[64:65], v[36:39]
  s_cmp_lt_u32 s32, 60
  s_cbranch_scc1 CH_CONT_17
  buffer_store_dwordx4 v[68:71], v0, s[8:11], s34 offen sc1
  s_waitcnt vmcnt(0)
  s_barrier
  s_add_u32 s6, s32, 1
  v_mov_b32 v40, s6
  v_mov_b32 v41, 0
  s_mov_b64 exec, 1
  buffer_store_dword v40, v41, s[8:11], s58 offen sc1
  s_mov_b64 exec, -1
  s_cmp_lt_u32 s32, 63
  s_cbranch_scc1 CH_CONT_17
  s_waitcnt vmcnt(0)
  s_branch CH_END_12
CH_CONT_17:
  buffer_load_dwordx4 v[20:23], v0, s[8:11], s13 offen offset:3072
  s_nop 1
  v_rcp_f32 v44, v44
  buffer_load_dwordx4 v[56:59], v0, s[8:11], s14 offen offset:0
  v_pk_mul_f32 v[32:33], v[32:33], v[44:45] op_sel_hi:[1,0]
  v_pk_mul_f32 v[34:35], v[34:35], v[44:45] op_sel_hi:[1,0]
  v_cvt_pk_bf16_f32 v28, v32, v33
  v_cvt_pk_bf16_f32 v29, v34, v35
  v_pk_mul_f32 v[36:37], v[36:37], v[44:45] op_sel_hi:[1,0]
  v_pk_mul_f32 v[38:39], v[38:39], v[44:45] op_sel_hi:[1,0]
  v_cvt_pk_bf16_f32 v30, v36, v37
  v_cvt_pk_bf16_f32 v31, v38, v39
  s_mov_b64 exec, s[44:45]
  ds_write_b64 v5, v[28:29] offset:0
  ds_write_b64 v5, v[30:31] offset:256
  s_mov_b64 exec, -1
  buffer_load_dwordx4 v[60:63], v0, s[8:11], s14 offen offset:1024
  v_add_u32 v78, 81920, v1
  ds_read_b128 v[32:35], v78 offset:0
  ds_read_b128 v[36:39], v78 offset:1024
  ds_read_b128 v[48:51], v78 offset:2048
  ds_read_b128 v[52:55], v78 offset:3072
  v_mov_b64 v[64:65], 0
  v_mov_b64 v[66:67], 0
  v_mov_b64 v[72:73], 0
  v_mov_b64 v[74:75], 0
  s_waitcnt lgkmcnt(4)
  s_barrier
  ds_read_b128 v[40:43], v0 offset:0
  ds_read_b128 v[44:47], v0 offset:1024
  s_waitcnt vmcnt(8)
  v_readfirstlane_b32 s6, v77
  s_nop 0
  s_max_u32 s62, s62, s6
  s_waitcnt lgkmcnt(1)
  v_smfmac_f32_16x16x64_bf16 v[64:67], v[40:43], v[192:199], v2
  s_waitcnt vmcnt(4) lgkmcnt(0)
  v_smfmac_f32_16x16x64_bf16 v[64:67], v[44:47], v[8:15], v2
  buffer_load_dwordx4 v[24:27], v0, s[8:11], s14 offen offset:2048
  v_mov_b64 v[8:9], 0
  v_mov_b64 v[10:11], 0
  v_mov_b64 v[12:13], 0
  v_mov_b64 v[14:15], 0
  v_smfmac_f32_16x16x64_bf16 v[72:75], v[40:43], v[200:207], v2
  s_waitcnt vmcnt(3)
  v_smfmac_f32_16x16x64_bf16 v[72:75], v[44:47], v[16:23], v2
  buffer_load_dwordx4 v[28:31], v0, s[8:11], s14 offen offset:3072
  v_mov_b64 v[16:17], 0
  v_mov_b64 v[18:19], 0
  v_smfmac_f32_16x16x64_bf16 v[8:11], v[40:43], v[32:39], v2
  ds_read_b128 v[32:35], v78 offset:16384
  ds_read_b128 v[36:39], v78 offset:17408
  v_smfmac_f32_16x16x64_bf16 v[8:11], v[44:47], v[208:215], v2
  v_add_f32 v64, v64, v65
  v_add_f32 v66, v66, v67
  v_cvt_pk_bf16_f32 v64, v64, v66
  v_bfi_b32 v64, 1, s17, v64
  v_mov_b64 v[20:21], 0
  v_mov_b64 v[22:23], 0
  v_smfmac_f32_16x16x64_bf16 v[12:15], v[40:43], v[48:55], v2
  ds_read_b128 v[48:51], v78 offset:18432
  ds_read_b128 v[52:55], v78 offset:19456
  v_smfmac_f32_16x16x64_bf16 v[12:15], v[44:47], v[216:223], v2
  v_add_f32 v72, v72, v73
  v_add_f32 v74, v74, v75
  v_cvt_pk_bf16_f32 v65, v72, v74
  v_bfi_b32 v65, 1, s17, v65
  v_mov_b64 v[72:73], 0
  v_mov_b64 v[74:75], 0
  v_smfmac_f32_16x16x64_bf16 v[16:19], v[40:43], v[224:231], v2
  s_waitcnt lgkmcnt(2)
  v_smfmac_f32_16x16x64_bf16 v[16:19], v[44:47], v[32:39], v2
  ds_read_b128 v[32:35], v78 offset:32768
  ds_read_b128 v[36:39], v78 offset:33792
  v_add_f32 v8, v8, v9
  v_add_f32 v10, v10, v11
  v_cvt_pk_bf16_f32 v66, v8, v10
  v_bfi_b32 v66, 1, s17, v66
  v_mov_b64 v[8:9], 0
  v_mov_b64 v[10:11], 0
  v_smfmac_f32_16x16x64_bf16 v[20:23], v[40:43], v[232:239], v2
  s_waitcnt lgkmcnt(2)
  v_smfmac_f32_16x16x64_bf16 v[20:23], v[44:47], v[48:55], v2
  ds_read_b128 v[48:51], v78 offset:34816
  ds_read_b128 v[52:55], v78 offset:35840
  v_add_f32 v12, v12, v13
  v_add_f32 v14, v14, v15
  v_cvt_pk_bf16_f32 v67, v12, v14
  v_bfi_b32 v67, 1, s17, v67
  s_add_u32 s5, s35, s54
  buffer_store_dwordx4 v[64:67], v6, s[8:11], s5 offen
  v_mov_b64 v[12:13], 0
  v_mov_b64 v[14:15], 0
  s_waitcnt lgkmcnt(2)
  v_smfmac_f32_16x16x64_bf16 v[72:75], v[40:43], v[32:39], v2
  ds_read_b128 v[32:35], v78 offset:49152
  ds_read_b128 v[36:39], v78 offset:50176
  v_smfmac_f32_16x16x64_bf16 v[72:75], v[44:47], v[240:247], v2
  v_add_f32 v16, v16, v17
  v_add_f32 v18, v18, v19
  v_cvt_pk_bf16_f32 v16, v16, v18
  v_bfi_b32 v16, 1, s17, v16
  v_mov_b64 v[64:65], 0
  v_mov_b64 v[66:67], 0
  s_waitcnt lgkmcnt(2)
  v_smfmac_f32_16x16x64_bf16 v[8:11], v[40:43], v[48:55], v2
  ds_read_b128 v[48:51], v78 offset:51200
  ds_read_b128 v[52:55], v78 offset:52224
  v_smfmac_f32_16x16x64_bf16 v[8:11], v[44:47], v[248:255], v2
  v_add_f32 v20, v20, v21
  v_add_f32 v22, v22, v23
  v_cvt_pk_bf16_f32 v17, v20, v22
  v_bfi_b32 v17, 1, s17, v17
  s_waitcnt lgkmcnt(2)
  v_smfmac_f32_16x16x64_bf16 v[12:15], v[40:43], v[32:39], v2
  s_waitcnt vmcnt(3)
  v_smfmac_f32_16x16x64_bf16 v[12:15], v[44:47], v[56:63], v2
  v_add_f32 v72, v72, v73
  v_add_f32 v74, v74, v75
  v_cvt_pk_bf16_f32 v18, v72, v74
  v_bfi_b32 v18, 1, s17, v18
  s_waitcnt lgkmcnt(0)
  v_smfmac_f32_16x16x64_bf16 v[64:67], v[40:43], v[48:55], v2
  s_waitcnt vmcnt(1)
  v_smfmac_f32_16x16x64_bf16 v[64:67], v[44:47], v[24:31], v2
  v_add_f32 v8, v8, v9
  v_add_f32 v10, v10, v11
  v_cvt_pk_bf16_f32 v19, v8, v10
  v_bfi_b32 v19, 1, s17, v19
  s_add_u32 s5, s35, s54
  s_add_u32 s5, s5, 131072
  buffer_store_dwordx4 v[16:19], v6, s[8:11], s5 offen
  v_add_f32 v12, v12, v13
  v_add_f32 v14, v14, v15
  v_cvt_pk_bf16_f32 v12, v12, v14
  v_bfi_b32 v12, 1, s17, v12
  v_add_f32 v64, v64, v65
  v_add_f32 v66, v66, v67
  v_cvt_pk_bf16_f32 v13, v64, v66
  v_bfi_b32 v13, 1, s17, v13
  v_lshrrev_b32 v8, 1, v6
  s_add_u32 s5, s35, s55
  buffer_store_dwordx2 v[12:13], v8, s[8:11], s5 offen
  v_mov_b32 v44, v68
  v_mov_b32 v45, v69
  v_mov_b32 v46, v70
  v_mov_b32 v47, v71
  s_cmp_lg_u32 s28, 3
  s_cbranch_scc1 HP_SEEN_20
  s_add_u32 s61, s32, 2
  s_min_u32 s61, s61, 64
  s_cmp_ge_u32 s62, s61
  s_cbranch_scc1 HP_SEEN_20
  s_mov_b32 s7, 0
  v_mov_b32 v9, 0
CH_KV_21:
  buffer_load_dword v8, v9, s[8:11], s59 offen sc1
  s_add_u32 s7, s7, 1
  s_cmp_gt_u32 s7, 0x40000
  s_cbranch_scc1 CH_KVX_22
  s_waitcnt vmcnt(0)
  v_readfirstlane_b32 s6, v8
  s_nop 0
  s_cmp_ge_u32 s6, s61
  s_cbranch_scc1 CH_KVX_22
  s_sleep 1
  s_branch CH_KV_21
CH_KVX_22:
  s_waitcnt vmcnt(0)
  s_mov_b32 s62, s6
HP_SEEN_20:
  s_cmp_eq_u32 s51, 0
  s_cbranch_scc1 HP_POLL_18
  s_add_u32 s5, s35, s52
  s_add_u32 s6, s5, 4096
  s_mov_b32 s7, 0
  v_and_b32 v32, 1, v7
  v_lshlrev_b32 v32, 4, v32
  v_mov_b32 v33, 0x3f80
  v_lshlrev_b32 v32, v32, v33
  v_cndmask_b32 v24, 0, v32, s[20:21]
  v_cndmask_b32 v25, 0, v32, s[22:23]
  v_cndmask_b32 v26, 0, v32, s[40:41]
  v_cndmask_b32 v27, 0, v32, s[42:43]
  v_bfe_u32 v32, v7, 1, 3
  v_lshlrev_b32 v32, 10, v32
  v_lshrrev_b32 v33, 4, v7
  v_lshl_add_u32 v32, v33, 6, v32
  v_and_b32 v33, 1, v7
  v_lshl_add_u32 v32, v33, 5, v32
  s_cmp_eq_u32 s51, 2
  s_cbranch_scc1 H1_H_24
  s_cmp_lt_u32 s27, 16
  s_cbranch_scc1 H1_G0_26
  s_sleep 2
H1_G0_26:
  s_sleep 1
  s_cmp_eq_u32 s17, 1
  s_cbranch_scc1 H1_F1_28
H1_F0_27:
  buffer_load_dwordx4 v[8:11], v0, s[8:11], s5 offen offset:0 sc1
  buffer_load_dwordx4 v[12:15], v0, s[8:11], s5 offen offset:1024 sc1
  buffer_load_dwordx4 v[16:19], v0, s[8:11], s5 offen offset:2048 sc1
  buffer_load_dwordx4 v[20:23], v0, s[8:11], s5 offen offset:3072 sc1
  buffer_load_dwordx4 v[48:51], v0, s[8:11], s6 offen offset:0 sc1
  buffer_load_dwordx4 v[52:55], v0, s[8:11], s6 offen offset:1024 sc1
  buffer_load_dwordx4 v[56:59], v0, s[8:11], s6 offen offset:2048 sc1
  buffer_load_dwordx4 v[60:63], v0, s[8:11], s6 offen offset:3072 sc1
  s_add_u32 s7, s7, 1
  s_waitcnt vmcnt(7)
  v_mfma_f32_16x16x32_bf16 v[28:31], v[8:11], v[24:27], 0
  v_or_b32 v33, v8, v9
  v_bitop3_b32 v33, v33, v10, v11 bitop3:0xfe
  s_waitcnt vmcnt(6)
  v_mfma_f32_16x16x32_bf16 v[28:31], v[12:15], v[24:27], v[28:31]
  v_bitop3_b32 v33, v33, v12, v13 bitop3:0xfe
  v_bitop3_b32 v33, v33, v14, v15 bitop3:0xfe
  s_waitcnt vmcnt(5)
  v_mfma_f32_16x16x32_bf16 v[28:31], v[16:19], v[24:27], v[28:31]
  v_bitop3_b32 v33, v33, v16, v17 bitop3:0xfe
  v_bitop3_b32 v33, v33, v18, v19 bitop3:0xfe
  s_waitcnt vmcnt(4)
  v_mfma_f32_16x16x32_bf16 v[28:31], v[20:23], v[24:27], v[28:31]
  v_bitop3_b32 v33, v33, v20, v21 bitop3:0xfe
  v_bitop3_b32 v33, v33, v22, v23 bitop3:0xfe
  s_waitcnt vmcnt(3)
  v_mfma_f32_16x16x32_bf16 v[28:31], v[48:51], v[24:27], v[28:31]
  v_bitop3_b32 v33, v33, v48, v49 bitop3:0xfe
  v_bitop3_b32 v33, v33, v50, v51 bitop3:0xfe
  s_waitcnt vmcnt(2)
  v_mfma_f32_16x16x32_bf16 v[28:31], v[52:55], v[24:27], v[28:31]
  v_bitop3_b32 v33, v33, v52, v53 bitop3:0xfe
  v_bitop3_b32 v33, v33, v54, v55 bitop3:0xfe
  s_waitcnt vmcnt(1)
  v_mfma_f32_16x16x32_bf16 v[28:31], v[56:59], v[24:27], v[28:31]
  v_bitop3_b32 v33, v33, v56, v57 bitop3:0xfe
  v_bitop3_b32 v33, v33, v58, v59 bitop3:0xfe
  s_waitcnt vmcnt(0)
  v_mfma_f32_16x16x32_bf16 v[28:31], v[60:63], v[24:27], v[28:31]
  v_bitop3_b32 v33, v33, v60, v61 bitop3:0xfe
  v_bitop3_b32 v33, v33, v62, v63 bitop3:0xfe
  v_and_b32 v33, 1, v33
  v_cmp_ne_u32 vcc, 0, v33
  s_cbranch_vccz H1_P_25
  s_cmp_gt_u32 s7, 0x40000
  s_cbranch_scc0 H1_F0_27
  s_branch H1_P_25
H1_F1_28:
  buffer_load_dwordx4 v[8:11], v0, s[8:11], s5 offen offset:0 sc1
  buffer_load_dwordx4 v[12:15], v0, s[8:11], s5 offen offset:1024 sc1
  buffer_load_dwordx4 v[16:19], v0, s[8:11], s5 offen offset:2048 sc1
  buffer_load_dwordx4 v[20:23], v0, s[8:11], s5 offen offset:3072 sc1
  buffer_load_dwordx4 v[48:51], v0, s[8:11], s6 offen offset:0 sc1
  buffer_load_dwordx4 v[52:55], v0, s[8:11], s6 offen offset:1024 sc1
  buffer_load_dwordx4 v[56:59], v0, s[8:11], s6 offen offset:2048 sc1
  buffer_load_dwordx4 v[60:63], v0, s[8:11], s6 offen offset:3072 sc1
  s_add_u32 s7, s7, 1
  s_waitcnt vmcnt(7)
  v_mfma_f32_16x16x32_bf16 v[28:31], v[8:11], v[24:27], 0
  v_and_b32 v33, v8, v9
  v_bitop3_b32 v33, v33, v10, v11 bitop3:0x80
  s_waitcnt vmcnt(6)
  v_mfma_f32_16x16x32_bf16 v[28:31], v[12:15], v[24:27], v[28:31]
  v_bitop3_b32 v33, v33, v12, v13 bitop3:0x80
  v_bitop3_b32 v33, v33, v14, v15 bitop3:0x80
  s_waitcnt vmcnt(5)
  v_mfma_f32_16x16x32_bf16 v[28:31], v[16:19], v[24:27], v[28:31]
  v_bitop3_b32 v33, v33, v16, v17 bitop3:0x80
  v_bitop3_b32 v33, v33, v18, v19 bitop3:0x80
  s_waitcnt vmcnt(4)
  v_mfma_f32_16x16x32_bf16 v[28:31], v[20:23], v[24:27], v[28:31]
  v_bitop3_b32 v33, v33, v20, v21 bitop3:0x80
  v_bitop3_b32 v33, v33, v22, v23 bitop3:0x80
  s_waitcnt vmcnt(3)
  v_mfma_f32_16x16x32_bf16 v[28:31], v[48:51], v[24:27], v[28:31]
  v_bitop3_b32 v33, v33, v48, v49 bitop3:0x80
  v_bitop3_b32 v33, v33, v50, v51 bitop3:0x80
  s_waitcnt vmcnt(2)
  v_mfma_f32_16x16x32_bf16 v[28:31], v[52:55], v[24:27], v[28:31]
  v_bitop3_b32 v33, v33, v52, v53 bitop3:0x80
  v_bitop3_b32 v33, v33, v54, v55 bitop3:0x80
  s_waitcnt vmcnt(1)
  v_mfma_f32_16x16x32_bf16 v[28:31], v[56:59], v[24:27], v[28:31]
  v_bitop3_b32 v33, v33, v56, v57 bitop3:0x80
  v_bitop3_b32 v33, v33, v58, v59 bitop3:0x80
  s_waitcnt vmcnt(0)
  v_mfma_f32_16x16x32_bf16 v[28:31], v[60:63], v[24:27], v[28:31]
  v_bitop3_b32 v33, v33, v60, v61 bitop3:0x80
  v_bitop3_b32 v33, v33, v62, v63 bitop3:0x80
  v_and_b32 v33, 1, v33
  v_cmp_ne_u32 vcc, 1, v33
  s_cbranch_vccz H1_P_25
  s_cmp_gt_u32 s7, 0x40000
  s_cbranch_scc0 H1_F1_28
  s_branch H1_P_25
H1_H_24:
  v_lshrrev_b32 v34, 1, v0
  s_sleep 5
  s_cmp_eq_u32 s17, 1
  s_cbranch_scc1 H1_H1_30
H1_H0_29:
  buffer_load_dwordx2 v[8:9], v34, s[8:11], s5 offen offset:0 sc1
  buffer_load_dwordx2 v[10:11], v34, s[8:11], s5 offen offset:512 sc1
  buffer_load_dwordx2 v[12:13], v34, s[8:11], s5 offen offset:1024 sc1
  buffer_load_dwordx2 v[14:15], v34, s[8:11], s5 offen offset:1536 sc1
  buffer_load_dwordx2 v[16:17], v34, s[8:11], s5 offen offset:2048 sc1
  buffer_load_dwordx2 v[18:19], v34, s[8:11], s5 offen offset:2560 sc1
  buffer_load_dwordx2 v[20:21], v34, s[8:11], s5 offen offset:3072 sc1
  buffer_load_dwordx2 v[22:23], v34, s[8:11], s5 offen offset:3584 sc1
  s_add_u32 s7, s7, 1
  s_waitcnt vmcnt(7)
  v_mfma_f32_16x16x16_bf16 v[28:31], v[8:9], v[24:25], 0
  v_or_b32 v33, v8, v9
  s_waitcnt vmcnt(6)
  v_mfma_f32_16x16x16_bf16 v[28:31], v[10:11], v[24:25], v[28:31]
  v_bitop3_b32 v33, v33, v10, v11 bitop3:0xfe
  s_waitcnt vmcnt(5)
  v_mfma_f32_16x16x16_bf16 v[28:31], v[12:13], v[24:25], v[28:31]
  v_bitop3_b32 v33, v33, v12, v13 bitop3:0xfe
  s_waitcnt vmcnt(4)
  v_mfma_f32_16x16x16_bf16 v[28:31], v[14:15], v[24:25], v[28:31]
  v_bitop3_b32 v33, v33, v14, v15 bitop3:0xfe
  s_waitcnt vmcnt(3)
  v_mfma_f32_16x16x16_bf16 v[28:31], v[16:17], v[24:25], v[28:31]
  v_bitop3_b32 v33, v33, v16, v17 bitop3:0xfe
  s_waitcnt vmcnt(2)
  v_mfma_f32_16x16x16_bf16 v[28:31], v[18:19], v[24:25], v[28:31]
  v_bitop3_b32 v33, v33, v18, v19 bitop3:0xfe
  s_waitcnt vmcnt(1)
  v_mfma_f32_16x16x16_bf16 v[28:31], v[20:21], v[24:25], v[28:31]
  v_bitop3_b32 v33, v33, v20, v21 bitop3:0xfe
  s_waitcnt vmcnt(0)
  v_mfma_f32_16x16x16_bf16 v[28:31], v[22:23], v[24:25], v[28:31]
  v_bitop3_b32 v33, v33, v22, v23 bitop3:0xfe
  v_and_b32 v33, 1, v33
  v_cmp_ne_u32 vcc, 0, v33
  s_cbranch_vccz H1_P_25
  s_cmp_gt_u32 s7, 0x40000
  s_cbranch_scc0 H1_H0_29
  s_branch H1_P_25
H1_H1_30:
  buffer_load_dwordx2 v[8:9], v34, s[8:11], s5 offen offset:0 sc1
  buffer_load_dwordx2 v[10:11], v34, s[8:11], s5 offen offset:512 sc1
  buffer_load_dwordx2 v[12:13], v34, s[8:11], s5 offen offset:1024 sc1
  buffer_load_dwordx2 v[14:15], v34, s[8:11], s5 offen offset:1536 sc1
  buffer_load_dwordx2 v[16:17], v34, s[8:11], s5 offen offset:2048 sc1
  buffer_load_dwordx2 v[18:19], v34, s[8:11], s5 offen offset:2560 sc1
  buffer_load_dwordx2 v[20:21], v34, s[8:11], s5 offen offset:3072 sc1
  buffer_load_dwordx2 v[22:23], v34, s[8:11], s5 offen offset:3584 sc1
  s_add_u32 s7, s7, 1
  s_waitcnt vmcnt(7)
  v_mfma_f32_16x16x16_bf16 v[28:31], v[8:9], v[24:25], 0
  v_and_b32 v33, v8, v9
  s_waitcnt vmcnt(6)
  v_mfma_f32_16x16x16_bf16 v[28:31], v[10:11], v[24:25], v[28:31]
  v_bitop3_b32 v33, v33, v10, v11 bitop3:0x80
  s_waitcnt vmcnt(5)
  v_mfma_f32_16x16x16_bf16 v[28:31], v[12:13], v[24:25], v[28:31]
  v_bitop3_b32 v33, v33, v12, v13 bitop3:0x80
  s_waitcnt vmcnt(4)
  v_mfma_f32_16x16x16_bf16 v[28:31], v[14:15], v[24:25], v[28:31]
  v_bitop3_b32 v33, v33, v14, v15 bitop3:0x80
  s_waitcnt vmcnt(3)
  v_mfma_f32_16x16x16_bf16 v[28:31], v[16:17], v[24:25], v[28:31]
  v_bitop3_b32 v33, v33, v16, v17 bitop3:0x80
  s_waitcnt vmcnt(2)
  v_mfma_f32_16x16x16_bf16 v[28:31], v[18:19], v[24:25], v[28:31]
  v_bitop3_b32 v33, v33, v18, v19 bitop3:0x80
  s_waitcnt vmcnt(1)
  v_mfma_f32_16x16x16_bf16 v[28:31], v[20:21], v[24:25], v[28:31]
  v_bitop3_b32 v33, v33, v20, v21 bitop3:0x80
  s_waitcnt vmcnt(0)
  v_mfma_f32_16x16x16_bf16 v[28:31], v[22:23], v[24:25], v[28:31]
  v_bitop3_b32 v33, v33, v22, v23 bitop3:0x80
  v_and_b32 v33, 1, v33
  v_cmp_ne_u32 vcc, 1, v33
  s_cbranch_vccz H1_P_25
  s_cmp_gt_u32 s7, 0x40000
  s_cbranch_scc0 H1_H1_30
  s_branch H1_P_25
H1_P_25:
  s_nop 4
  v_cvt_pk_bf16_f32 v8, v28, v29
  v_cvt_pk_bf16_f32 v9, v30, v31
  v_min_u32 v8, 0xfffffffe, v8
  v_min_u32 v9, 0xfffffffe, v9
  s_add_u32 s5, s37, s53
  s_mov_b64 exec, s[90:91]
  buffer_store_dwordx2 v[8:9], v32, s[8:11], s5 offen
  v_mov_b32 v10, -1
  v_mov_b32 v11, -1
  s_add_u32 s5, s38, s53
  buffer_store_dwordx2 v[10:11], v32, s[8:11], s5 offen
  s_mov_b64 exec, -1
HP_POLL_18:
  s_barrier
  s_lshl_b32 s4, s28, 1
  s_cmp_eq_u32 s28, 3
  s_cselect_b32 s4, 7, s4
  s_lshl_b32 s4, s4, 10
  s_add_u32 s5, s37, s4
  v_add_u32 v9, s4, v0
  s_mov_b32 s7, 0
  s_cmp_ge_u32 s28, 2
  s_cbranch_scc1 H2_3_31
H2_2_32:
  buffer_load_dwordx4 v[56:59], v0, s[8:11], s5 offen offset:0 sc1
  buffer_load_dwordx4 v[60:63], v0, s[8:11], s5 offen offset:1024 sc1
  s_sleep 2
H2_L_34:
  buffer_load_dwordx4 v[68:71], v0, s[8:11], s5 offen offset:0 sc1
  buffer_load_dwordx4 v[72:75], v0, s[8:11], s5 offen offset:1024 sc1
  s_waitcnt vmcnt(2)
  v_max3_u32 v8, v56, v57, v58
  v_max3_u32 v8, v8, v59, v60
  v_max3_u32 v8, v8, v61, v62
  v_max_u32 v8, v8, v63
  v_cmp_eq_u32 vcc, -1, v8
  s_cbranch_vccz H2_A_35
  buffer_load_dwordx4 v[56:59], v0, s[8:11], s5 offen offset:0 sc1
  buffer_load_dwordx4 v[60:63], v0, s[8:11], s5 offen offset:1024 sc1
  s_waitcnt vmcnt(2)
  v_max3_u32 v8, v68, v69, v70
  v_max3_u32 v8, v8, v71, v72
  v_max3_u32 v8, v8, v73, v74
  v_max_u32 v8, v8, v75
  v_cmp_eq_u32 vcc, -1, v8
  s_cbranch_vccz H2_B_36
  s_add_u32 s7, s7, 1
  s_cmp_gt_u32 s7, 0x40000
  s_cbranch_scc0 H2_L_34
  s_waitcnt vmcnt(0)
H2_A_35:
  ds_write_b128 v9, v[56:59] offset:6144
  ds_write_b128 v9, v[60:63] offset:7168
  s_branch H2_D_33
H2_B_36:
  ds_write_b128 v9, v[68:71] offset:6144
  ds_write_b128 v9, v[72:75] offset:7168
  s_branch H2_D_33
H2_3_31:
  buffer_load_dwordx4 v[56:59], v0, s[8:11], s5 offen offset:0 sc1
  buffer_load_dwordx4 v[60:63], v0, s[8:11], s5 offen offset:1024 sc1
  buffer_load_dwordx4 v[64:67], v0, s[8:11], s5 offen offset:2048 sc1
  s_sleep 2
H2_L_37:
  buffer_load_dwordx4 v[68:71], v0, s[8:11], s5 offen offset:0 sc1
  buffer_load_dwordx4 v[72:75], v0, s[8:11], s5 offen offset:1024 sc1
  buffer_load_dwordx4 v[76:79], v0, s[8:11], s5 offen offset:2048 sc1
  s_waitcnt vmcnt(3)
  v_max3_u32 v8, v56, v57, v58
  v_max3_u32 v8, v8, v59, v60
  v_max3_u32 v8, v8, v61, v62
  v_max3_u32 v8, v8, v63, v64
  v_max3_u32 v8, v8, v65, v66
  v_max_u32 v8, v8, v67
  v_cmp_eq_u32 vcc, -1, v8
  s_cbranch_vccz H2_A_38
  buffer_load_dwordx4 v[56:59], v0, s[8:11], s5 offen offset:0 sc1
  buffer_load_dwordx4 v[60:63], v0, s[8:11], s5 offen offset:1024 sc1
  buffer_load_dwordx4 v[64:67], v0, s[8:11], s5 offen offset:2048 sc1
  s_waitcnt vmcnt(3)
  v_max3_u32 v8, v68, v69, v70
  v_max3_u32 v8, v8, v71, v72
  v_max3_u32 v8, v8, v73, v74
  v_max3_u32 v8, v8, v75, v76
  v_max3_u32 v8, v8, v77, v78
  v_max_u32 v8, v8, v79
  v_cmp_eq_u32 vcc, -1, v8
  s_cbranch_vccz H2_B_39
  s_add_u32 s7, s7, 1
  s_cmp_gt_u32 s7, 0x40000
  s_cbranch_scc0 H2_L_37
  s_waitcnt vmcnt(0)
H2_A_38:
  ds_write_b128 v9, v[56:59] offset:6144
  ds_write_b128 v9, v[60:63] offset:7168
  ds_write_b128 v9, v[64:67] offset:8192
  s_branch H2_D_33
H2_B_39:
  ds_write_b128 v9, v[68:71] offset:6144
  ds_write_b128 v9, v[72:75] offset:7168
  ds_write_b128 v9, v[76:79] offset:8192
  s_branch H2_D_33
H2_D_33:
  buffer_load_dwordx4 v[48:51], v0, s[8:11], s39 offen offset:0
  buffer_load_dwordx4 v[52:55], v0, s[8:11], s39 offen offset:1024
  s_add_u32 s32, s32, 1
  s_add_u32 s33, s33, 524288
  s_add_u32 s34, s34, 131072
  s_add_u32 s15, s15, 524288
  s_xor_b32 s17, s17, 1
  s_mov_b32 s88, s38
  s_mov_b32 s38, s37
  s_add_u32 s37, s37, 16384
  s_sub_u32 s5, s37, s57
  s_cmp_eq_u32 s5, 49152
  s_cselect_b32 s37, s57, s37
  s_waitcnt lgkmcnt(0)
  s_barrier
  s_branch CH_LOOP_16
CH_SAFE_15:
CH_LOOP_40:
  ds_read_b128 v[28:31], v0 offset:6144
  ds_read_b128 v[32:35], v0 offset:7168
  v_mov_b64 v[8:9], 0
  v_mov_b64 v[10:11], 0
  v_mov_b64 v[12:13], 0
  v_mov_b64 v[14:15], 0
  v_mov_b64 v[16:17], 0
  v_mov_b64 v[18:19], 0
  v_mov_b64 v[24:25], 0
  v_mov_b64 v[26:27], 0
  ds_read_b128 v[20:23], v0 offset:8192
  s_waitcnt lgkmcnt(2)
  v_smfmac_f32_16x16x64_bf16 v[16:19], v[28:31], a[144:151], v2
  v_smfmac_f32_16x16x64_bf16 v[24:27], v[28:31], a[152:159], v2
  buffer_load_dwordx4 v[56:59], v0, s[8:11], s39 offen offset:2048
  v_smfmac_f32_16x16x64_bf16 v[8:11], v[28:31], a[0:7], v2
  v_smfmac_f32_16x16x64_bf16 v[12:15], v[28:31], a[8:15], v2
  ds_read_b128 v[28:31], v0 offset:9216
  s_waitcnt lgkmcnt(2)
  v_smfmac_f32_16x16x64_bf16 v[16:19], v[32:35], a[160:167], v2
  v_smfmac_f32_16x16x64_bf16 v[24:27], v[32:35], a[168:175], v2
  buffer_load_dwordx4 v[60:63], v0, s[8:11], s39 offen offset:3072
  v_smfmac_f32_16x16x64_bf16 v[8:11], v[32:35], a[16:23], v2
  v_smfmac_f32_16x16x64_bf16 v[12:15], v[32:35], a[24:31], v2
  ds_read_b128 v[32:35], v0 offset:10240
  s_waitcnt lgkmcnt(2)
  v_smfmac_f32_16x16x64_bf16 v[16:19], v[20:23], a[176:183], v2
  v_smfmac_f32_16x16x64_bf16 v[24:27], v[20:23], a[184:191], v2
  buffer_load_dwordx4 v[64:67], v0, s[8:11], s12 offen offset:0
  v_smfmac_f32_16x16x64_bf16 v[8:11], v[20:23], a[32:39], v2
  v_smfmac_f32_16x16x64_bf16 v[12:15], v[20:23], a[40:47], v2
  ds_read_b128 v[20:23], v0 offset:11264
  s_waitcnt lgkmcnt(2)
  v_smfmac_f32_16x16x64_bf16 v[16:19], v[28:31], a[192:199], v2
  v_smfmac_f32_16x16x64_bf16 v[24:27], v[28:31], a[200:207], v2
  buffer_load_dwordx4 v[68:71], v0, s[8:11], s12 offen offset:1024
  v_smfmac_f32_16x16x64_bf16 v[8:11], v[28:31], a[48:55], v2
  v_smfmac_f32_16x16x64_bf16 v[12:15], v[28:31], a[56:63], v2
  ds_read_b128 v[28:31], v0 offset:12288
  s_waitcnt lgkmcnt(2)
  v_smfmac_f32_16x16x64_bf16 v[16:19], v[32:35], a[208:215], v2
  v_smfmac_f32_16x16x64_bf16 v[24:27], v[32:35], a[216:223], v2
  buffer_load_dwordx4 v[72:75], v0, s[8:11], s12 offen offset:2048
  v_smfmac_f32_16x16x64_bf16 v[8:11], v[32:35], a[64:71], v2
  v_smfmac_f32_16x16x64_bf16 v[12:15], v[32:35], a[72:79], v2
  ds_read_b128 v[32:35], v0 offset:13312
  s_waitcnt lgkmcnt(2)
  v_smfmac_f32_16x16x64_bf16 v[16:19], v[20:23], a[224:231], v2
  v_smfmac_f32_16x16x64_bf16 v[24:27], v[20:23], a[232:239], v2
  buffer_load_dwordx4 v[76:79], v0, s[8:11], s12 offen offset:3072
  v_smfmac_f32_16x16x64_bf16 v[8:11], v[20:23], a[80:87], v2
  v_smfmac_f32_16x16x64_bf16 v[12:15], v[20:23], a[88:95], v2
  ds_read_b128 v[20:23], v0 offset:14336
  s_waitcnt lgkmcnt(2)
  v_smfmac_f32_16x16x64_bf16 v[16:19], v[28:31], a[240:247], v2
  v_smfmac_f32_16x16x64_bf16 v[24:27], v[28:31], a[248:255], v2
  v_smfmac_f32_16x16x64_bf16 v[8:11], v[28:31], a[96:103], v2
  v_smfmac_f32_16x16x64_bf16 v[12:15], v[28:31], a[104:111], v2
  ds_read_b128 v[28:31], v0 offset:15360
  s_waitcnt lgkmcnt(2)
  v_smfmac_f32_16x16x64_bf16 v[16:19], v[32:35], v[80:87], v2
  v_smfmac_f32_16x16x64_bf16 v[24:27], v[32:35], v[88:95], v2
  buffer_load_dwordx4 v[36:39], v0, s[8:11], s33 offen offset:0 nt
  v_smfmac_f32_16x16x64_bf16 v[8:11], v[32:35], a[112:119], v2
  v_smfmac_f32_16x16x64_bf16 v[12:15], v[32:35], a[120:127], v2
  s_waitcnt lgkmcnt(1)
  v_smfmac_f32_16x16x64_bf16 v[16:19], v[20:23], v[96:103], v2
  v_smfmac_f32_16x16x64_bf16 v[24:27], v[20:23], v[104:111], v2
  buffer_load_dwordx4 v[40:43], v0, s[8:11], s33 offen offset:1024 nt
  v_smfmac_f32_16x16x64_bf16 v[8:11], v[20:23], a[128:135], v2
  v_smfmac_f32_16x16x64_bf16 v[12:15], v[20:23], a[136:143], v2
  s_waitcnt vmcnt(8) lgkmcnt(0)
  v_smfmac_f32_16x16x64_bf16 v[16:19], v[28:31], v[48:55], v2
  s_waitcnt vmcnt(6)
  v_smfmac_f32_16x16x64_bf16 v[24:27], v[28:31], v[56:63], v2
  v_mov_b64 v[48:49], 0
  v_mov_b64 v[50:51], 0
  v_mov_b64 v[52:53], 0
  v_mov_b64 v[54:55], 0
  buffer_load_dwordx4 v[56:59], v0, s[8:11], s15 offen nt
  s_waitcnt vmcnt(5)
  v_smfmac_f32_16x16x64_bf16 v[8:11], v[28:31], v[64:71], v2
  s_waitcnt vmcnt(3)
  v_smfmac_f32_16x16x64_bf16 v[12:15], v[28:31], v[72:79], v2
  v_smfmac_f32_16x16x64_bf16 v[48:51], v[28:31], v[176:183], v2
  v_smfmac_f32_16x16x64_bf16 v[52:55], v[28:31], v[184:191], v2
  ds_read_b128 v[28:31], v0 offset:12288
  v_add_f32 v16, v16, v17
  v_add_f32 v18, v18, v19
  v_cvt_pk_bf16_f32 v64, v16, v18
  v_add_f32 v24, v24, v25
  v_add_f32 v26, v26, v27
  v_cvt_pk_bf16_f32 v66, v24, v26
  buffer_load_dwordx4 v[60:63], v0, s[8:11], s15 offen offset:1024 nt
  v_smfmac_f32_16x16x64_bf16 v[48:51], v[20:23], v[160:167], v2
  v_smfmac_f32_16x16x64_bf16 v[52:55], v[20:23], v[168:175], v2
  ds_read_b128 v[20:23], v0 offset:6144
  v_add_f32 v8, v8, v9
  v_add_f32 v10, v10, v11
  v_cvt_pk_bf16_f32 v65, v8, v10
  ds_write_b64 v3, v[64:65] offset:0
  v_add_f32 v12, v12, v13
  v_add_f32 v14, v14, v15
  v_cvt_pk_bf16_f32 v67, v12, v14
  ds_write_b64 v3, v[66:67] offset:512
  v_lshlrev_b32 v77, 3, v0
  s_add_u32 s5, s33, s97
  s_add_u32 s6, s32, 2
  s_cmp_ge_u32 s62, s6
  s_cselect_b64 exec, s[18:19], 0
  buffer_load_dword v76, v77, s[8:11], s5 offen
  s_mov_b64 exec, -1
  v_smfmac_f32_16x16x64_bf16 v[48:51], v[32:35], v[144:151], v2
  v_smfmac_f32_16x16x64_bf16 v[52:55], v[32:35], v[152:159], v2
  ds_read_b128 v[32:35], v0 offset:7168
  v_mov_b32 v68, v64
  v_mov_b32 v70, v66
  buffer_load_dword v77, off, s[8:11], s59 sc1
  s_waitcnt lgkmcnt(1)
  s_barrier
  ds_read_b64_tr_b16 v[8:9], v4 offset:0
  ds_read_b64_tr_b16 v[10:11], v4 offset:128
  v_xor_b32 v69, 1024, v4
  ds_read_b64_tr_b16 v[12:13], v69 offset:0
  ds_read_b64_tr_b16 v[14:15], v69 offset:128
  v_xor_b32 v69, 2048, v4
  ds_read_b64_tr_b16 v[16:17], v69 offset:0
  ds_read_b64_tr_b16 v[18:19], v69 offset:128
  s_sub_u32 s5, s34, 131072
  s_cmp_lg_u32 s32, 0
  s_cselect_b64 exec, -1, 0
  buffer_store_dwordx4 v[44:47], v0, s[8:11], s5 offen sc1
  s_mov_b64 exec, -1
  v_xor_b32 v69, 3072, v4
  ds_read_b64_tr_b16 v[64:65], v69 offset:0
  ds_read_b64_tr_b16 v[66:67], v69 offset:128
  v_smfmac_f32_16x16x64_bf16 v[48:51], v[28:31], v[128:135], v2
  v_smfmac_f32_16x16x64_bf16 v[52:55], v[28:31], v[136:143], v2
  ds_read_b128 v[28:31], v0 offset:8192
  s_sub_u32 s6, s32, 1
  s_max_i32 s6, s6, 0
  v_mov_b32 v69, s6
  s_cmp_le_u32 s32, 60
  s_cselect_b64 exec, s[94:95], 0
  buffer_store_dword v69, v0, s[8:11], s58 offen sc1
  s_mov_b64 exec, -1
  s_waitcnt vmcnt(7) lgkmcnt(7)
  v_mfma_f32_16x16x32_bf16 v[24:27], v[36:39], v[8:11], 0
  s_waitcnt vmcnt(6)
  v_mfma_f32_16x16x32_bf16 v[44:47], v[40:43], v[8:11], 0
  v_mfma_f32_16x16x32_bf16 v[72:75], v[8:11], v[8:11], 0
  s_waitcnt lgkmcnt(5)
  v_mfma_f32_16x16x32_bf16 v[72:75], v[12:15], v[12:15], v[72:75]
  s_waitcnt lgkmcnt(3)
  v_mfma_f32_16x16x32_bf16 v[72:75], v[16:19], v[16:19], v[72:75]
  s_waitcnt lgkmcnt(1)
  v_mfma_f32_16x16x32_bf16 v[72:75], v[64:67], v[64:67], v[72:75]
  v_smfmac_f32_16x16x64_bf16 v[48:51], v[20:23], v[112:119], v2
  v_smfmac_f32_16x16x64_bf16 v[52:55], v[20:23], v[120:127], v2
  ds_read_b128 v[8:11], v1 offset:0
  ds_read_b128 v[12:15], v1 offset:1024
  ds_read_b128 v[16:19], v1 offset:2048
  ds_read_b128 v[20:23], v1 offset:3072
  s_mov_b64 vcc, s[44:45]
  v_add_u32 v69, s63, v0
  v_cndmask_b32_dpp v24, v44, v24, vcc quad_perm:[2,3,2,3] row_mask:0xf bank_mask:0xf
  v_cndmask_b32_dpp v25, v45, v25, vcc quad_perm:[2,3,2,3] row_mask:0xf bank_mask:0xf
  v_cndmask_b32_dpp v26, v46, v26, vcc quad_perm:[2,3,2,3] row_mask:0xf bank_mask:0xf
  v_cndmask_b32_dpp v27, v47, v27, vcc quad_perm:[2,3,2,3] row_mask:0xf bank_mask:0xf
  ds_write_b128 v69, v[24:27]
  s_waitcnt lgkmcnt(3)
  v_smfmac_f32_16x16x64_bf16 v[48:51], v[32:35], v[8:15], v2
  ds_read_b128 v[8:11], v1 offset:16384
  ds_read_b128 v[12:15], v1 offset:17408
  s_waitcnt lgkmcnt(3)
  v_smfmac_f32_16x16x64_bf16 v[52:55], v[32:35], v[16:23], v2
  ds_read_b128 v[16:19], v1 offset:18432
  ds_read_b128 v[20:23], v1 offset:19456
  ds_read_b128 v[32:35], v0 offset:9216
  s_waitcnt lgkmcnt(5)
  s_barrier
  v_xor_b32 v44, 1024, v69
  ds_read_b128 v[44:47], v44
  v_xor_b32 v36, 2048, v69
  ds_read_b128 v[36:39], v36
  v_xor_b32 v40, 3072, v69
  ds_read_b128 v[40:43], v40
  v_mov_b32 v75, 0xff800000
  v_cndmask_b32 v72, v75, v72, vcc
  v_cndmask_b32 v73, v75, v73, vcc
  v_max_f32 v74, v72, v73
  s_waitcnt lgkmcnt(6)
  v_smfmac_f32_16x16x64_bf16 v[48:51], v[28:31], v[8:15], v2
  ds_read_b128 v[8:11], v1 offset:32768
  ds_read_b128 v[12:15], v1 offset:33792
  s_waitcnt lgkmcnt(6)
  v_smfmac_f32_16x16x64_bf16 v[52:55], v[28:31], v[16:23], v2
  ds_read_b128 v[16:19], v1 offset:34816
  ds_read_b128 v[20:23], v1 offset:35840
  ds_read_b128 v[28:31], v0 offset:10240
  s_waitcnt lgkmcnt(7)
  v_pk_add_f32 v[24:25], v[24:25], v[44:45]
  v_pk_add_f32 v[26:27], v[26:27], v[46:47]
  s_waitcnt lgkmcnt(5)
  v_pk_add_f32 v[36:37], v[36:37], v[40:41]
  v_pk_add_f32 v[38:39], v[38:39], v[42:43]
  v_pk_add_f32 v[24:25], v[24:25], v[36:37]
  v_pk_add_f32 v[26:27], v[26:27], v[38:39]
  v_max3_f32 v74, v74, v24, v25
  v_max3_f32 v74, v74, v26, v27
  s_waitcnt lgkmcnt(3)
  v_smfmac_f32_16x16x64_bf16 v[48:51], v[32:35], v[8:15], v2
  ds_read_b128 v[8:11], v1 offset:49152
  ds_read_b128 v[12:15], v1 offset:50176
  s_waitcnt lgkmcnt(3)
  v_smfmac_f32_16x16x64_bf16 v[52:55], v[32:35], v[16:23], v2
  ds_read_b128 v[16:19], v1 offset:51200
  ds_read_b128 v[20:23], v1 offset:52224
  ds_read_b128 v[32:35], v0 offset:11264
  v_max_f32_dpp v74, v74, v74 quad_perm:[2,3,0,1] row_mask:0xf bank_mask:0xf
  v_mov_b32 v75, v74
  s_nop 1
  v_permlane16_swap_b32 v74, v75
  v_max_f32 v74, v74, v75
  v_mov_b32 v75, v74
  s_waitcnt lgkmcnt(3)
  v_smfmac_f32_16x16x64_bf16 v[48:51], v[28:31], v[8:15], v2
  v_add_u32 v36, 65536, v1
  ds_read_b128 v[8:11], v36 offset:0
  ds_read_b128 v[12:15], v36 offset:1024
  v_permlane32_swap_b32 v74, v75
  v_max_f32 v74, v74, v75
  v_mul_f32 v74, s50, v74
  s_waitcnt lgkmcnt(3)
  v_smfmac_f32_16x16x64_bf16 v[52:55], v[28:31], v[16:23], v2
  ds_read_b128 v[16:19], v36 offset:2048
  ds_read_b128 v[20:23], v36 offset:3072
  v_fma_f32 v24, v24, s50, -v74
  v_fma_f32 v25, v25, s50, -v74
  v_fma_f32 v26, v26, s50, -v74
  v_fma_f32 v27, v27, s50, -v74
  v_fma_f32 v72, v72, s50, -v74
  v_fma_f32 v73, v73, s50, -v74
  v_exp_f32 v24, v24
  v_exp_f32 v25, v25
  v_exp_f32 v26, v26
  v_exp_f32 v27, v27
  v_exp_f32 v72, v72
  v_exp_f32 v73, v73
  s_waitcnt lgkmcnt(2)
  v_smfmac_f32_16x16x64_bf16 v[48:51], v[32:35], v[8:15], v2
  s_waitcnt lgkmcnt(0)
  v_smfmac_f32_16x16x64_bf16 v[52:55], v[32:35], v[16:23], v2
  buffer_load_dwordx4 v[8:11], v0, s[8:11], s13 offen offset:0
  v_cvt_pk_bf16_f32 v28, v24, v25
  v_cvt_pk_bf16_f32 v29, v26, v27
  v_mov_b32 v64, 0
  v_cvt_pk_bf16_f32 v65, v72, v73
  v_mov_b32_dpp v30, v28 quad_perm:[0,1,0,1] row_mask:0xf bank_mask:0xf
  v_mov_b32_dpp v31, v29 quad_perm:[0,1,0,1] row_mask:0xf bank_mask:0xf
  v_mov_b32 v40, 0x3f803f80
  v_mov_b32 v41, 0x3f803f80
  v_mov_b32 v42, 0x3f803f80
  v_mov_b32 v43, 0x3f803f80
  buffer_load_dwordx4 v[12:15], v0, s[8:11], s13 offen offset:1024
  s_waitcnt vmcnt(7)
  v_mfma_f32_16x16x32_bf16 v[32:35], v[56:59], v[28:31], 0
  s_waitcnt vmcnt(6)
  v_mfma_f32_16x16x32_bf16 v[36:39], v[60:63], v[28:31], 0
  v_mfma_f32_16x16x32_bf16 v[44:47], v[40:43], v[28:31], 0
  v_add_f32 v48, v48, v49
  v_add_f32 v50, v50, v51
  v_cvt_pk_bf16_f32 v69, v48, v50
  v_add_f32 v52, v52, v53
  v_add_f32 v54, v54, v55
  v_cvt_pk_bf16_f32 v71, v52, v54
  v_mfma_f32_16x16x16_bf16 v[44:47], v[40:41], v[64:65], v[44:47]
  buffer_load_dwordx4 v[16:19], v0, s[8:11], s13 offen offset:2048
  v_mfma_f32_16x16x16_bf16 v[32:35], v[68:69], v[64:65], v[32:35]
  v_mfma_f32_16x16x16_bf16 v[36:39], v[70:71], v[64:65], v[36:39]
  s_cmp_lt_u32 s32, 60
  s_cbranch_scc1 CH_CONT_41
  buffer_store_dwordx4 v[68:71], v0, s[8:11], s34 offen sc1
  s_waitcnt vmcnt(0)
  s_barrier
  s_add_u32 s6, s32, 1
  v_mov_b32 v40, s6
  v_mov_b32 v41, 0
  s_mov_b64 exec, 1
  buffer_store_dword v40, v41, s[8:11], s58 offen sc1
  s_mov_b64 exec, -1
  s_cmp_lt_u32 s32, 63
  s_cbranch_scc1 CH_CONT_41
  s_waitcnt vmcnt(0)
  s_branch CH_END_12
CH_CONT_41:
  buffer_load_dwordx4 v[20:23], v0, s[8:11], s13 offen offset:3072
  s_nop 1
  v_rcp_f32 v44, v44
  buffer_load_dwordx4 v[56:59], v0, s[8:11], s14 offen offset:0
  v_pk_mul_f32 v[32:33], v[32:33], v[44:45] op_sel_hi:[1,0]
  v_pk_mul_f32 v[34:35], v[34:35], v[44:45] op_sel_hi:[1,0]
  v_cvt_pk_bf16_f32 v28, v32, v33
  v_cvt_pk_bf16_f32 v29, v34, v35
  v_pk_mul_f32 v[36:37], v[36:37], v[44:45] op_sel_hi:[1,0]
  v_pk_mul_f32 v[38:39], v[38:39], v[44:45] op_sel_hi:[1,0]
  v_cvt_pk_bf16_f32 v30, v36, v37
  v_cvt_pk_bf16_f32 v31, v38, v39
  s_mov_b64 exec, s[44:45]
  ds_write_b64 v5, v[28:29] offset:0
  ds_write_b64 v5, v[30:31] offset:256
  s_mov_b64 exec, -1
  buffer_load_dwordx4 v[60:63], v0, s[8:11], s14 offen offset:1024
  v_add_u32 v78, 81920, v1
  ds_read_b128 v[32:35], v78 offset:0
  ds_read_b128 v[36:39], v78 offset:1024
  ds_read_b128 v[48:51], v78 offset:2048
  ds_read_b128 v[52:55], v78 offset:3072
  v_mov_b64 v[64:65], 0
  v_mov_b64 v[66:67], 0
  v_mov_b64 v[72:73], 0
  v_mov_b64 v[74:75], 0
  s_waitcnt lgkmcnt(4)
  s_barrier
  ds_read_b128 v[40:43], v0 offset:0
  ds_read_b128 v[44:47], v0 offset:1024
  s_waitcnt vmcnt(8)
  v_readfirstlane_b32 s6, v77
  s_nop 0
  s_max_u32 s62, s62, s6
  s_waitcnt lgkmcnt(1)
  v_smfmac_f32_16x16x64_bf16 v[64:67], v[40:43], v[192:199], v2
  s_waitcnt vmcnt(4) lgkmcnt(0)
  v_smfmac_f32_16x16x64_bf16 v[64:67], v[44:47], v[8:15], v2
  buffer_load_dwordx4 v[24:27], v0, s[8:11], s14 offen offset:2048
  v_mov_b64 v[8:9], 0
  v_mov_b64 v[10:11], 0
  v_mov_b64 v[12:13], 0
  v_mov_b64 v[14:15], 0
  v_smfmac_f32_16x16x64_bf16 v[72:75], v[40:43], v[200:207], v2
  s_waitcnt vmcnt(3)
  v_smfmac_f32_16x16x64_bf16 v[72:75], v[44:47], v[16:23], v2
  buffer_load_dwordx4 v[28:31], v0, s[8:11], s14 offen offset:3072
  v_mov_b64 v[16:17], 0
  v_mov_b64 v[18:19], 0
  v_smfmac_f32_16x16x64_bf16 v[8:11], v[40:43], v[32:39], v2
  ds_read_b128 v[32:35], v78 offset:16384
  ds_read_b128 v[36:39], v78 offset:17408
  v_smfmac_f32_16x16x64_bf16 v[8:11], v[44:47], v[208:215], v2
  v_add_f32 v64, v64, v65
  v_add_f32 v66, v66, v67
  v_cvt_pk_bf16_f32 v64, v64, v66
  v_bfi_b32 v64, 1, s17, v64
  v_mov_b64 v[20:21], 0
  v_mov_b64 v[22:23], 0
  v_smfmac_f32_16x16x64_bf16 v[12:15], v[40:43], v[48:55], v2
  ds_read_b128 v[48:51], v78 offset:18432
  ds_read_b128 v[52:55], v78 offset:19456
  v_smfmac_f32_16x16x64_bf16 v[12:15], v[44:47], v[216:223], v2
  v_add_f32 v72, v72, v73
  v_add_f32 v74, v74, v75
  v_cvt_pk_bf16_f32 v65, v72, v74
  v_bfi_b32 v65, 1, s17, v65
  v_mov_b64 v[72:73], 0
  v_mov_b64 v[74:75], 0
  v_smfmac_f32_16x16x64_bf16 v[16:19], v[40:43], v[224:231], v2
  s_waitcnt lgkmcnt(2)
  v_smfmac_f32_16x16x64_bf16 v[16:19], v[44:47], v[32:39], v2
  ds_read_b128 v[32:35], v78 offset:32768
  ds_read_b128 v[36:39], v78 offset:33792
  v_add_f32 v8, v8, v9
  v_add_f32 v10, v10, v11
  v_cvt_pk_bf16_f32 v66, v8, v10
  v_bfi_b32 v66, 1, s17, v66
  v_mov_b64 v[8:9], 0
  v_mov_b64 v[10:11], 0
  v_smfmac_f32_16x16x64_bf16 v[20:23], v[40:43], v[232:239], v2
  s_waitcnt lgkmcnt(2)
  v_smfmac_f32_16x16x64_bf16 v[20:23], v[44:47], v[48:55], v2
  ds_read_b128 v[48:51], v78 offset:34816
  ds_read_b128 v[52:55], v78 offset:35840
  v_add_f32 v12, v12, v13
  v_add_f32 v14, v14, v15
  v_cvt_pk_bf16_f32 v67, v12, v14
  v_bfi_b32 v67, 1, s17, v67
  s_add_u32 s5, s35, s54
  buffer_store_dwordx4 v[64:67], v6, s[8:11], s5 offen sc1
  v_mov_b64 v[12:13], 0
  v_mov_b64 v[14:15], 0
  s_waitcnt lgkmcnt(2)
  v_smfmac_f32_16x16x64_bf16 v[72:75], v[40:43], v[32:39], v2
  ds_read_b128 v[32:35], v78 offset:49152
  ds_read_b128 v[36:39], v78 offset:50176
  v_smfmac_f32_16x16x64_bf16 v[72:75], v[44:47], v[240:247], v2
  v_add_f32 v16, v16, v17
  v_add_f32 v18, v18, v19
  v_cvt_pk_bf16_f32 v16, v16, v18
  v_bfi_b32 v16, 1, s17, v16
  v_mov_b64 v[64:65], 0
  v_mov_b64 v[66:67], 0
  s_waitcnt lgkmcnt(2)
  v_smfmac_f32_16x16x64_bf16 v[8:11], v[40:43], v[48:55], v2
  ds_read_b128 v[48:51], v78 offset:51200
  ds_read_b128 v[52:55], v78 offset:52224
  v_smfmac_f32_16x16x64_bf16 v[8:11], v[44:47], v[248:255], v2
  v_add_f32 v20, v20, v21
  v_add_f32 v22, v22, v23
  v_cvt_pk_bf16_f32 v17, v20, v22
  v_bfi_b32 v17, 1, s17, v17
  s_waitcnt lgkmcnt(2)
  v_smfmac_f32_16x16x64_bf16 v[12:15], v[40:43], v[32:39], v2
  s_waitcnt vmcnt(3)
  v_smfmac_f32_16x16x64_bf16 v[12:15], v[44:47], v[56:63], v2
  v_add_f32 v72, v72, v73
  v_add_f32 v74, v74, v75
  v_cvt_pk_bf16_f32 v18, v72, v74
  v_bfi_b32 v18, 1, s17, v18
  s_waitcnt lgkmcnt(0)
  v_smfmac_f32_16x16x64_bf16 v[64:67], v[40:43], v[48:55], v2
  s_waitcnt vmcnt(1)
  v_smfmac_f32_16x16x64_bf16 v[64:67], v[44:47], v[24:31], v2
  v_add_f32 v8, v8, v9
  v_add_f32 v10, v10, v11
  v_cvt_pk_bf16_f32 v19, v8, v10
  v_bfi_b32 v19, 1, s17, v19
  s_add_u32 s5, s35, s54
  s_add_u32 s5, s5, 131072
  buffer_store_dwordx4 v[16:19], v6, s[8:11], s5 offen sc1
  v_add_f32 v12, v12, v13
  v_add_f32 v14, v14, v15
  v_cvt_pk_bf16_f32 v12, v12, v14
  v_bfi_b32 v12, 1, s17, v12
  v_add_f32 v64, v64, v65
  v_add_f32 v66, v66, v67
  v_cvt_pk_bf16_f32 v13, v64, v66
  v_bfi_b32 v13, 1, s17, v13
  v_lshrrev_b32 v8, 1, v6
  s_add_u32 s5, s35, s55
  buffer_store_dwordx2 v[12:13], v8, s[8:11], s5 offen sc1
  v_mov_b32 v44, v68
  v_mov_b32 v45, v69
  v_mov_b32 v46, v70
  v_mov_b32 v47, v71
  s_cmp_lg_u32 s28, 3
  s_cbranch_scc1 HP_SEEN_44
  s_add_u32 s61, s32, 2
  s_min_u32 s61, s61, 64
  s_cmp_ge_u32 s62, s61
  s_cbranch_scc1 HP_SEEN_44
  s_mov_b32 s7, 0
  v_mov_b32 v9, 0
CH_KV_45:
  buffer_load_dword v8, v9, s[8:11], s59 offen sc1
  s_add_u32 s7, s7, 1
  s_cmp_gt_u32 s7, 0x40000
  s_cbranch_scc1 CH_KVX_46
  s_waitcnt vmcnt(0)
  v_readfirstlane_b32 s6, v8
  s_nop 0
  s_cmp_ge_u32 s6, s61
  s_cbranch_scc1 CH_KVX_46
  s_sleep 1
  s_branch CH_KV_45
CH_KVX_46:
  s_waitcnt vmcnt(0)
  s_mov_b32 s62, s6
HP_SEEN_44:
  s_cmp_eq_u32 s51, 0
  s_cbranch_scc1 HP_POLL_42
  s_add_u32 s5, s35, s52
  s_add_u32 s6, s5, 4096
  s_mov_b32 s7, 0
  v_and_b32 v32, 1, v7
  v_lshlrev_b32 v32, 4, v32
  v_mov_b32 v33, 0x3f80
  v_lshlrev_b32 v32, v32, v33
  v_cndmask_b32 v24, 0, v32, s[20:21]
  v_cndmask_b32 v25, 0, v32, s[22:23]
  v_cndmask_b32 v26, 0, v32, s[40:41]
  v_cndmask_b32 v27, 0, v32, s[42:43]
  v_bfe_u32 v32, v7, 1, 3
  v_lshlrev_b32 v32, 10, v32
  v_lshrrev_b32 v33, 4, v7
  v_lshl_add_u32 v32, v33, 6, v32
  v_and_b32 v33, 1, v7
  v_lshl_add_u32 v32, v33, 5, v32
  s_cmp_eq_u32 s51, 2
  s_cbranch_scc1 H1_H_48
  s_cmp_lt_u32 s27, 16
  s_cbranch_scc1 H1_G0_50
  s_sleep 2
H1_G0_50:
  s_sleep 1
  s_cmp_eq_u32 s17, 1
  s_cbranch_scc1 H1_F1_52
H1_F0_51:
  buffer_load_dwordx4 v[8:11], v0, s[8:11], s5 offen offset:0 sc1
  buffer_load_dwordx4 v[12:15], v0, s[8:11], s5 offen offset:1024 sc1
  buffer_load_dwordx4 v[16:19], v0, s[8:11], s5 offen offset:2048 sc1
  buffer_load_dwordx4 v[20:23], v0, s[8:11], s5 offen offset:3072 sc1
  buffer_load_dwordx4 v[48:51], v0, s[8:11], s6 offen offset:0 sc1
  buffer_load_dwordx4 v[52:55], v0, s[8:11], s6 offen offset:1024 sc1
  buffer_load_dwordx4 v[56:59], v0, s[8:11], s6 offen offset:2048 sc1
  buffer_load_dwordx4 v[60:63], v0, s[8:11], s6 offen offset:3072 sc1
  s_add_u32 s7, s7, 1
  s_waitcnt vmcnt(7)
  v_mfma_f32_16x16x32_bf16 v[28:31], v[8:11], v[24:27], 0
  v_or_b32 v33, v8, v9
  v_bitop3_b32 v33, v33, v10, v11 bitop3:0xfe
  s_waitcnt vmcnt(6)
  v_mfma_f32_16x16x32_bf16 v[28:31], v[12:15], v[24:27], v[28:31]
  v_bitop3_b32 v33, v33, v12, v13 bitop3:0xfe
  v_bitop3_b32 v33, v33, v14, v15 bitop3:0xfe
  s_waitcnt vmcnt(5)
  v_mfma_f32_16x16x32_bf16 v[28:31], v[16:19], v[24:27], v[28:31]
  v_bitop3_b32 v33, v33, v16, v17 bitop3:0xfe
  v_bitop3_b32 v33, v33, v18, v19 bitop3:0xfe
  s_waitcnt vmcnt(4)
  v_mfma_f32_16x16x32_bf16 v[28:31], v[20:23], v[24:27], v[28:31]
  v_bitop3_b32 v33, v33, v20, v21 bitop3:0xfe
  v_bitop3_b32 v33, v33, v22, v23 bitop3:0xfe
  s_waitcnt vmcnt(3)
  v_mfma_f32_16x16x32_bf16 v[28:31], v[48:51], v[24:27], v[28:31]
  v_bitop3_b32 v33, v33, v48, v49 bitop3:0xfe
  v_bitop3_b32 v33, v33, v50, v51 bitop3:0xfe
  s_waitcnt vmcnt(2)
  v_mfma_f32_16x16x32_bf16 v[28:31], v[52:55], v[24:27], v[28:31]
  v_bitop3_b32 v33, v33, v52, v53 bitop3:0xfe
  v_bitop3_b32 v33, v33, v54, v55 bitop3:0xfe
  s_waitcnt vmcnt(1)
  v_mfma_f32_16x16x32_bf16 v[28:31], v[56:59], v[24:27], v[28:31]
  v_bitop3_b32 v33, v33, v56, v57 bitop3:0xfe
  v_bitop3_b32 v33, v33, v58, v59 bitop3:0xfe
  s_waitcnt vmcnt(0)
  v_mfma_f32_16x16x32_bf16 v[28:31], v[60:63], v[24:27], v[28:31]
  v_bitop3_b32 v33, v33, v60, v61 bitop3:0xfe
  v_bitop3_b32 v33, v33, v62, v63 bitop3:0xfe
  v_and_b32 v33, 1, v33
  v_cmp_ne_u32 vcc, 0, v33
  s_cbranch_vccz H1_P_49
  s_cmp_gt_u32 s7, 0x40000
  s_cbranch_scc0 H1_F0_51
  s_branch H1_P_49
H1_F1_52:
  buffer_load_dwordx4 v[8:11], v0, s[8:11], s5 offen offset:0 sc1
  buffer_load_dwordx4 v[12:15], v0, s[8:11], s5 offen offset:1024 sc1
  buffer_load_dwordx4 v[16:19], v0, s[8:11], s5 offen offset:2048 sc1
  buffer_load_dwordx4 v[20:23], v0, s[8:11], s5 offen offset:3072 sc1
  buffer_load_dwordx4 v[48:51], v0, s[8:11], s6 offen offset:0 sc1
  buffer_load_dwordx4 v[52:55], v0, s[8:11], s6 offen offset:1024 sc1
  buffer_load_dwordx4 v[56:59], v0, s[8:11], s6 offen offset:2048 sc1
  buffer_load_dwordx4 v[60:63], v0, s[8:11], s6 offen offset:3072 sc1
  s_add_u32 s7, s7, 1
  s_waitcnt vmcnt(7)
  v_mfma_f32_16x16x32_bf16 v[28:31], v[8:11], v[24:27], 0
  v_and_b32 v33, v8, v9
  v_bitop3_b32 v33, v33, v10, v11 bitop3:0x80
  s_waitcnt vmcnt(6)
  v_mfma_f32_16x16x32_bf16 v[28:31], v[12:15], v[24:27], v[28:31]
  v_bitop3_b32 v33, v33, v12, v13 bitop3:0x80
  v_bitop3_b32 v33, v33, v14, v15 bitop3:0x80
  s_waitcnt vmcnt(5)
  v_mfma_f32_16x16x32_bf16 v[28:31], v[16:19], v[24:27], v[28:31]
  v_bitop3_b32 v33, v33, v16, v17 bitop3:0x80
  v_bitop3_b32 v33, v33, v18, v19 bitop3:0x80
  s_waitcnt vmcnt(4)
  v_mfma_f32_16x16x32_bf16 v[28:31], v[20:23], v[24:27], v[28:31]
  v_bitop3_b32 v33, v33, v20, v21 bitop3:0x80
  v_bitop3_b32 v33, v33, v22, v23 bitop3:0x80
  s_waitcnt vmcnt(3)
  v_mfma_f32_16x16x32_bf16 v[28:31], v[48:51], v[24:27], v[28:31]
  v_bitop3_b32 v33, v33, v48, v49 bitop3:0x80
  v_bitop3_b32 v33, v33, v50, v51 bitop3:0x80
  s_waitcnt vmcnt(2)
  v_mfma_f32_16x16x32_bf16 v[28:31], v[52:55], v[24:27], v[28:31]
  v_bitop3_b32 v33, v33, v52, v53 bitop3:0x80
  v_bitop3_b32 v33, v33, v54, v55 bitop3:0x80
  s_waitcnt vmcnt(1)
  v_mfma_f32_16x16x32_bf16 v[28:31], v[56:59], v[24:27], v[28:31]
  v_bitop3_b32 v33, v33, v56, v57 bitop3:0x80
  v_bitop3_b32 v33, v33, v58, v59 bitop3:0x80
  s_waitcnt vmcnt(0)
  v_mfma_f32_16x16x32_bf16 v[28:31], v[60:63], v[24:27], v[28:31]
  v_bitop3_b32 v33, v33, v60, v61 bitop3:0x80
  v_bitop3_b32 v33, v33, v62, v63 bitop3:0x80
  v_and_b32 v33, 1, v33
  v_cmp_ne_u32 vcc, 1, v33
  s_cbranch_vccz H1_P_49
  s_cmp_gt_u32 s7, 0x40000
  s_cbranch_scc0 H1_F1_52
  s_branch H1_P_49
H1_H_48:
  v_lshrrev_b32 v34, 1, v0
  s_sleep 5
  s_cmp_eq_u32 s17, 1
  s_cbranch_scc1 H1_H1_54
H1_H0_53:
  buffer_load_dwordx2 v[8:9], v34, s[8:11], s5 offen offset:0 sc1
  buffer_load_dwordx2 v[10:11], v34, s[8:11], s5 offen offset:512 sc1
  buffer_load_dwordx2 v[12:13], v34, s[8:11], s5 offen offset:1024 sc1
  buffer_load_dwordx2 v[14:15], v34, s[8:11], s5 offen offset:1536 sc1
  buffer_load_dwordx2 v[16:17], v34, s[8:11], s5 offen offset:2048 sc1
  buffer_load_dwordx2 v[18:19], v34, s[8:11], s5 offen offset:2560 sc1
  buffer_load_dwordx2 v[20:21], v34, s[8:11], s5 offen offset:3072 sc1
  buffer_load_dwordx2 v[22:23], v34, s[8:11], s5 offen offset:3584 sc1
  s_add_u32 s7, s7, 1
  s_waitcnt vmcnt(7)
  v_mfma_f32_16x16x16_bf16 v[28:31], v[8:9], v[24:25], 0
  v_or_b32 v33, v8, v9
  s_waitcnt vmcnt(6)
  v_mfma_f32_16x16x16_bf16 v[28:31], v[10:11], v[24:25], v[28:31]
  v_bitop3_b32 v33, v33, v10, v11 bitop3:0xfe
  s_waitcnt vmcnt(5)
  v_mfma_f32_16x16x16_bf16 v[28:31], v[12:13], v[24:25], v[28:31]
  v_bitop3_b32 v33, v33, v12, v13 bitop3:0xfe
  s_waitcnt vmcnt(4)
  v_mfma_f32_16x16x16_bf16 v[28:31], v[14:15], v[24:25], v[28:31]
  v_bitop3_b32 v33, v33, v14, v15 bitop3:0xfe
  s_waitcnt vmcnt(3)
  v_mfma_f32_16x16x16_bf16 v[28:31], v[16:17], v[24:25], v[28:31]
  v_bitop3_b32 v33, v33, v16, v17 bitop3:0xfe
  s_waitcnt vmcnt(2)
  v_mfma_f32_16x16x16_bf16 v[28:31], v[18:19], v[24:25], v[28:31]
  v_bitop3_b32 v33, v33, v18, v19 bitop3:0xfe
  s_waitcnt vmcnt(1)
  v_mfma_f32_16x16x16_bf16 v[28:31], v[20:21], v[24:25], v[28:31]
  v_bitop3_b32 v33, v33, v20, v21 bitop3:0xfe
  s_waitcnt vmcnt(0)
  v_mfma_f32_16x16x16_bf16 v[28:31], v[22:23], v[24:25], v[28:31]
  v_bitop3_b32 v33, v33, v22, v23 bitop3:0xfe
  v_and_b32 v33, 1, v33
  v_cmp_ne_u32 vcc, 0, v33
  s_cbranch_vccz H1_P_49
  s_cmp_gt_u32 s7, 0x40000
  s_cbranch_scc0 H1_H0_53
  s_branch H1_P_49
H1_H1_54:
  buffer_load_dwordx2 v[8:9], v34, s[8:11], s5 offen offset:0 sc1
  buffer_load_dwordx2 v[10:11], v34, s[8:11], s5 offen offset:512 sc1
  buffer_load_dwordx2 v[12:13], v34, s[8:11], s5 offen offset:1024 sc1
  buffer_load_dwordx2 v[14:15], v34, s[8:11], s5 offen offset:1536 sc1
  buffer_load_dwordx2 v[16:17], v34, s[8:11], s5 offen offset:2048 sc1
  buffer_load_dwordx2 v[18:19], v34, s[8:11], s5 offen offset:2560 sc1
  buffer_load_dwordx2 v[20:21], v34, s[8:11], s5 offen offset:3072 sc1
  buffer_load_dwordx2 v[22:23], v34, s[8:11], s5 offen offset:3584 sc1
  s_add_u32 s7, s7, 1
  s_waitcnt vmcnt(7)
  v_mfma_f32_16x16x16_bf16 v[28:31], v[8:9], v[24:25], 0
  v_and_b32 v33, v8, v9
  s_waitcnt vmcnt(6)
  v_mfma_f32_16x16x16_bf16 v[28:31], v[10:11], v[24:25], v[28:31]
  v_bitop3_b32 v33, v33, v10, v11 bitop3:0x80
  s_waitcnt vmcnt(5)
  v_mfma_f32_16x16x16_bf16 v[28:31], v[12:13], v[24:25], v[28:31]
  v_bitop3_b32 v33, v33, v12, v13 bitop3:0x80
  s_waitcnt vmcnt(4)
  v_mfma_f32_16x16x16_bf16 v[28:31], v[14:15], v[24:25], v[28:31]
  v_bitop3_b32 v33, v33, v14, v15 bitop3:0x80
  s_waitcnt vmcnt(3)
  v_mfma_f32_16x16x16_bf16 v[28:31], v[16:17], v[24:25], v[28:31]
  v_bitop3_b32 v33, v33, v16, v17 bitop3:0x80
  s_waitcnt vmcnt(2)
  v_mfma_f32_16x16x16_bf16 v[28:31], v[18:19], v[24:25], v[28:31]
  v_bitop3_b32 v33, v33, v18, v19 bitop3:0x80
  s_waitcnt vmcnt(1)
  v_mfma_f32_16x16x16_bf16 v[28:31], v[20:21], v[24:25], v[28:31]
  v_bitop3_b32 v33, v33, v20, v21 bitop3:0x80
  s_waitcnt vmcnt(0)
  v_mfma_f32_16x16x16_bf16 v[28:31], v[22:23], v[24:25], v[28:31]
  v_bitop3_b32 v33, v33, v22, v23 bitop3:0x80
  v_and_b32 v33, 1, v33
  v_cmp_ne_u32 vcc, 1, v33
  s_cbranch_vccz H1_P_49
  s_cmp_gt_u32 s7, 0x40000
  s_cbranch_scc0 H1_H1_54
  s_branch H1_P_49
H1_P_49:
  s_nop 4
  v_cvt_pk_bf16_f32 v8, v28, v29
  v_cvt_pk_bf16_f32 v9, v30, v31
  v_min_u32 v8, 0xfffffffe, v8
  v_min_u32 v9, 0xfffffffe, v9
  s_add_u32 s5, s37, s53
  s_mov_b64 exec, s[90:91]
  buffer_store_dwordx2 v[8:9], v32, s[8:11], s5 offen sc1
  v_mov_b32 v10, -1
  v_mov_b32 v11, -1
  s_add_u32 s5, s38, s53
  buffer_store_dwordx2 v[10:11], v32, s[8:11], s5 offen sc1
  s_mov_b64 exec, -1
HP_POLL_42:
  s_barrier
  s_lshl_b32 s4, s28, 1
  s_cmp_eq_u32 s28, 3
  s_cselect_b32 s4, 7, s4
  s_lshl_b32 s4, s4, 10
  s_add_u32 s5, s37, s4
  v_add_u32 v9, s4, v0
  s_mov_b32 s7, 0
  s_cmp_ge_u32 s28, 2
  s_cbranch_scc1 H2_3_55
H2_2_56:
  buffer_load_dwordx4 v[56:59], v0, s[8:11], s5 offen offset:0 sc1
  buffer_load_dwordx4 v[60:63], v0, s[8:11], s5 offen offset:1024 sc1
  s_sleep 2
H2_L_58:
  buffer_load_dwordx4 v[68:71], v0, s[8:11], s5 offen offset:0 sc1
  buffer_load_dwordx4 v[72:75], v0, s[8:11], s5 offen offset:1024 sc1
  s_waitcnt vmcnt(2)
  v_max3_u32 v8, v56, v57, v58
  v_max3_u32 v8, v8, v59, v60
  v_max3_u32 v8, v8, v61, v62
  v_max_u32 v8, v8, v63
  v_cmp_eq_u32 vcc, -1, v8
  s_cbranch_vccz H2_A_59
  buffer_load_dwordx4 v[56:59], v0, s[8:11], s5 offen offset:0 sc1
  buffer_load_dwordx4 v[60:63], v0, s[8:11], s5 offen offset:1024 sc1
  s_waitcnt vmcnt(2)
  v_max3_u32 v8, v68, v69, v70
  v_max3_u32 v8, v8, v71, v72
  v_max3_u32 v8, v8, v73, v74
  v_max_u32 v8, v8, v75
  v_cmp_eq_u32 vcc, -1, v8
  s_cbranch_vccz H2_B_60
  s_add_u32 s7, s7, 1
  s_cmp_gt_u32 s7, 0x40000
  s_cbranch_scc0 H2_L_58
  s_waitcnt vmcnt(0)
H2_A_59:
  ds_write_b128 v9, v[56:59] offset:6144
  ds_write_b128 v9, v[60:63] offset:7168
  s_branch H2_D_57
H2_B_60:
  ds_write_b128 v9, v[68:71] offset:6144
  ds_write_b128 v9, v[72:75] offset:7168
  s_branch H2_D_57
H2_3_55:
  buffer_load_dwordx4 v[56:59], v0, s[8:11], s5 offen offset:0 sc1
  buffer_load_dwordx4 v[60:63], v0, s[8:11], s5 offen offset:1024 sc1
  buffer_load_dwordx4 v[64:67], v0, s[8:11], s5 offen offset:2048 sc1
  s_sleep 2
H2_L_61:
  buffer_load_dwordx4 v[68:71], v0, s[8:11], s5 offen offset:0 sc1
  buffer_load_dwordx4 v[72:75], v0, s[8:11], s5 offen offset:1024 sc1
  buffer_load_dwordx4 v[76:79], v0, s[8:11], s5 offen offset:2048 sc1
  s_waitcnt vmcnt(3)
  v_max3_u32 v8, v56, v57, v58
  v_max3_u32 v8, v8, v59, v60
  v_max3_u32 v8, v8, v61, v62
  v_max3_u32 v8, v8, v63, v64
  v_max3_u32 v8, v8, v65, v66
  v_max_u32 v8, v8, v67
  v_cmp_eq_u32 vcc, -1, v8
  s_cbranch_vccz H2_A_62
  buffer_load_dwordx4 v[56:59], v0, s[8:11], s5 offen offset:0 sc1
  buffer_load_dwordx4 v[60:63], v0, s[8:11], s5 offen offset:1024 sc1
  buffer_load_dwordx4 v[64:67], v0, s[8:11], s5 offen offset:2048 sc1
  s_waitcnt vmcnt(3)
  v_max3_u32 v8, v68, v69, v70
  v_max3_u32 v8, v8, v71, v72
  v_max3_u32 v8, v8, v73, v74
  v_max3_u32 v8, v8, v75, v76
  v_max3_u32 v8, v8, v77, v78
  v_max_u32 v8, v8, v79
  v_cmp_eq_u32 vcc, -1, v8
  s_cbranch_vccz H2_B_63
  s_add_u32 s7, s7, 1
  s_cmp_gt_u32 s7, 0x40000
  s_cbranch_scc0 H2_L_61
  s_waitcnt vmcnt(0)
H2_A_62:
  ds_write_b128 v9, v[56:59] offset:6144
  ds_write_b128 v9, v[60:63] offset:7168
  ds_write_b128 v9, v[64:67] offset:8192
  s_branch H2_D_57
H2_B_63:
  ds_write_b128 v9, v[68:71] offset:6144
  ds_write_b128 v9, v[72:75] offset:7168
  ds_write_b128 v9, v[76:79] offset:8192
  s_branch H2_D_57
H2_D_57:
  buffer_load_dwordx4 v[48:51], v0, s[8:11], s39 offen offset:0
  buffer_load_dwordx4 v[52:55], v0, s[8:11], s39 offen offset:1024
  s_add_u32 s32, s32, 1
  s_add_u32 s33, s33, 524288
  s_add_u32 s34, s34, 131072
  s_add_u32 s15, s15, 524288
  s_xor_b32 s17, s17, 1
  s_mov_b32 s88, s38
  s_mov_b32 s38, s37
  s_add_u32 s37, s37, 16384
  s_sub_u32 s5, s37, s57
  s_cmp_eq_u32 s5, 49152
  s_cselect_b32 s37, s57, s37
  s_waitcnt lgkmcnt(0)
  s_barrier
  s_branch CH_LOOP_40
CH_END_12:
  s_branch L_END
L_KV:
  s_mul_i32 s4, s26, 56
  s_add_u32 s30, s0, s4
  s_addc_u32 s31, s1, 0
  s_cmp_eq_u32 s26, 0
  s_cselect_b32 s4, s64, s78
  s_cselect_b32 s5, s65, s79
  s_mov_b32 s12, s4
  s_and_b32 s13, s5, 0xffff
  s_mov_b32 s14, 0x280000
  s_mov_b32 s15, 0x20000
  s_cmp_eq_u32 s26, 0
  s_cselect_b32 s4, s70, s84
  s_cselect_b32 s5, s71, s85
  s_cmp_eq_u32 s26, 0
  s_cselect_b32 s6, s72, s86
  s_cselect_b32 s7, s73, s87
  s_cmp_ge_u32 s28, 2
  s_cselect_b32 s4, s6, s4
  s_cselect_b32 s5, s7, s5
  s_mov_b32 s16, s4
  s_and_b32 s17, s5, 0xffff
  s_mov_b32 s18, 0x500000
  s_mov_b32 s19, 0x20000
  s_lshl_b32 s4, s26, 5
  s_add_u32 s4, s4, s27
  s_lshl_b32 s4, s4, 7
  s_add_u32 s4, s4, 166723584
  v_mov_b32 v12, 0
  v_mov_b32 v13, 0
  s_mov_b64 exec, 1
  buffer_store_dword v12, v13, s[8:11], s4 offen sc1
  s_mov_b64 exec, -1
  v_lshrrev_b32 v12, 4, v2
  v_lshlrev_b32 v13, 2, v12
  v_and_b32 v14, 15, v2
  v_xor_b32 v13, v13, v14
  v_lshlrev_b32 v13, 4, v13
  v_lshl_add_u32 v9, v12, 13, v13
  s_and_b32 s42, s28, 1
  s_lshl_b32 s40, s27, 8
  s_lshl_b32 s43, s42, 18
  s_add_u32 s40, s40, s43
  s_lshr_b32 s41, s28, 1
  s_lshl_b32 s41, s41, 14
  s_lshl_b32 s43, s42, 13
  s_add_u32 s41, s41, s43
  s_add_u32 m0, s41, 0
  s_add_u32 s5, s40, 0
  buffer_load_dwordx4 v9, s[16:19], s5 offen lds
  s_add_u32 m0, s41, 1024
  s_add_u32 s5, s40, 32768
  buffer_load_dwordx4 v9, s[16:19], s5 offen lds
  s_add_u32 m0, s41, 2048
  s_add_u32 s5, s40, 65536
  buffer_load_dwordx4 v9, s[16:19], s5 offen lds
  s_add_u32 m0, s41, 3072
  s_add_u32 s5, s40, 98304
  buffer_load_dwordx4 v9, s[16:19], s5 offen lds
  s_add_u32 m0, s41, 4096
  s_add_u32 s5, s40, 131072
  buffer_load_dwordx4 v9, s[16:19], s5 offen lds
  s_add_u32 m0, s41, 5120
  s_add_u32 s5, s40, 163840
  buffer_load_dwordx4 v9, s[16:19], s5 offen lds
  s_add_u32 m0, s41, 6144
  s_add_u32 s5, s40, 196608
  buffer_load_dwordx4 v9, s[16:19], s5 offen lds
  s_add_u32 m0, s41, 7168
  s_add_u32 s5, s40, 229376
  buffer_load_dwordx4 v9, s[16:19], s5 offen lds
  s_add_u32 m0, s41, 32768
  s_add_u32 s5, s40, 524288
  buffer_load_dwordx4 v9, s[16:19], s5 offen lds
  s_add_u32 m0, s41, 33792
  s_add_u32 s5, s40, 557056
  buffer_load_dwordx4 v9, s[16:19], s5 offen lds
  s_add_u32 m0, s41, 34816
  s_add_u32 s5, s40, 589824
  buffer_load_dwordx4 v9, s[16:19], s5 offen lds
  s_add_u32 m0, s41, 35840
  s_add_u32 s5, s40, 622592
  buffer_load_dwordx4 v9, s[16:19], s5 offen lds
  s_add_u32 m0, s41, 36864
  s_add_u32 s5, s40, 655360
  buffer_load_dwordx4 v9, s[16:19], s5 offen lds
  s_add_u32 m0, s41, 37888
  s_add_u32 s5, s40, 688128
  buffer_load_dwordx4 v9, s[16:19], s5 offen lds
  s_add_u32 m0, s41, 38912
  s_add_u32 s5, s40, 720896
  buffer_load_dwordx4 v9, s[16:19], s5 offen lds
  s_add_u32 m0, s41, 39936
  s_add_u32 s5, s40, 753664
  buffer_load_dwordx4 v9, s[16:19], s5 offen lds
  s_lshl_b32 s4, s28, 3
  v_lshrrev_b32 v12, 3, v2
  v_add_u32 v12, s4, v12
  v_bfe_u32 v13, v12, 1, 3
  v_and_b32 v3, 7, v2
  v_xor_b32 v13, v13, v3
  v_lshlrev_b32 v13, 4, v13
  v_mul_u32_u24 v12, 1280, v12
  v_add_u32 v3, v12, v13
  v_bfe_u32 v12, v2, 4, 1
  v_lshlrev_b32 v12, 10, v12
  v_lshrrev_b32 v13, 5, v2
  v_lshl_add_u32 v12, v13, 9, v12
  v_and_b32 v13, 15, v2
  v_lshl_add_u32 v8, v13, 4, v12
  s_cmp_ge_u32 s28, 2
  s_cbranch_scc1 KV_V_65
  v_bfe_u32 v12, v2, 4, 1
  v_and_b32 v13, 1, v2
  v_bfe_u32 v14, v2, 1, 1
  v_lshl_or_b32 v12, v13, 1, v12
  v_lshlrev_b32 v13, 3, v14
  s_and_b32 s42, s28, 1
  s_lshl_b32 s42, s42, 3
  v_or_b32 v12, s42, v12
  v_bfe_u32 v14, v2, 2, 2
  v_lshlrev_b32 v11, 2, v14
  v_xor_b32 v12, v12, v11
  v_lshl_add_u32 v13, v12, 4, v13
  v_lshl_add_u32 v13, v14, 8, v13
  v_lshrrev_b32 v14, 5, v2
  v_lshl_add_u32 v13, v14, 11, v13
  s_lshr_b32 s42, s28, 1
  s_lshl_b32 s42, s42, 14
  v_add_u32 v10, s42, v13
  v_xor_b32 v11, 64, v10
  s_waitcnt vmcnt(8) lgkmcnt(0)
  s_barrier
  v_mov_b32 v12, 32
  v_mov_b32 v13, 1
  s_cmp_eq_u32 s28, 0
  s_cselect_b64 exec, 1, 0
  global_atomic_add v12, v13, s[24:25]
  s_mov_b64 exec, -1
  ds_read_b64_tr_b16 a[0:1], v10 offset:0
  ds_read_b64_tr_b16 a[2:3], v10 offset:1024
  ds_read_b64_tr_b16 a[160:161], v11 offset:0
  ds_read_b64_tr_b16 a[162:163], v11 offset:1024
  ds_read_b64_tr_b16 a[4:5], v10 offset:4096
  ds_read_b64_tr_b16 a[6:7], v10 offset:5120
  ds_read_b64_tr_b16 a[164:165], v11 offset:4096
  ds_read_b64_tr_b16 a[166:167], v11 offset:5120
  ds_read_b64_tr_b16 a[8:9], v10 offset:8192
  ds_read_b64_tr_b16 a[10:11], v10 offset:9216
  ds_read_b64_tr_b16 a[168:169], v11 offset:8192
  ds_read_b64_tr_b16 a[170:171], v11 offset:9216
  ds_read_b64_tr_b16 a[12:13], v10 offset:12288
  ds_read_b64_tr_b16 a[14:15], v10 offset:13312
  ds_read_b64_tr_b16 a[172:173], v11 offset:12288
  ds_read_b64_tr_b16 a[174:175], v11 offset:13312
  s_waitcnt vmcnt(1) lgkmcnt(0)
  s_barrier
  s_add_u32 m0, s41, 65536
  s_add_u32 s5, s40, 1048576
  buffer_load_dwordx4 v9, s[16:19], s5 offen lds
  s_add_u32 m0, s41, 66560
  s_add_u32 s5, s40, 1081344
  buffer_load_dwordx4 v9, s[16:19], s5 offen lds
  s_add_u32 m0, s41, 67584
  s_add_u32 s5, s40, 1114112
  buffer_load_dwordx4 v9, s[16:19], s5 offen lds
  s_add_u32 m0, s41, 68608
  s_add_u32 s5, s40, 1146880
  buffer_load_dwordx4 v9, s[16:19], s5 offen lds
  s_add_u32 m0, s41, 69632
  s_add_u32 s5, s40, 1179648
  buffer_load_dwordx4 v9, s[16:19], s5 offen lds
  s_add_u32 m0, s41, 70656
  s_add_u32 s5, s40, 1212416
  buffer_load_dwordx4 v9, s[16:19], s5 offen lds
  s_add_u32 m0, s41, 71680
  s_add_u32 s5, s40, 1245184
  buffer_load_dwordx4 v9, s[16:19], s5 offen lds
  s_add_u32 m0, s41, 72704
  s_add_u32 s5, s40, 1277952
  buffer_load_dwordx4 v9, s[16:19], s5 offen lds
  v_add_u32 v10, 32768, v10
  v_add_u32 v11, 32768, v11
  ds_read_b64_tr_b16 a[16:17], v10 offset:0
  ds_read_b64_tr_b16 a[18:19], v10 offset:1024
  ds_read_b64_tr_b16 a[176:177], v11 offset:0
  ds_read_b64_tr_b16 a[178:179], v11 offset:1024
  ds_read_b64_tr_b16 a[20:21], v10 offset:4096
  ds_read_b64_tr_b16 a[22:23], v10 offset:5120
  ds_read_b64_tr_b16 a[180:181], v11 offset:4096
  ds_read_b64_tr_b16 a[182:183], v11 offset:5120
  ds_read_b64_tr_b16 a[24:25], v10 offset:8192
  ds_read_b64_tr_b16 a[26:27], v10 offset:9216
  ds_read_b64_tr_b16 a[184:185], v11 offset:8192
  ds_read_b64_tr_b16 a[186:187], v11 offset:9216
  ds_read_b64_tr_b16 a[28:29], v10 offset:12288
  ds_read_b64_tr_b16 a[30:31], v10 offset:13312
  ds_read_b64_tr_b16 a[188:189], v11 offset:12288
  ds_read_b64_tr_b16 a[190:191], v11 offset:13312
  s_waitcnt vmcnt(0) lgkmcnt(0)
  s_barrier
  s_add_u32 m0, s41, 98304
  s_add_u32 s5, s40, 1572864
  buffer_load_dwordx4 v9, s[16:19], s5 offen lds
  s_add_u32 m0, s41, 99328
  s_add_u32 s5, s40, 1605632
  buffer_load_dwordx4 v9, s[16:19], s5 offen lds
  s_add_u32 m0, s41, 100352
  s_add_u32 s5, s40, 1638400
  buffer_load_dwordx4 v9, s[16:19], s5 offen lds
  s_add_u32 m0, s41, 101376
  s_add_u32 s5, s40, 1671168
  buffer_load_dwordx4 v9, s[16:19], s5 offen lds
  s_add_u32 m0, s41, 102400
  s_add_u32 s5, s40, 1703936
  buffer_load_dwordx4 v9, s[16:19], s5 offen lds
  s_add_u32 m0, s41, 103424
  s_add_u32 s5, s40, 1736704
  buffer_load_dwordx4 v9, s[16:19], s5 offen lds
  s_add_u32 m0, s41, 104448
  s_add_u32 s5, s40, 1769472
  buffer_load_dwordx4 v9, s[16:19], s5 offen lds
  s_add_u32 m0, s41, 105472
  s_add_u32 s5, s40, 1802240
  buffer_load_dwordx4 v9, s[16:19], s5 offen lds
  v_add_u32 v10, 32768, v10
  v_add_u32 v11, 32768, v11
  ds_read_b64_tr_b16 a[32:33], v10 offset:0
  ds_read_b64_tr_b16 a[34:35], v10 offset:1024
  ds_read_b64_tr_b16 a[192:193], v11 offset:0
  ds_read_b64_tr_b16 a[194:195], v11 offset:1024
  ds_read_b64_tr_b16 a[36:37], v10 offset:4096
  ds_read_b64_tr_b16 a[38:39], v10 offset:5120
  ds_read_b64_tr_b16 a[196:197], v11 offset:4096
  ds_read_b64_tr_b16 a[198:199], v11 offset:5120
  ds_read_b64_tr_b16 a[40:41], v10 offset:8192
  ds_read_b64_tr_b16 a[42:43], v10 offset:9216
  ds_read_b64_tr_b16 a[200:201], v11 offset:8192
  ds_read_b64_tr_b16 a[202:203], v11 offset:9216
  ds_read_b64_tr_b16 a[44:45], v10 offset:12288
  ds_read_b64_tr_b16 a[46:47], v10 offset:13312
  ds_read_b64_tr_b16 a[204:205], v11 offset:12288
  ds_read_b64_tr_b16 a[206:207], v11 offset:13312
  s_waitcnt vmcnt(0) lgkmcnt(0)
  s_barrier
  s_add_u32 m0, s41, 0
  s_add_u32 s5, s40, 2097152
  buffer_load_dwordx4 v9, s[16:19], s5 offen lds
  s_add_u32 m0, s41, 1024
  s_add_u32 s5, s40, 2129920
  buffer_load_dwordx4 v9, s[16:19], s5 offen lds
  s_add_u32 m0, s41, 2048
  s_add_u32 s5, s40, 2162688
  buffer_load_dwordx4 v9, s[16:19], s5 offen lds
  s_add_u32 m0, s41, 3072
  s_add_u32 s5, s40, 2195456
  buffer_load_dwordx4 v9, s[16:19], s5 offen lds
  s_add_u32 m0, s41, 4096
  s_add_u32 s5, s40, 2228224
  buffer_load_dwordx4 v9, s[16:19], s5 offen lds
  s_add_u32 m0, s41, 5120
  s_add_u32 s5, s40, 2260992
  buffer_load_dwordx4 v9, s[16:19], s5 offen lds
  s_add_u32 m0, s41, 6144
  s_add_u32 s5, s40, 2293760
  buffer_load_dwordx4 v9, s[16:19], s5 offen lds
  s_add_u32 m0, s41, 7168
  s_add_u32 s5, s40, 2326528
  buffer_load_dwordx4 v9, s[16:19], s5 offen lds
  v_add_u32 v10, 32768, v10
  v_add_u32 v11, 32768, v11
  ds_read_b64_tr_b16 a[48:49], v10 offset:0
  ds_read_b64_tr_b16 a[50:51], v10 offset:1024
  ds_read_b64_tr_b16 a[208:209], v11 offset:0
  ds_read_b64_tr_b16 a[210:211], v11 offset:1024
  ds_read_b64_tr_b16 a[52:53], v10 offset:4096
  ds_read_b64_tr_b16 a[54:55], v10 offset:5120
  ds_read_b64_tr_b16 a[212:213], v11 offset:4096
  ds_read_b64_tr_b16 a[214:215], v11 offset:5120
  ds_read_b64_tr_b16 a[56:57], v10 offset:8192
  ds_read_b64_tr_b16 a[58:59], v10 offset:9216
  ds_read_b64_tr_b16 a[216:217], v11 offset:8192
  ds_read_b64_tr_b16 a[218:219], v11 offset:9216
  ds_read_b64_tr_b16 a[60:61], v10 offset:12288
  ds_read_b64_tr_b16 a[62:63], v10 offset:13312
  ds_read_b64_tr_b16 a[220:221], v11 offset:12288
  ds_read_b64_tr_b16 a[222:223], v11 offset:13312
  s_waitcnt vmcnt(0) lgkmcnt(0)
  s_barrier
  s_add_u32 m0, s41, 32768
  s_add_u32 s5, s40, 2621440
  buffer_load_dwordx4 v9, s[16:19], s5 offen lds
  s_add_u32 m0, s41, 33792
  s_add_u32 s5, s40, 2654208
  buffer_load_dwordx4 v9, s[16:19], s5 offen lds
  s_add_u32 m0, s41, 34816
  s_add_u32 s5, s40, 2686976
  buffer_load_dwordx4 v9, s[16:19], s5 offen lds
  s_add_u32 m0, s41, 35840
  s_add_u32 s5, s40, 2719744
  buffer_load_dwordx4 v9, s[16:19], s5 offen lds
  s_add_u32 m0, s41, 36864
  s_add_u32 s5, s40, 2752512
  buffer_load_dwordx4 v9, s[16:19], s5 offen lds
  s_add_u32 m0, s41, 37888
  s_add_u32 s5, s40, 2785280
  buffer_load_dwordx4 v9, s[16:19], s5 offen lds
  s_add_u32 m0, s41, 38912
  s_add_u32 s5, s40, 2818048
  buffer_load_dwordx4 v9, s[16:19], s5 offen lds
  s_add_u32 m0, s41, 39936
  s_add_u32 s5, s40, 2850816
  buffer_load_dwordx4 v9, s[16:19], s5 offen lds
  v_subrev_u32 v10, 98304, v10
  v_subrev_u32 v11, 98304, v11
  ds_read_b64_tr_b16 a[64:65], v10 offset:0
  ds_read_b64_tr_b16 a[66:67], v10 offset:1024
  ds_read_b64_tr_b16 a[224:225], v11 offset:0
  ds_read_b64_tr_b16 a[226:227], v11 offset:1024
  ds_read_b64_tr_b16 a[68:69], v10 offset:4096
  ds_read_b64_tr_b16 a[70:71], v10 offset:5120
  ds_read_b64_tr_b16 a[228:229], v11 offset:4096
  ds_read_b64_tr_b16 a[230:231], v11 offset:5120
  ds_read_b64_tr_b16 a[72:73], v10 offset:8192
  ds_read_b64_tr_b16 a[74:75], v10 offset:9216
  ds_read_b64_tr_b16 a[232:233], v11 offset:8192
  ds_read_b64_tr_b16 a[234:235], v11 offset:9216
  ds_read_b64_tr_b16 a[76:77], v10 offset:12288
  ds_read_b64_tr_b16 a[78:79], v10 offset:13312
  ds_read_b64_tr_b16 a[236:237], v11 offset:12288
  ds_read_b64_tr_b16 a[238:239], v11 offset:13312
  s_waitcnt vmcnt(0) lgkmcnt(0)
  s_barrier
  s_add_u32 m0, s41, 65536
  s_add_u32 s5, s40, 3145728
  buffer_load_dwordx4 v9, s[16:19], s5 offen lds
  s_add_u32 m0, s41, 66560
  s_add_u32 s5, s40, 3178496
  buffer_load_dwordx4 v9, s[16:19], s5 offen lds
  s_add_u32 m0, s41, 67584
  s_add_u32 s5, s40, 3211264
  buffer_load_dwordx4 v9, s[16:19], s5 offen lds
  s_add_u32 m0, s41, 68608
  s_add_u32 s5, s40, 3244032
  buffer_load_dwordx4 v9, s[16:19], s5 offen lds
  s_add_u32 m0, s41, 69632
  s_add_u32 s5, s40, 3276800
  buffer_load_dwordx4 v9, s[16:19], s5 offen lds
  s_add_u32 m0, s41, 70656
  s_add_u32 s5, s40, 3309568
  buffer_load_dwordx4 v9, s[16:19], s5 offen lds
  s_add_u32 m0, s41, 71680
  s_add_u32 s5, s40, 3342336
  buffer_load_dwordx4 v9, s[16:19], s5 offen lds
  s_add_u32 m0, s41, 72704
  s_add_u32 s5, s40, 3375104
  buffer_load_dwordx4 v9, s[16:19], s5 offen lds
  v_add_u32 v10, 32768, v10
  v_add_u32 v11, 32768, v11
  ds_read_b64_tr_b16 a[80:81], v10 offset:0
  ds_read_b64_tr_b16 a[82:83], v10 offset:1024
  ds_read_b64_tr_b16 a[240:241], v11 offset:0
  ds_read_b64_tr_b16 a[242:243], v11 offset:1024
  ds_read_b64_tr_b16 a[84:85], v10 offset:4096
  ds_read_b64_tr_b16 a[86:87], v10 offset:5120
  ds_read_b64_tr_b16 a[244:245], v11 offset:4096
  ds_read_b64_tr_b16 a[246:247], v11 offset:5120
  ds_read_b64_tr_b16 a[88:89], v10 offset:8192
  ds_read_b64_tr_b16 a[90:91], v10 offset:9216
  ds_read_b64_tr_b16 a[248:249], v11 offset:8192
  ds_read_b64_tr_b16 a[250:251], v11 offset:9216
  ds_read_b64_tr_b16 a[92:93], v10 offset:12288
  ds_read_b64_tr_b16 a[94:95], v10 offset:13312
  ds_read_b64_tr_b16 a[252:253], v11 offset:12288
  ds_read_b64_tr_b16 a[254:255], v11 offset:13312
  s_waitcnt vmcnt(0) lgkmcnt(0)
  s_barrier
  s_add_u32 m0, s41, 98304
  s_add_u32 s5, s40, 3670016
  buffer_load_dwordx4 v9, s[16:19], s5 offen lds
  s_add_u32 m0, s41, 99328
  s_add_u32 s5, s40, 3702784
  buffer_load_dwordx4 v9, s[16:19], s5 offen lds
  s_add_u32 m0, s41, 100352
  s_add_u32 s5, s40, 3735552
  buffer_load_dwordx4 v9, s[16:19], s5 offen lds
  s_add_u32 m0, s41, 101376
  s_add_u32 s5, s40, 3768320
  buffer_load_dwordx4 v9, s[16:19], s5 offen lds
  s_add_u32 m0, s41, 102400
  s_add_u32 s5, s40, 3801088
  buffer_load_dwordx4 v9, s[16:19], s5 offen lds
  s_add_u32 m0, s41, 103424
  s_add_u32 s5, s40, 3833856
  buffer_load_dwordx4 v9, s[16:19], s5 offen lds
  s_add_u32 m0, s41, 104448
  s_add_u32 s5, s40, 3866624
  buffer_load_dwordx4 v9, s[16:19], s5 offen lds
  s_add_u32 m0, s41, 105472
  s_add_u32 s5, s40, 3899392
  buffer_load_dwordx4 v9, s[16:19], s5 offen lds
  v_add_u32 v10, 32768, v10
  v_add_u32 v11, 32768, v11
  ds_read_b64_tr_b16 a[96:97], v10 offset:0
  ds_read_b64_tr_b16 a[98:99], v10 offset:1024
  ds_read_b64_tr_b16 v[192:193], v11 offset:0
  ds_read_b64_tr_b16 v[194:195], v11 offset:1024
  ds_read_b64_tr_b16 a[100:101], v10 offset:4096
  ds_read_b64_tr_b16 a[102:103], v10 offset:5120
  ds_read_b64_tr_b16 v[196:197], v11 offset:4096
  ds_read_b64_tr_b16 v[198:199], v11 offset:5120
  ds_read_b64_tr_b16 a[104:105], v10 offset:8192
  ds_read_b64_tr_b16 a[106:107], v10 offset:9216
  ds_read_b64_tr_b16 v[200:201], v11 offset:8192
  ds_read_b64_tr_b16 v[202:203], v11 offset:9216
  ds_read_b64_tr_b16 a[108:109], v10 offset:12288
  ds_read_b64_tr_b16 a[110:111], v10 offset:13312
  ds_read_b64_tr_b16 v[204:205], v11 offset:12288
  ds_read_b64_tr_b16 v[206:207], v11 offset:13312
  s_waitcnt vmcnt(0) lgkmcnt(0)
  s_barrier
  s_add_u32 m0, s41, 0
  s_add_u32 s5, s40, 4194304
  buffer_load_dwordx4 v9, s[16:19], s5 offen lds
  s_add_u32 m0, s41, 1024
  s_add_u32 s5, s40, 4227072
  buffer_load_dwordx4 v9, s[16:19], s5 offen lds
  s_add_u32 m0, s41, 2048
  s_add_u32 s5, s40, 4259840
  buffer_load_dwordx4 v9, s[16:19], s5 offen lds
  s_add_u32 m0, s41, 3072
  s_add_u32 s5, s40, 4292608
  buffer_load_dwordx4 v9, s[16:19], s5 offen lds
  s_add_u32 m0, s41, 4096
  s_add_u32 s5, s40, 4325376
  buffer_load_dwordx4 v9, s[16:19], s5 offen lds
  s_add_u32 m0, s41, 5120
  s_add_u32 s5, s40, 4358144
  buffer_load_dwordx4 v9, s[16:19], s5 offen lds
  s_add_u32 m0, s41, 6144
  s_add_u32 s5, s40, 4390912
  buffer_load_dwordx4 v9, s[16:19], s5 offen lds
  s_add_u32 m0, s41, 7168
  s_add_u32 s5, s40, 4423680
  buffer_load_dwordx4 v9, s[16:19], s5 offen lds
  v_add_u32 v10, 32768, v10
  v_add_u32 v11, 32768, v11
  ds_read_b64_tr_b16 a[112:113], v10 offset:0
  ds_read_b64_tr_b16 a[114:115], v10 offset:1024
  ds_read_b64_tr_b16 v[208:209], v11 offset:0
  ds_read_b64_tr_b16 v[210:211], v11 offset:1024
  ds_read_b64_tr_b16 a[116:117], v10 offset:4096
  ds_read_b64_tr_b16 a[118:119], v10 offset:5120
  ds_read_b64_tr_b16 v[212:213], v11 offset:4096
  ds_read_b64_tr_b16 v[214:215], v11 offset:5120
  ds_read_b64_tr_b16 a[120:121], v10 offset:8192
  ds_read_b64_tr_b16 a[122:123], v10 offset:9216
  ds_read_b64_tr_b16 v[216:217], v11 offset:8192
  ds_read_b64_tr_b16 v[218:219], v11 offset:9216
  ds_read_b64_tr_b16 a[124:125], v10 offset:12288
  ds_read_b64_tr_b16 a[126:127], v10 offset:13312
  ds_read_b64_tr_b16 v[220:221], v11 offset:12288
  ds_read_b64_tr_b16 v[222:223], v11 offset:13312
  s_waitcnt vmcnt(0) lgkmcnt(0)
  s_barrier
  s_add_u32 m0, s41, 32768
  s_add_u32 s5, s40, 4718592
  buffer_load_dwordx4 v9, s[16:19], s5 offen lds
  s_add_u32 m0, s41, 33792
  s_add_u32 s5, s40, 4751360
  buffer_load_dwordx4 v9, s[16:19], s5 offen lds
  s_add_u32 m0, s41, 34816
  s_add_u32 s5, s40, 4784128
  buffer_load_dwordx4 v9, s[16:19], s5 offen lds
  s_add_u32 m0, s41, 35840
  s_add_u32 s5, s40, 4816896
  buffer_load_dwordx4 v9, s[16:19], s5 offen lds
  s_add_u32 m0, s41, 36864
  s_add_u32 s5, s40, 4849664
  buffer_load_dwordx4 v9, s[16:19], s5 offen lds
  s_add_u32 m0, s41, 37888
  s_add_u32 s5, s40, 4882432
  buffer_load_dwordx4 v9, s[16:19], s5 offen lds
  s_add_u32 m0, s41, 38912
  s_add_u32 s5, s40, 4915200
  buffer_load_dwordx4 v9, s[16:19], s5 offen lds
  s_add_u32 m0, s41, 39936
  s_add_u32 s5, s40, 4947968
  buffer_load_dwordx4 v9, s[16:19], s5 offen lds
  v_subrev_u32 v10, 98304, v10
  v_subrev_u32 v11, 98304, v11
  ds_read_b64_tr_b16 a[128:129], v10 offset:0
  ds_read_b64_tr_b16 a[130:131], v10 offset:1024
  ds_read_b64_tr_b16 v[224:225], v11 offset:0
  ds_read_b64_tr_b16 v[226:227], v11 offset:1024
  ds_read_b64_tr_b16 a[132:133], v10 offset:4096
  ds_read_b64_tr_b16 a[134:135], v10 offset:5120
  ds_read_b64_tr_b16 v[228:229], v11 offset:4096
  ds_read_b64_tr_b16 v[230:231], v11 offset:5120
  ds_read_b64_tr_b16 a[136:137], v10 offset:8192
  ds_read_b64_tr_b16 a[138:139], v10 offset:9216
  ds_read_b64_tr_b16 v[232:233], v11 offset:8192
  ds_read_b64_tr_b16 v[234:235], v11 offset:9216
  ds_read_b64_tr_b16 a[140:141], v10 offset:12288
  ds_read_b64_tr_b16 a[142:143], v10 offset:13312
  ds_read_b64_tr_b16 v[236:237], v11 offset:12288
  ds_read_b64_tr_b16 v[238:239], v11 offset:13312
  s_waitcnt vmcnt(0) lgkmcnt(0)
  s_barrier
  v_add_u32 v10, 32768, v10
  v_add_u32 v11, 32768, v11
  ds_read_b64_tr_b16 a[144:145], v10 offset:0
  ds_read_b64_tr_b16 a[146:147], v10 offset:1024
  ds_read_b64_tr_b16 v[240:241], v11 offset:0
  ds_read_b64_tr_b16 v[242:243], v11 offset:1024
  ds_read_b64_tr_b16 a[148:149], v10 offset:4096
  ds_read_b64_tr_b16 a[150:151], v10 offset:5120
  ds_read_b64_tr_b16 v[244:245], v11 offset:4096
  ds_read_b64_tr_b16 v[246:247], v11 offset:5120
  ds_read_b64_tr_b16 a[152:153], v10 offset:8192
  ds_read_b64_tr_b16 a[154:155], v10 offset:9216
  ds_read_b64_tr_b16 v[248:249], v11 offset:8192
  ds_read_b64_tr_b16 v[250:251], v11 offset:9216
  ds_read_b64_tr_b16 a[156:157], v10 offset:12288
  ds_read_b64_tr_b16 a[158:159], v10 offset:13312
  ds_read_b64_tr_b16 v[252:253], v11 offset:12288
  ds_read_b64_tr_b16 v[254:255], v11 offset:13312
  s_waitcnt vmcnt(0) lgkmcnt(0)
  s_barrier
  v_and_b32 v12, 31, v2
  v_lshrrev_b32 v13, 3, v12
  v_mul_u32_u24 v13, 10240, v13
  v_and_b32 v14, 7, v12
  v_lshl_add_u32 v13, v14, 7, v13
  v_bfe_u32 v14, v12, 1, 3
  v_lshrrev_b32 v12, 5, v2
  v_xor_b32 v14, v14, v12
  v_xor_b32 v12, 0, v14
  v_lshl_add_u32 v4, v12, 4, v13
  v_xor_b32 v12, 2, v14
  v_lshl_add_u32 v5, v12, 4, v13
  v_xor_b32 v12, 4, v14
  v_lshl_add_u32 v6, v12, 4, v13
  v_xor_b32 v12, 6, v14
  v_lshl_add_u32 v7, v12, 4, v13
  s_mul_i32 s45, s28, 10240
  s_mov_b32 s44, 0
  s_add_u32 m0, s45, 0
  s_add_u32 s5, s44, 0
  buffer_load_dwordx4 v3, s[12:15], s5 offen lds
  s_add_u32 m0, s45, 1024
  s_add_u32 s5, s44, 128
  buffer_load_dwordx4 v3, s[12:15], s5 offen lds
  s_add_u32 m0, s45, 2048
  s_add_u32 s5, s44, 256
  buffer_load_dwordx4 v3, s[12:15], s5 offen lds
  s_add_u32 m0, s45, 3072
  s_add_u32 s5, s44, 384
  buffer_load_dwordx4 v3, s[12:15], s5 offen lds
  s_add_u32 m0, s45, 4096
  s_add_u32 s5, s44, 512
  buffer_load_dwordx4 v3, s[12:15], s5 offen lds
  s_add_u32 m0, s45, 5120
  s_add_u32 s5, s44, 640
  buffer_load_dwordx4 v3, s[12:15], s5 offen lds
  s_add_u32 m0, s45, 6144
  s_add_u32 s5, s44, 768
  buffer_load_dwordx4 v3, s[12:15], s5 offen lds
  s_add_u32 m0, s45, 7168
  s_add_u32 s5, s44, 896
  buffer_load_dwordx4 v3, s[12:15], s5 offen lds
  s_add_u32 m0, s45, 8192
  s_add_u32 s5, s44, 1024
  buffer_load_dwordx4 v3, s[12:15], s5 offen lds
  s_add_u32 m0, s45, 9216
  s_add_u32 s5, s44, 1152
  buffer_load_dwordx4 v3, s[12:15], s5 offen lds
  s_add_u32 s44, s44, 40960
  s_add_u32 s45, s45, 40960
  s_add_u32 m0, s45, 0
  s_add_u32 s5, s44, 0
  buffer_load_dwordx4 v3, s[12:15], s5 offen lds
  s_add_u32 m0, s45, 1024
  s_add_u32 s5, s44, 128
  buffer_load_dwordx4 v3, s[12:15], s5 offen lds
  s_add_u32 m0, s45, 2048
  s_add_u32 s5, s44, 256
  buffer_load_dwordx4 v3, s[12:15], s5 offen lds
  s_add_u32 m0, s45, 3072
  s_add_u32 s5, s44, 384
  buffer_load_dwordx4 v3, s[12:15], s5 offen lds
  s_add_u32 m0, s45, 4096
  s_add_u32 s5, s44, 512
  buffer_load_dwordx4 v3, s[12:15], s5 offen lds
  s_add_u32 m0, s45, 5120
  s_add_u32 s5, s44, 640
  buffer_load_dwordx4 v3, s[12:15], s5 offen lds
  s_add_u32 m0, s45, 6144
  s_add_u32 s5, s44, 768
  buffer_load_dwordx4 v3, s[12:15], s5 offen lds
  s_add_u32 m0, s45, 7168
  s_add_u32 s5, s44, 896
  buffer_load_dwordx4 v3, s[12:15], s5 offen lds
  s_add_u32 m0, s45, 8192
  s_add_u32 s5, s44, 1024
  buffer_load_dwordx4 v3, s[12:15], s5 offen lds
  s_add_u32 m0, s45, 9216
  s_add_u32 s5, s44, 1152
  buffer_load_dwordx4 v3, s[12:15], s5 offen lds
  s_add_u32 s44, s44, 40960
  s_add_u32 s45, s45, 40960
  s_mov_b32 s46, 0
  s_mov_b32 s48, 2
  s_mov_b32 s49, 0
  s_mov_b32 s52, -81920
  s_mov_b32 s53, 40960
  s_lshl_b32 s47, s26, 11
  s_add_u32 s47, s47, s27
  s_lshl_b32 s47, s47, 14
  s_and_b32 s42, s28, 1
  s_lshl_b32 s42, s42, 12
  s_add_u32 s47, s47, s42
  s_lshl_b32 s50, s26, 5
  s_add_u32 s50, s50, s27
  s_lshl_b32 s50, s50, 7
  s_add_u32 s50, s50, 166723584
  s_waitcnt vmcnt(10)
  s_barrier
KV_LOOP_67:
  ds_read_b128 v[160:163], v4 offset:0
  ds_read_b128 v[164:167], v5 offset:0
  ds_read_b128 v[168:171], v6 offset:0
  ds_read_b128 v[172:175], v7 offset:0
  s_waitcnt lgkmcnt(3)
  v_mfma_f32_32x32x16_bf16 v[128:143], a[0:3], v[160:163], 0
  v_mfma_f32_32x32x16_bf16 v[144:159], a[160:163], v[160:163], 0
  ds_read_b128 v[160:163], v4 offset:1024
  s_waitcnt lgkmcnt(3)
  v_mfma_f32_32x32x16_bf16 v[128:143], a[4:7], v[164:167], v[128:143]
  v_mfma_f32_32x32x16_bf16 v[144:159], a[164:167], v[164:167], v[144:159]
  ds_read_b128 v[164:167], v5 offset:1024
  s_waitcnt lgkmcnt(3)
  v_mfma_f32_32x32x16_bf16 v[128:143], a[8:11], v[168:171], v[128:143]
  v_mfma_f32_32x32x16_bf16 v[144:159], a[168:171], v[168:171], v[144:159]
  s_add_u32 m0, s45, 0
  s_add_u32 s5, s44, 0
  buffer_load_dwordx4 v3, s[12:15], s5 offen lds
  ds_read_b128 v[168:171], v6 offset:1024
  s_waitcnt lgkmcnt(3)
  v_mfma_f32_32x32x16_bf16 v[128:143], a[12:15], v[172:175], v[128:143]
  v_mfma_f32_32x32x16_bf16 v[144:159], a[172:175], v[172:175], v[144:159]
  ds_read_b128 v[172:175], v7 offset:1024
  s_waitcnt lgkmcnt(3)
  v_mfma_f32_32x32x16_bf16 v[128:143], a[16:19], v[160:163], v[128:143]
  v_mfma_f32_32x32x16_bf16 v[144:159], a[176:179], v[160:163], v[144:159]
  ds_read_b128 v[160:163], v4 offset:2048
  s_waitcnt lgkmcnt(3)
  v_mfma_f32_32x32x16_bf16 v[128:143], a[20:23], v[164:167], v[128:143]
  v_mfma_f32_32x32x16_bf16 v[144:159], a[180:183], v[164:167], v[144:159]
  s_add_u32 m0, s45, 1024
  s_add_u32 s5, s44, 128
  buffer_load_dwordx4 v3, s[12:15], s5 offen lds
  ds_read_b128 v[164:167], v5 offset:2048
  s_waitcnt lgkmcnt(3)
  v_mfma_f32_32x32x16_bf16 v[128:143], a[24:27], v[168:171], v[128:143]
  v_mfma_f32_32x32x16_bf16 v[144:159], a[184:187], v[168:171], v[144:159]
  ds_read_b128 v[168:171], v6 offset:2048
  s_waitcnt lgkmcnt(3)
  v_mfma_f32_32x32x16_bf16 v[128:143], a[28:31], v[172:175], v[128:143]
  v_mfma_f32_32x32x16_bf16 v[144:159], a[188:191], v[172:175], v[144:159]
  ds_read_b128 v[172:175], v7 offset:2048
  s_waitcnt lgkmcnt(3)
  v_mfma_f32_32x32x16_bf16 v[128:143], a[32:35], v[160:163], v[128:143]
  v_mfma_f32_32x32x16_bf16 v[144:159], a[192:195], v[160:163], v[144:159]
  s_add_u32 m0, s45, 2048
  s_add_u32 s5, s44, 256
  buffer_load_dwordx4 v3, s[12:15], s5 offen lds
  ds_read_b128 v[160:163], v4 offset:3072
  s_waitcnt lgkmcnt(3)
  v_mfma_f32_32x32x16_bf16 v[128:143], a[36:39], v[164:167], v[128:143]
  v_mfma_f32_32x32x16_bf16 v[144:159], a[196:199], v[164:167], v[144:159]
  ds_read_b128 v[164:167], v5 offset:3072
  s_waitcnt lgkmcnt(3)
  v_mfma_f32_32x32x16_bf16 v[128:143], a[40:43], v[168:171], v[128:143]
  v_mfma_f32_32x32x16_bf16 v[144:159], a[200:203], v[168:171], v[144:159]
  ds_read_b128 v[168:171], v6 offset:3072
  s_waitcnt lgkmcnt(3)
  v_mfma_f32_32x32x16_bf16 v[128:143], a[44:47], v[172:175], v[128:143]
  v_mfma_f32_32x32x16_bf16 v[144:159], a[204:207], v[172:175], v[144:159]
  s_add_u32 m0, s45, 3072
  s_add_u32 s5, s44, 384
  buffer_load_dwordx4 v3, s[12:15], s5 offen lds
  ds_read_b128 v[172:175], v7 offset:3072
  s_waitcnt lgkmcnt(3)
  v_mfma_f32_32x32x16_bf16 v[128:143], a[48:51], v[160:163], v[128:143]
  v_mfma_f32_32x32x16_bf16 v[144:159], a[208:211], v[160:163], v[144:159]
  ds_read_b128 v[160:163], v4 offset:4096
  s_waitcnt lgkmcnt(3)
  v_mfma_f32_32x32x16_bf16 v[128:143], a[52:55], v[164:167], v[128:143]
  v_mfma_f32_32x32x16_bf16 v[144:159], a[212:215], v[164:167], v[144:159]
  ds_read_b128 v[164:167], v5 offset:4096
  s_waitcnt lgkmcnt(3)
  v_mfma_f32_32x32x16_bf16 v[128:143], a[56:59], v[168:171], v[128:143]
  v_mfma_f32_32x32x16_bf16 v[144:159], a[216:219], v[168:171], v[144:159]
  s_add_u32 m0, s45, 4096
  s_add_u32 s5, s44, 512
  buffer_load_dwordx4 v3, s[12:15], s5 offen lds
  ds_read_b128 v[168:171], v6 offset:4096
  s_waitcnt lgkmcnt(3)
  v_mfma_f32_32x32x16_bf16 v[128:143], a[60:63], v[172:175], v[128:143]
  v_mfma_f32_32x32x16_bf16 v[144:159], a[220:223], v[172:175], v[144:159]
  ds_read_b128 v[172:175], v7 offset:4096
  s_waitcnt lgkmcnt(3)
  v_mfma_f32_32x32x16_bf16 v[128:143], a[64:67], v[160:163], v[128:143]
  v_mfma_f32_32x32x16_bf16 v[144:159], a[224:227], v[160:163], v[144:159]
  ds_read_b128 v[160:163], v4 offset:5120
  s_waitcnt lgkmcnt(3)
  v_mfma_f32_32x32x16_bf16 v[128:143], a[68:71], v[164:167], v[128:143]
  v_mfma_f32_32x32x16_bf16 v[144:159], a[228:231], v[164:167], v[144:159]
  s_add_u32 m0, s45, 5120
  s_add_u32 s5, s44, 640
  buffer_load_dwordx4 v3, s[12:15], s5 offen lds
  ds_read_b128 v[164:167], v5 offset:5120
  s_waitcnt lgkmcnt(3)
  v_mfma_f32_32x32x16_bf16 v[128:143], a[72:75], v[168:171], v[128:143]
  v_mfma_f32_32x32x16_bf16 v[144:159], a[232:235], v[168:171], v[144:159]
  ds_read_b128 v[168:171], v6 offset:5120
  s_waitcnt lgkmcnt(3)
  v_mfma_f32_32x32x16_bf16 v[128:143], a[76:79], v[172:175], v[128:143]
  v_mfma_f32_32x32x16_bf16 v[144:159], a[236:239], v[172:175], v[144:159]
  ds_read_b128 v[172:175], v7 offset:5120
  s_waitcnt lgkmcnt(3)
  v_mfma_f32_32x32x16_bf16 v[128:143], a[80:83], v[160:163], v[128:143]
  v_mfma_f32_32x32x16_bf16 v[144:159], a[240:243], v[160:163], v[144:159]
  s_add_u32 m0, s45, 6144
  s_add_u32 s5, s44, 768
  buffer_load_dwordx4 v3, s[12:15], s5 offen lds
  ds_read_b128 v[160:163], v4 offset:6144
  s_waitcnt lgkmcnt(3)
  v_mfma_f32_32x32x16_bf16 v[128:143], a[84:87], v[164:167], v[128:143]
  v_mfma_f32_32x32x16_bf16 v[144:159], a[244:247], v[164:167], v[144:159]
  ds_read_b128 v[164:167], v5 offset:6144
  s_waitcnt lgkmcnt(3)
  v_mfma_f32_32x32x16_bf16 v[128:143], a[88:91], v[168:171], v[128:143]
  v_mfma_f32_32x32x16_bf16 v[144:159], a[248:251], v[168:171], v[144:159]
  ds_read_b128 v[168:171], v6 offset:6144
  s_waitcnt lgkmcnt(3)
  v_mfma_f32_32x32x16_bf16 v[128:143], a[92:95], v[172:175], v[128:143]
  v_mfma_f32_32x32x16_bf16 v[144:159], a[252:255], v[172:175], v[144:159]
  s_add_u32 m0, s45, 7168
  s_add_u32 s5, s44, 896
  buffer_load_dwordx4 v3, s[12:15], s5 offen lds
  ds_read_b128 v[172:175], v7 offset:6144
  s_waitcnt lgkmcnt(3)
  v_mfma_f32_32x32x16_bf16 v[128:143], a[96:99], v[160:163], v[128:143]
  v_mfma_f32_32x32x16_bf16 v[144:159], v[192:195], v[160:163], v[144:159]
  ds_read_b128 v[160:163], v4 offset:7168
  s_waitcnt lgkmcnt(3)
  v_mfma_f32_32x32x16_bf16 v[128:143], a[100:103], v[164:167], v[128:143]
  v_mfma_f32_32x32x16_bf16 v[144:159], v[196:199], v[164:167], v[144:159]
  ds_read_b128 v[164:167], v5 offset:7168
  s_waitcnt lgkmcnt(3)
  v_mfma_f32_32x32x16_bf16 v[128:143], a[104:107], v[168:171], v[128:143]
  v_mfma_f32_32x32x16_bf16 v[144:159], v[200:203], v[168:171], v[144:159]
  s_add_u32 m0, s45, 8192
  s_add_u32 s5, s44, 1024
  buffer_load_dwordx4 v3, s[12:15], s5 offen lds
  ds_read_b128 v[168:171], v6 offset:7168
  s_waitcnt lgkmcnt(3)
  v_mfma_f32_32x32x16_bf16 v[128:143], a[108:111], v[172:175], v[128:143]
  v_mfma_f32_32x32x16_bf16 v[144:159], v[204:207], v[172:175], v[144:159]
  ds_read_b128 v[172:175], v7 offset:7168
  s_waitcnt lgkmcnt(3)
  v_mfma_f32_32x32x16_bf16 v[128:143], a[112:115], v[160:163], v[128:143]
  v_mfma_f32_32x32x16_bf16 v[144:159], v[208:211], v[160:163], v[144:159]
  ds_read_b128 v[160:163], v4 offset:8192
  s_waitcnt lgkmcnt(3)
  v_mfma_f32_32x32x16_bf16 v[128:143], a[116:119], v[164:167], v[128:143]
  v_mfma_f32_32x32x16_bf16 v[144:159], v[212:215], v[164:167], v[144:159]
  s_add_u32 m0, s45, 9216
  s_add_u32 s5, s44, 1152
  buffer_load_dwordx4 v3, s[12:15], s5 offen lds
  ds_read_b128 v[164:167], v5 offset:8192
  s_waitcnt lgkmcnt(3)
  v_mfma_f32_32x32x16_bf16 v[128:143], a[120:123], v[168:171], v[128:143]
  v_mfma_f32_32x32x16_bf16 v[144:159], v[216:219], v[168:171], v[144:159]
  ds_read_b128 v[168:171], v6 offset:8192
  s_waitcnt lgkmcnt(3)
  v_mfma_f32_32x32x16_bf16 v[128:143], a[124:127], v[172:175], v[128:143]
  v_mfma_f32_32x32x16_bf16 v[144:159], v[220:223], v[172:175], v[144:159]
  ds_read_b128 v[172:175], v7 offset:8192
  s_waitcnt lgkmcnt(3)
  v_mfma_f32_32x32x16_bf16 v[128:143], a[128:131], v[160:163], v[128:143]
  v_mfma_f32_32x32x16_bf16 v[144:159], v[224:227], v[160:163], v[144:159]
  ds_read_b128 v[160:163], v4 offset:9216
  s_waitcnt lgkmcnt(3)
  v_mfma_f32_32x32x16_bf16 v[128:143], a[132:135], v[164:167], v[128:143]
  v_mfma_f32_32x32x16_bf16 v[144:159], v[228:231], v[164:167], v[144:159]
  ds_read_b128 v[164:167], v5 offset:9216
  s_waitcnt lgkmcnt(3)
  v_mfma_f32_32x32x16_bf16 v[128:143], a[136:139], v[168:171], v[128:143]
  v_mfma_f32_32x32x16_bf16 v[144:159], v[232:235], v[168:171], v[144:159]
  ds_read_b128 v[168:171], v6 offset:9216
  s_waitcnt lgkmcnt(3)
  v_mfma_f32_32x32x16_bf16 v[128:143], a[140:143], v[172:175], v[128:143]
  v_mfma_f32_32x32x16_bf16 v[144:159], v[236:239], v[172:175], v[144:159]
  ds_read_b128 v[172:175], v7 offset:9216
  s_waitcnt lgkmcnt(3)
  v_mfma_f32_32x32x16_bf16 v[128:143], a[144:147], v[160:163], v[128:143]
  v_mfma_f32_32x32x16_bf16 v[144:159], v[240:243], v[160:163], v[144:159]
  s_waitcnt lgkmcnt(2)
  v_mfma_f32_32x32x16_bf16 v[128:143], a[148:151], v[164:167], v[128:143]
  v_mfma_f32_32x32x16_bf16 v[144:159], v[244:247], v[164:167], v[144:159]
  s_waitcnt lgkmcnt(1)
  v_mfma_f32_32x32x16_bf16 v[128:143], a[152:155], v[168:171], v[128:143]
  v_mfma_f32_32x32x16_bf16 v[144:159], v[248:251], v[168:171], v[144:159]
  s_waitcnt lgkmcnt(0)
  v_mfma_f32_32x32x16_bf16 v[128:143], a[156:159], v[172:175], v[128:143]
  v_mfma_f32_32x32x16_bf16 v[144:159], v[252:255], v[172:175], v[144:159]
  s_add_u32 s49, s49, 1
  s_cmp_eq_u32 s49, 3
  s_cselect_b32 s51, s52, s53
  s_cselect_b32 s49, 0, s49
  v_add_u32 v4, s51, v4
  v_add_u32 v5, s51, v5
  v_add_u32 v6, s51, v6
  v_add_u32 v7, s51, v7
  s_nop 2
  v_cvt_pk_bf16_f32 v176, v128, v129
  v_cvt_pk_bf16_f32 v177, v130, v131
  v_cvt_pk_bf16_f32 v178, v132, v133
  v_cvt_pk_bf16_f32 v179, v134, v135
  v_cvt_pk_bf16_f32 v180, v136, v137
  v_cvt_pk_bf16_f32 v181, v138, v139
  v_cvt_pk_bf16_f32 v182, v140, v141
  v_cvt_pk_bf16_f32 v183, v142, v143
  v_cvt_pk_bf16_f32 v184, v144, v145
  v_cvt_pk_bf16_f32 v185, v146, v147
  v_cvt_pk_bf16_f32 v186, v148, v149
  v_cvt_pk_bf16_f32 v187, v150, v151
  v_cvt_pk_bf16_f32 v188, v152, v153
  v_cvt_pk_bf16_f32 v189, v154, v155
  v_cvt_pk_bf16_f32 v190, v156, v157
  v_cvt_pk_bf16_f32 v191, v158, v159
  buffer_store_dwordx4 v[176:179], v8, s[8:11], s47 offen offset:0 sc1
  buffer_store_dwordx4 v[180:183], v8, s[8:11], s47 offen offset:256 sc1
  buffer_store_dwordx4 v[184:187], v8, s[8:11], s47 offen offset:2048 sc1
  buffer_store_dwordx4 v[188:191], v8, s[8:11], s47 offen offset:2304 sc1
  s_cmp_eq_u32 s46, 0
  s_cbranch_scc1 KV_W0_68
  s_waitcnt vmcnt(14)
  s_mov_b32 s54, s46
  s_branch KV_W1_69
KV_W0_68:
  s_waitcnt vmcnt(0)
  s_mov_b32 s54, 1
KV_W1_69:
  s_barrier
  s_cmp_lg_u32 s28, 0
  s_cbranch_scc1 KV_NF_70
  v_mov_b32 v15, s54
  v_mov_b32 v16, 0
  s_mov_b64 exec, 1
  buffer_store_dword v15, v16, s[8:11], s50 offen sc1
  s_mov_b64 exec, -1
KV_NF_70:
  s_add_u32 s44, s44, 40960
  s_add_u32 s45, s45, 40960
  s_add_u32 s48, s48, 1
  s_cmp_eq_u32 s48, 3
  s_cselect_b32 s48, 0, s48
  s_cselect_b32 s51, 122880, 0
  s_sub_u32 s45, s45, s51
  s_add_u32 s47, s47, 524288
  s_add_u32 s46, s46, 1
  s_cmp_lt_u32 s46, 64
  s_cbranch_scc1 KV_LOOP_67
  s_waitcnt vmcnt(0)
  s_barrier
  s_cmp_lg_u32 s28, 0
  s_cbranch_scc1 KV_DONE_66
  v_mov_b32 v15, 64
  v_mov_b32 v16, 0
  s_mov_b64 exec, 1
  buffer_store_dword v15, v16, s[8:11], s50 offen sc1
  s_mov_b64 exec, -1
  s_waitcnt vmcnt(0)
  s_branch KV_DONE_66
KV_V_65:
  v_bfe_u32 v12, v2, 4, 1
  v_and_b32 v13, 1, v2
  v_bfe_u32 v14, v2, 1, 1
  v_lshl_or_b32 v12, v12, 1, v14
  v_lshlrev_b32 v13, 3, v13
  s_and_b32 s42, s28, 1
  s_lshl_b32 s42, s42, 3
  v_or_b32 v12, s42, v12
  v_bfe_u32 v14, v2, 2, 2
  v_lshlrev_b32 v11, 2, v14
  v_xor_b32 v12, v12, v11
  v_lshl_add_u32 v13, v12, 4, v13
  v_lshl_add_u32 v13, v14, 8, v13
  v_lshrrev_b32 v14, 5, v2
  v_lshl_add_u32 v13, v14, 11, v13
  s_lshr_b32 s42, s28, 1
  s_lshl_b32 s42, s42, 14
  v_add_u32 v10, s42, v13
  v_xor_b32 v11, 64, v10
  s_waitcnt vmcnt(8) lgkmcnt(0)
  s_barrier
  v_mov_b32 v12, 32
  v_mov_b32 v13, 1
  s_cmp_eq_u32 s28, 0
  s_cselect_b64 exec, 1, 0
  global_atomic_add v12, v13, s[24:25]
  s_mov_b64 exec, -1
  ds_read_b64_tr_b16 a[0:1], v10 offset:0
  ds_read_b64_tr_b16 a[2:3], v10 offset:1024
  ds_read_b64_tr_b16 a[160:161], v11 offset:0
  ds_read_b64_tr_b16 a[162:163], v11 offset:1024
  ds_read_b64_tr_b16 a[4:5], v10 offset:4096
  ds_read_b64_tr_b16 a[6:7], v10 offset:5120
  ds_read_b64_tr_b16 a[164:165], v11 offset:4096
  ds_read_b64_tr_b16 a[166:167], v11 offset:5120
  ds_read_b64_tr_b16 a[8:9], v10 offset:8192
  ds_read_b64_tr_b16 a[10:11], v10 offset:9216
  ds_read_b64_tr_b16 a[168:169], v11 offset:8192
  ds_read_b64_tr_b16 a[170:171], v11 offset:9216
  ds_read_b64_tr_b16 a[12:13], v10 offset:12288
  ds_read_b64_tr_b16 a[14:15], v10 offset:13312
  ds_read_b64_tr_b16 a[172:173], v11 offset:12288
  ds_read_b64_tr_b16 a[174:175], v11 offset:13312
  s_waitcnt vmcnt(1) lgkmcnt(0)
  s_barrier
  s_add_u32 m0, s41, 65536
  s_add_u32 s5, s40, 1048576
  buffer_load_dwordx4 v9, s[16:19], s5 offen lds
  s_add_u32 m0, s41, 66560
  s_add_u32 s5, s40, 1081344
  buffer_load_dwordx4 v9, s[16:19], s5 offen lds
  s_add_u32 m0, s41, 67584
  s_add_u32 s5, s40, 1114112
  buffer_load_dwordx4 v9, s[16:19], s5 offen lds
  s_add_u32 m0, s41, 68608
  s_add_u32 s5, s40, 1146880
  buffer_load_dwordx4 v9, s[16:19], s5 offen lds
  s_add_u32 m0, s41, 69632
  s_add_u32 s5, s40, 1179648
  buffer_load_dwordx4 v9, s[16:19], s5 offen lds
  s_add_u32 m0, s41, 70656
  s_add_u32 s5, s40, 1212416
  buffer_load_dwordx4 v9, s[16:19], s5 offen lds
  s_add_u32 m0, s41, 71680
  s_add_u32 s5, s40, 1245184
  buffer_load_dwordx4 v9, s[16:19], s5 offen lds
  s_add_u32 m0, s41, 72704
  s_add_u32 s5, s40, 1277952
  buffer_load_dwordx4 v9, s[16:19], s5 offen lds
  v_add_u32 v10, 32768, v10
  v_add_u32 v11, 32768, v11
  ds_read_b64_tr_b16 a[16:17], v10 offset:0
  ds_read_b64_tr_b16 a[18:19], v10 offset:1024
  ds_read_b64_tr_b16 a[176:177], v11 offset:0
  ds_read_b64_tr_b16 a[178:179], v11 offset:1024
  ds_read_b64_tr_b16 a[20:21], v10 offset:4096
  ds_read_b64_tr_b16 a[22:23], v10 offset:5120
  ds_read_b64_tr_b16 a[180:181], v11 offset:4096
  ds_read_b64_tr_b16 a[182:183], v11 offset:5120
  ds_read_b64_tr_b16 a[24:25], v10 offset:8192
  ds_read_b64_tr_b16 a[26:27], v10 offset:9216
  ds_read_b64_tr_b16 a[184:185], v11 offset:8192
  ds_read_b64_tr_b16 a[186:187], v11 offset:9216
  ds_read_b64_tr_b16 a[28:29], v10 offset:12288
  ds_read_b64_tr_b16 a[30:31], v10 offset:13312
  ds_read_b64_tr_b16 a[188:189], v11 offset:12288
  ds_read_b64_tr_b16 a[190:191], v11 offset:13312
  s_waitcnt vmcnt(0) lgkmcnt(0)
  s_barrier
  s_add_u32 m0, s41, 98304
  s_add_u32 s5, s40, 1572864
  buffer_load_dwordx4 v9, s[16:19], s5 offen lds
  s_add_u32 m0, s41, 99328
  s_add_u32 s5, s40, 1605632
  buffer_load_dwordx4 v9, s[16:19], s5 offen lds
  s_add_u32 m0, s41, 100352
  s_add_u32 s5, s40, 1638400
  buffer_load_dwordx4 v9, s[16:19], s5 offen lds
  s_add_u32 m0, s41, 101376
  s_add_u32 s5, s40, 1671168
  buffer_load_dwordx4 v9, s[16:19], s5 offen lds
  s_add_u32 m0, s41, 102400
  s_add_u32 s5, s40, 1703936
  buffer_load_dwordx4 v9, s[16:19], s5 offen lds
  s_add_u32 m0, s41, 103424
  s_add_u32 s5, s40, 1736704
  buffer_load_dwordx4 v9, s[16:19], s5 offen lds
  s_add_u32 m0, s41, 104448
  s_add_u32 s5, s40, 1769472
  buffer_load_dwordx4 v9, s[16:19], s5 offen lds
  s_add_u32 m0, s41, 105472
  s_add_u32 s5, s40, 1802240
  buffer_load_dwordx4 v9, s[16:19], s5 offen lds
  v_add_u32 v10, 32768, v10
  v_add_u32 v11, 32768, v11
  ds_read_b64_tr_b16 a[32:33], v10 offset:0
  ds_read_b64_tr_b16 a[34:35], v10 offset:1024
  ds_read_b64_tr_b16 a[192:193], v11 offset:0
  ds_read_b64_tr_b16 a[194:195], v11 offset:1024
  ds_read_b64_tr_b16 a[36:37], v10 offset:4096
  ds_read_b64_tr_b16 a[38:39], v10 offset:5120
  ds_read_b64_tr_b16 a[196:197], v11 offset:4096
  ds_read_b64_tr_b16 a[198:199], v11 offset:5120
  ds_read_b64_tr_b16 a[40:41], v10 offset:8192
  ds_read_b64_tr_b16 a[42:43], v10 offset:9216
  ds_read_b64_tr_b16 a[200:201], v11 offset:8192
  ds_read_b64_tr_b16 a[202:203], v11 offset:9216
  ds_read_b64_tr_b16 a[44:45], v10 offset:12288
  ds_read_b64_tr_b16 a[46:47], v10 offset:13312
  ds_read_b64_tr_b16 a[204:205], v11 offset:12288
  ds_read_b64_tr_b16 a[206:207], v11 offset:13312
  s_waitcnt vmcnt(0) lgkmcnt(0)
  s_barrier
  s_add_u32 m0, s41, 0
  s_add_u32 s5, s40, 2097152
  buffer_load_dwordx4 v9, s[16:19], s5 offen lds
  s_add_u32 m0, s41, 1024
  s_add_u32 s5, s40, 2129920
  buffer_load_dwordx4 v9, s[16:19], s5 offen lds
  s_add_u32 m0, s41, 2048
  s_add_u32 s5, s40, 2162688
  buffer_load_dwordx4 v9, s[16:19], s5 offen lds
  s_add_u32 m0, s41, 3072
  s_add_u32 s5, s40, 2195456
  buffer_load_dwordx4 v9, s[16:19], s5 offen lds
  s_add_u32 m0, s41, 4096
  s_add_u32 s5, s40, 2228224
  buffer_load_dwordx4 v9, s[16:19], s5 offen lds
  s_add_u32 m0, s41, 5120
  s_add_u32 s5, s40, 2260992
  buffer_load_dwordx4 v9, s[16:19], s5 offen lds
  s_add_u32 m0, s41, 6144
  s_add_u32 s5, s40, 2293760
  buffer_load_dwordx4 v9, s[16:19], s5 offen lds
  s_add_u32 m0, s41, 7168
  s_add_u32 s5, s40, 2326528
  buffer_load_dwordx4 v9, s[16:19], s5 offen lds
  v_add_u32 v10, 32768, v10
  v_add_u32 v11, 32768, v11
  ds_read_b64_tr_b16 a[48:49], v10 offset:0
  ds_read_b64_tr_b16 a[50:51], v10 offset:1024
  ds_read_b64_tr_b16 a[208:209], v11 offset:0
  ds_read_b64_tr_b16 a[210:211], v11 offset:1024
  ds_read_b64_tr_b16 a[52:53], v10 offset:4096
  ds_read_b64_tr_b16 a[54:55], v10 offset:5120
  ds_read_b64_tr_b16 a[212:213], v11 offset:4096
  ds_read_b64_tr_b16 a[214:215], v11 offset:5120
  ds_read_b64_tr_b16 a[56:57], v10 offset:8192
  ds_read_b64_tr_b16 a[58:59], v10 offset:9216
  ds_read_b64_tr_b16 a[216:217], v11 offset:8192
  ds_read_b64_tr_b16 a[218:219], v11 offset:9216
  ds_read_b64_tr_b16 a[60:61], v10 offset:12288
  ds_read_b64_tr_b16 a[62:63], v10 offset:13312
  ds_read_b64_tr_b16 a[220:221], v11 offset:12288
  ds_read_b64_tr_b16 a[222:223], v11 offset:13312
  s_waitcnt vmcnt(0) lgkmcnt(0)
  s_barrier
  s_add_u32 m0, s41, 32768
  s_add_u32 s5, s40, 2621440
  buffer_load_dwordx4 v9, s[16:19], s5 offen lds
  s_add_u32 m0, s41, 33792
  s_add_u32 s5, s40, 2654208
  buffer_load_dwordx4 v9, s[16:19], s5 offen lds
  s_add_u32 m0, s41, 34816
  s_add_u32 s5, s40, 2686976
  buffer_load_dwordx4 v9, s[16:19], s5 offen lds
  s_add_u32 m0, s41, 35840
  s_add_u32 s5, s40, 2719744
  buffer_load_dwordx4 v9, s[16:19], s5 offen lds
  s_add_u32 m0, s41, 36864
  s_add_u32 s5, s40, 2752512
  buffer_load_dwordx4 v9, s[16:19], s5 offen lds
  s_add_u32 m0, s41, 37888
  s_add_u32 s5, s40, 2785280
  buffer_load_dwordx4 v9, s[16:19], s5 offen lds
  s_add_u32 m0, s41, 38912
  s_add_u32 s5, s40, 2818048
  buffer_load_dwordx4 v9, s[16:19], s5 offen lds
  s_add_u32 m0, s41, 39936
  s_add_u32 s5, s40, 2850816
  buffer_load_dwordx4 v9, s[16:19], s5 offen lds
  v_subrev_u32 v10, 98304, v10
  v_subrev_u32 v11, 98304, v11
  ds_read_b64_tr_b16 a[64:65], v10 offset:0
  ds_read_b64_tr_b16 a[66:67], v10 offset:1024
  ds_read_b64_tr_b16 a[224:225], v11 offset:0
  ds_read_b64_tr_b16 a[226:227], v11 offset:1024
  ds_read_b64_tr_b16 a[68:69], v10 offset:4096
  ds_read_b64_tr_b16 a[70:71], v10 offset:5120
  ds_read_b64_tr_b16 a[228:229], v11 offset:4096
  ds_read_b64_tr_b16 a[230:231], v11 offset:5120
  ds_read_b64_tr_b16 a[72:73], v10 offset:8192
  ds_read_b64_tr_b16 a[74:75], v10 offset:9216
  ds_read_b64_tr_b16 a[232:233], v11 offset:8192
  ds_read_b64_tr_b16 a[234:235], v11 offset:9216
  ds_read_b64_tr_b16 a[76:77], v10 offset:12288
  ds_read_b64_tr_b16 a[78:79], v10 offset:13312
  ds_read_b64_tr_b16 a[236:237], v11 offset:12288
  ds_read_b64_tr_b16 a[238:239], v11 offset:13312
  s_waitcnt vmcnt(0) lgkmcnt(0)
  s_barrier
  s_add_u32 m0, s41, 65536
  s_add_u32 s5, s40, 3145728
  buffer_load_dwordx4 v9, s[16:19], s5 offen lds
  s_add_u32 m0, s41, 66560
  s_add_u32 s5, s40, 3178496
  buffer_load_dwordx4 v9, s[16:19], s5 offen lds
  s_add_u32 m0, s41, 67584
  s_add_u32 s5, s40, 3211264
  buffer_load_dwordx4 v9, s[16:19], s5 offen lds
  s_add_u32 m0, s41, 68608
  s_add_u32 s5, s40, 3244032
  buffer_load_dwordx4 v9, s[16:19], s5 offen lds
  s_add_u32 m0, s41, 69632
  s_add_u32 s5, s40, 3276800
  buffer_load_dwordx4 v9, s[16:19], s5 offen lds
  s_add_u32 m0, s41, 70656
  s_add_u32 s5, s40, 3309568
  buffer_load_dwordx4 v9, s[16:19], s5 offen lds
  s_add_u32 m0, s41, 71680
  s_add_u32 s5, s40, 3342336
  buffer_load_dwordx4 v9, s[16:19], s5 offen lds
  s_add_u32 m0, s41, 72704
  s_add_u32 s5, s40, 3375104
  buffer_load_dwordx4 v9, s[16:19], s5 offen lds
  v_add_u32 v10, 32768, v10
  v_add_u32 v11, 32768, v11
  ds_read_b64_tr_b16 a[80:81], v10 offset:0
  ds_read_b64_tr_b16 a[82:83], v10 offset:1024
  ds_read_b64_tr_b16 a[240:241], v11 offset:0
  ds_read_b64_tr_b16 a[242:243], v11 offset:1024
  ds_read_b64_tr_b16 a[84:85], v10 offset:4096
  ds_read_b64_tr_b16 a[86:87], v10 offset:5120
  ds_read_b64_tr_b16 a[244:245], v11 offset:4096
  ds_read_b64_tr_b16 a[246:247], v11 offset:5120
  ds_read_b64_tr_b16 a[88:89], v10 offset:8192
  ds_read_b64_tr_b16 a[90:91], v10 offset:9216
  ds_read_b64_tr_b16 a[248:249], v11 offset:8192
  ds_read_b64_tr_b16 a[250:251], v11 offset:9216
  ds_read_b64_tr_b16 a[92:93], v10 offset:12288
  ds_read_b64_tr_b16 a[94:95], v10 offset:13312
  ds_read_b64_tr_b16 a[252:253], v11 offset:12288
  ds_read_b64_tr_b16 a[254:255], v11 offset:13312
  s_waitcnt vmcnt(0) lgkmcnt(0)
  s_barrier
  s_add_u32 m0, s41, 98304
  s_add_u32 s5, s40, 3670016
  buffer_load_dwordx4 v9, s[16:19], s5 offen lds
  s_add_u32 m0, s41, 99328
  s_add_u32 s5, s40, 3702784
  buffer_load_dwordx4 v9, s[16:19], s5 offen lds
  s_add_u32 m0, s41, 100352
  s_add_u32 s5, s40, 3735552
  buffer_load_dwordx4 v9, s[16:19], s5 offen lds
  s_add_u32 m0, s41, 101376
  s_add_u32 s5, s40, 3768320
  buffer_load_dwordx4 v9, s[16:19], s5 offen lds
  s_add_u32 m0, s41, 102400
  s_add_u32 s5, s40, 3801088
  buffer_load_dwordx4 v9, s[16:19], s5 offen lds
  s_add_u32 m0, s41, 103424
  s_add_u32 s5, s40, 3833856
  buffer_load_dwordx4 v9, s[16:19], s5 offen lds
  s_add_u32 m0, s41, 104448
  s_add_u32 s5, s40, 3866624
  buffer_load_dwordx4 v9, s[16:19], s5 offen lds
  s_add_u32 m0, s41, 105472
  s_add_u32 s5, s40, 3899392
  buffer_load_dwordx4 v9, s[16:19], s5 offen lds
  v_add_u32 v10, 32768, v10
  v_add_u32 v11, 32768, v11
  ds_read_b64_tr_b16 a[96:97], v10 offset:0
  ds_read_b64_tr_b16 a[98:99], v10 offset:1024
  ds_read_b64_tr_b16 v[192:193], v11 offset:0
  ds_read_b64_tr_b16 v[194:195], v11 offset:1024
  ds_read_b64_tr_b16 a[100:101], v10 offset:4096
  ds_read_b64_tr_b16 a[102:103], v10 offset:5120
  ds_read_b64_tr_b16 v[196:197], v11 offset:4096
  ds_read_b64_tr_b16 v[198:199], v11 offset:5120
  ds_read_b64_tr_b16 a[104:105], v10 offset:8192
  ds_read_b64_tr_b16 a[106:107], v10 offset:9216
  ds_read_b64_tr_b16 v[200:201], v11 offset:8192
  ds_read_b64_tr_b16 v[202:203], v11 offset:9216
  ds_read_b64_tr_b16 a[108:109], v10 offset:12288
  ds_read_b64_tr_b16 a[110:111], v10 offset:13312
  ds_read_b64_tr_b16 v[204:205], v11 offset:12288
  ds_read_b64_tr_b16 v[206:207], v11 offset:13312
  s_waitcnt vmcnt(0) lgkmcnt(0)
  s_barrier
  s_add_u32 m0, s41, 0
  s_add_u32 s5, s40, 4194304
  buffer_load_dwordx4 v9, s[16:19], s5 offen lds
  s_add_u32 m0, s41, 1024
  s_add_u32 s5, s40, 4227072
  buffer_load_dwordx4 v9, s[16:19], s5 offen lds
  s_add_u32 m0, s41, 2048
  s_add_u32 s5, s40, 4259840
  buffer_load_dwordx4 v9, s[16:19], s5 offen lds
  s_add_u32 m0, s41, 3072
  s_add_u32 s5, s40, 4292608
  buffer_load_dwordx4 v9, s[16:19], s5 offen lds
  s_add_u32 m0, s41, 4096
  s_add_u32 s5, s40, 4325376
  buffer_load_dwordx4 v9, s[16:19], s5 offen lds
  s_add_u32 m0, s41, 5120
  s_add_u32 s5, s40, 4358144
  buffer_load_dwordx4 v9, s[16:19], s5 offen lds
  s_add_u32 m0, s41, 6144
  s_add_u32 s5, s40, 4390912
  buffer_load_dwordx4 v9, s[16:19], s5 offen lds
  s_add_u32 m0, s41, 7168
  s_add_u32 s5, s40, 4423680
  buffer_load_dwordx4 v9, s[16:19], s5 offen lds
  v_add_u32 v10, 32768, v10
  v_add_u32 v11, 32768, v11
  ds_read_b64_tr_b16 a[112:113], v10 offset:0
  ds_read_b64_tr_b16 a[114:115], v10 offset:1024
  ds_read_b64_tr_b16 v[208:209], v11 offset:0
  ds_read_b64_tr_b16 v[210:211], v11 offset:1024
  ds_read_b64_tr_b16 a[116:117], v10 offset:4096
  ds_read_b64_tr_b16 a[118:119], v10 offset:5120
  ds_read_b64_tr_b16 v[212:213], v11 offset:4096
  ds_read_b64_tr_b16 v[214:215], v11 offset:5120
  ds_read_b64_tr_b16 a[120:121], v10 offset:8192
  ds_read_b64_tr_b16 a[122:123], v10 offset:9216
  ds_read_b64_tr_b16 v[216:217], v11 offset:8192
  ds_read_b64_tr_b16 v[218:219], v11 offset:9216
  ds_read_b64_tr_b16 a[124:125], v10 offset:12288
  ds_read_b64_tr_b16 a[126:127], v10 offset:13312
  ds_read_b64_tr_b16 v[220:221], v11 offset:12288
  ds_read_b64_tr_b16 v[222:223], v11 offset:13312
  s_waitcnt vmcnt(0) lgkmcnt(0)
  s_barrier
  s_add_u32 m0, s41, 32768
  s_add_u32 s5, s40, 4718592
  buffer_load_dwordx4 v9, s[16:19], s5 offen lds
  s_add_u32 m0, s41, 33792
  s_add_u32 s5, s40, 4751360
  buffer_load_dwordx4 v9, s[16:19], s5 offen lds
  s_add_u32 m0, s41, 34816
  s_add_u32 s5, s40, 4784128
  buffer_load_dwordx4 v9, s[16:19], s5 offen lds
  s_add_u32 m0, s41, 35840
  s_add_u32 s5, s40, 4816896
  buffer_load_dwordx4 v9, s[16:19], s5 offen lds
  s_add_u32 m0, s41, 36864
  s_add_u32 s5, s40, 4849664
  buffer_load_dwordx4 v9, s[16:19], s5 offen lds
  s_add_u32 m0, s41, 37888
  s_add_u32 s5, s40, 4882432
  buffer_load_dwordx4 v9, s[16:19], s5 offen lds
  s_add_u32 m0, s41, 38912
  s_add_u32 s5, s40, 4915200
  buffer_load_dwordx4 v9, s[16:19], s5 offen lds
  s_add_u32 m0, s41, 39936
  s_add_u32 s5, s40, 4947968
  buffer_load_dwordx4 v9, s[16:19], s5 offen lds
  v_subrev_u32 v10, 98304, v10
  v_subrev_u32 v11, 98304, v11
  ds_read_b64_tr_b16 a[128:129], v10 offset:0
  ds_read_b64_tr_b16 a[130:131], v10 offset:1024
  ds_read_b64_tr_b16 v[224:225], v11 offset:0
  ds_read_b64_tr_b16 v[226:227], v11 offset:1024
  ds_read_b64_tr_b16 a[132:133], v10 offset:4096
  ds_read_b64_tr_b16 a[134:135], v10 offset:5120
  ds_read_b64_tr_b16 v[228:229], v11 offset:4096
  ds_read_b64_tr_b16 v[230:231], v11 offset:5120
  ds_read_b64_tr_b16 a[136:137], v10 offset:8192
  ds_read_b64_tr_b16 a[138:139], v10 offset:9216
  ds_read_b64_tr_b16 v[232:233], v11 offset:8192
  ds_read_b64_tr_b16 v[234:235], v11 offset:9216
  ds_read_b64_tr_b16 a[140:141], v10 offset:12288
  ds_read_b64_tr_b16 a[142:143], v10 offset:13312
  ds_read_b64_tr_b16 v[236:237], v11 offset:12288
  ds_read_b64_tr_b16 v[238:239], v11 offset:13312
  s_waitcnt vmcnt(0) lgkmcnt(0)
  s_barrier
  v_add_u32 v10, 32768, v10
  v_add_u32 v11, 32768, v11
  ds_read_b64_tr_b16 a[144:145], v10 offset:0
  ds_read_b64_tr_b16 a[146:147], v10 offset:1024
  ds_read_b64_tr_b16 v[240:241], v11 offset:0
  ds_read_b64_tr_b16 v[242:243], v11 offset:1024
  ds_read_b64_tr_b16 a[148:149], v10 offset:4096
  ds_read_b64_tr_b16 a[150:151], v10 offset:5120
  ds_read_b64_tr_b16 v[244:245], v11 offset:4096
  ds_read_b64_tr_b16 v[246:247], v11 offset:5120
  ds_read_b64_tr_b16 a[152:153], v10 offset:8192
  ds_read_b64_tr_b16 a[154:155], v10 offset:9216
  ds_read_b64_tr_b16 v[248:249], v11 offset:8192
  ds_read_b64_tr_b16 v[250:251], v11 offset:9216
  ds_read_b64_tr_b16 a[156:157], v10 offset:12288
  ds_read_b64_tr_b16 a[158:159], v10 offset:13312
  ds_read_b64_tr_b16 v[252:253], v11 offset:12288
  ds_read_b64_tr_b16 v[254:255], v11 offset:13312
  s_waitcnt vmcnt(0) lgkmcnt(0)
  s_barrier
  v_and_b32 v12, 31, v2
  v_and_b32 v13, 3, v12
  v_bfe_u32 v14, v12, 2, 2
  v_lshl_or_b32 v13, v14, 3, v13
  v_bfe_u32 v14, v12, 4, 1
  v_lshl_or_b32 v12, v14, 2, v13
  v_lshrrev_b32 v13, 3, v12
  v_mul_u32_u24 v13, 10240, v13
  v_and_b32 v14, 7, v12
  v_lshl_add_u32 v13, v14, 7, v13
  v_bfe_u32 v14, v12, 1, 3
  v_lshrrev_b32 v12, 5, v2
  v_xor_b32 v14, v14, v12
  v_xor_b32 v12, 0, v14
  v_lshl_add_u32 v4, v12, 4, v13
  v_xor_b32 v12, 2, v14
  v_lshl_add_u32 v5, v12, 4, v13
  v_xor_b32 v12, 4, v14
  v_lshl_add_u32 v6, v12, 4, v13
  v_xor_b32 v12, 6, v14
  v_lshl_add_u32 v7, v12, 4, v13
  s_mul_i32 s45, s28, 10240
  s_mov_b32 s44, 0
  s_add_u32 m0, s45, 0
  s_add_u32 s5, s44, 0
  buffer_load_dwordx4 v3, s[12:15], s5 offen lds
  s_add_u32 m0, s45, 1024
  s_add_u32 s5, s44, 128
  buffer_load_dwordx4 v3, s[12:15], s5 offen lds
  s_add_u32 m0, s45, 2048
  s_add_u32 s5, s44, 256
  buffer_load_dwordx4 v3, s[12:15], s5 offen lds
  s_add_u32 m0, s45, 3072
  s_add_u32 s5, s44, 384
  buffer_load_dwordx4 v3, s[12:15], s5 offen lds
  s_add_u32 m0, s45, 4096
  s_add_u32 s5, s44, 512
  buffer_load_dwordx4 v3, s[12:15], s5 offen lds
  s_add_u32 m0, s45, 5120
  s_add_u32 s5, s44, 640
  buffer_load_dwordx4 v3, s[12:15], s5 offen lds
  s_add_u32 m0, s45, 6144
  s_add_u32 s5, s44, 768
  buffer_load_dwordx4 v3, s[12:15], s5 offen lds
  s_add_u32 m0, s45, 7168
  s_add_u32 s5, s44, 896
  buffer_load_dwordx4 v3, s[12:15], s5 offen lds
  s_add_u32 m0, s45, 8192
  s_add_u32 s5, s44, 1024
  buffer_load_dwordx4 v3, s[12:15], s5 offen lds
  s_add_u32 m0, s45, 9216
  s_add_u32 s5, s44, 1152
  buffer_load_dwordx4 v3, s[12:15], s5 offen lds
  s_add_u32 s44, s44, 40960
  s_add_u32 s45, s45, 40960
  s_add_u32 m0, s45, 0
  s_add_u32 s5, s44, 0
  buffer_load_dwordx4 v3, s[12:15], s5 offen lds
  s_add_u32 m0, s45, 1024
  s_add_u32 s5, s44, 128
  buffer_load_dwordx4 v3, s[12:15], s5 offen lds
  s_add_u32 m0, s45, 2048
  s_add_u32 s5, s44, 256
  buffer_load_dwordx4 v3, s[12:15], s5 offen lds
  s_add_u32 m0, s45, 3072
  s_add_u32 s5, s44, 384
  buffer_load_dwordx4 v3, s[12:15], s5 offen lds
  s_add_u32 m0, s45, 4096
  s_add_u32 s5, s44, 512
  buffer_load_dwordx4 v3, s[12:15], s5 offen lds
  s_add_u32 m0, s45, 5120
  s_add_u32 s5, s44, 640
  buffer_load_dwordx4 v3, s[12:15], s5 offen lds
  s_add_u32 m0, s45, 6144
  s_add_u32 s5, s44, 768
  buffer_load_dwordx4 v3, s[12:15], s5 offen lds
  s_add_u32 m0, s45, 7168
  s_add_u32 s5, s44, 896
  buffer_load_dwordx4 v3, s[12:15], s5 offen lds
  s_add_u32 m0, s45, 8192
  s_add_u32 s5, s44, 1024
  buffer_load_dwordx4 v3, s[12:15], s5 offen lds
  s_add_u32 m0, s45, 9216
  s_add_u32 s5, s44, 1152
  buffer_load_dwordx4 v3, s[12:15], s5 offen lds
  s_add_u32 s44, s44, 40960
  s_add_u32 s45, s45, 40960
  s_mov_b32 s46, 0
  s_mov_b32 s48, 2
  s_mov_b32 s49, 0
  s_mov_b32 s52, -81920
  s_mov_b32 s53, 40960
  s_lshl_b32 s47, s26, 11
  s_add_u32 s47, s47, s27
  s_lshl_b32 s47, s47, 14
  s_and_b32 s42, s28, 1
  s_lshl_b32 s42, s42, 12
  s_add_u32 s47, s47, s42
  s_add_u32 s47, s47, 8192
  s_lshl_b32 s50, s26, 5
  s_add_u32 s50, s50, s27
  s_lshl_b32 s50, s50, 7
  s_add_u32 s50, s50, 166723584
  s_waitcnt vmcnt(10)
  s_barrier
KV_LOOP_72:
  ds_read_b128 v[160:163], v4 offset:0
  ds_read_b128 v[164:167], v5 offset:0
  ds_read_b128 v[168:171], v6 offset:0
  ds_read_b128 v[172:175], v7 offset:0
  s_waitcnt lgkmcnt(3)
  v_mfma_f32_32x32x16_bf16 v[128:143], v[160:163], a[0:3], 0
  v_mfma_f32_32x32x16_bf16 v[144:159], v[160:163], a[160:163], 0
  ds_read_b128 v[160:163], v4 offset:1024
  s_waitcnt lgkmcnt(3)
  v_mfma_f32_32x32x16_bf16 v[128:143], v[164:167], a[4:7], v[128:143]
  v_mfma_f32_32x32x16_bf16 v[144:159], v[164:167], a[164:167], v[144:159]
  ds_read_b128 v[164:167], v5 offset:1024
  s_waitcnt lgkmcnt(3)
  v_mfma_f32_32x32x16_bf16 v[128:143], v[168:171], a[8:11], v[128:143]
  v_mfma_f32_32x32x16_bf16 v[144:159], v[168:171], a[168:171], v[144:159]
  s_add_u32 m0, s45, 0
  s_add_u32 s5, s44, 0
  buffer_load_dwordx4 v3, s[12:15], s5 offen lds
  ds_read_b128 v[168:171], v6 offset:1024
  s_waitcnt lgkmcnt(3)
  v_mfma_f32_32x32x16_bf16 v[128:143], v[172:175], a[12:15], v[128:143]
  v_mfma_f32_32x32x16_bf16 v[144:159], v[172:175], a[172:175], v[144:159]
  ds_read_b128 v[172:175], v7 offset:1024
  s_waitcnt lgkmcnt(3)
  v_mfma_f32_32x32x16_bf16 v[128:143], v[160:163], a[16:19], v[128:143]
  v_mfma_f32_32x32x16_bf16 v[144:159], v[160:163], a[176:179], v[144:159]
  ds_read_b128 v[160:163], v4 offset:2048
  s_waitcnt lgkmcnt(3)
  v_mfma_f32_32x32x16_bf16 v[128:143], v[164:167], a[20:23], v[128:143]
  v_mfma_f32_32x32x16_bf16 v[144:159], v[164:167], a[180:183], v[144:159]
  s_add_u32 m0, s45, 1024
  s_add_u32 s5, s44, 128
  buffer_load_dwordx4 v3, s[12:15], s5 offen lds
  ds_read_b128 v[164:167], v5 offset:2048
  s_waitcnt lgkmcnt(3)
  v_mfma_f32_32x32x16_bf16 v[128:143], v[168:171], a[24:27], v[128:143]
  v_mfma_f32_32x32x16_bf16 v[144:159], v[168:171], a[184:187], v[144:159]
  ds_read_b128 v[168:171], v6 offset:2048
  s_waitcnt lgkmcnt(3)
  v_mfma_f32_32x32x16_bf16 v[128:143], v[172:175], a[28:31], v[128:143]
  v_mfma_f32_32x32x16_bf16 v[144:159], v[172:175], a[188:191], v[144:159]
  ds_read_b128 v[172:175], v7 offset:2048
  s_waitcnt lgkmcnt(3)
  v_mfma_f32_32x32x16_bf16 v[128:143], v[160:163], a[32:35], v[128:143]
  v_mfma_f32_32x32x16_bf16 v[144:159], v[160:163], a[192:195], v[144:159]
  s_add_u32 m0, s45, 2048
  s_add_u32 s5, s44, 256
  buffer_load_dwordx4 v3, s[12:15], s5 offen lds
  ds_read_b128 v[160:163], v4 offset:3072
  s_waitcnt lgkmcnt(3)
  v_mfma_f32_32x32x16_bf16 v[128:143], v[164:167], a[36:39], v[128:143]
  v_mfma_f32_32x32x16_bf16 v[144:159], v[164:167], a[196:199], v[144:159]
  ds_read_b128 v[164:167], v5 offset:3072
  s_waitcnt lgkmcnt(3)
  v_mfma_f32_32x32x16_bf16 v[128:143], v[168:171], a[40:43], v[128:143]
  v_mfma_f32_32x32x16_bf16 v[144:159], v[168:171], a[200:203], v[144:159]
  ds_read_b128 v[168:171], v6 offset:3072
  s_waitcnt lgkmcnt(3)
  v_mfma_f32_32x32x16_bf16 v[128:143], v[172:175], a[44:47], v[128:143]
  v_mfma_f32_32x32x16_bf16 v[144:159], v[172:175], a[204:207], v[144:159]
  s_add_u32 m0, s45, 3072
  s_add_u32 s5, s44, 384
  buffer_load_dwordx4 v3, s[12:15], s5 offen lds
  ds_read_b128 v[172:175], v7 offset:3072
  s_waitcnt lgkmcnt(3)
  v_mfma_f32_32x32x16_bf16 v[128:143], v[160:163], a[48:51], v[128:143]
  v_mfma_f32_32x32x16_bf16 v[144:159], v[160:163], a[208:211], v[144:159]
  ds_read_b128 v[160:163], v4 offset:4096
  s_waitcnt lgkmcnt(3)
  v_mfma_f32_32x32x16_bf16 v[128:143], v[164:167], a[52:55], v[128:143]
  v_mfma_f32_32x32x16_bf16 v[144:159], v[164:167], a[212:215], v[144:159]
  ds_read_b128 v[164:167], v5 offset:4096
  s_waitcnt lgkmcnt(3)
  v_mfma_f32_32x32x16_bf16 v[128:143], v[168:171], a[56:59], v[128:143]
  v_mfma_f32_32x32x16_bf16 v[144:159], v[168:171], a[216:219], v[144:159]
  s_add_u32 m0, s45, 4096
  s_add_u32 s5, s44, 512
  buffer_load_dwordx4 v3, s[12:15], s5 offen lds
  ds_read_b128 v[168:171], v6 offset:4096
  s_waitcnt lgkmcnt(3)
  v_mfma_f32_32x32x16_bf16 v[128:143], v[172:175], a[60:63], v[128:143]
  v_mfma_f32_32x32x16_bf16 v[144:159], v[172:175], a[220:223], v[144:159]
  ds_read_b128 v[172:175], v7 offset:4096
  s_waitcnt lgkmcnt(3)
  v_mfma_f32_32x32x16_bf16 v[128:143], v[160:163], a[64:67], v[128:143]
  v_mfma_f32_32x32x16_bf16 v[144:159], v[160:163], a[224:227], v[144:159]
  ds_read_b128 v[160:163], v4 offset:5120
  s_waitcnt lgkmcnt(3)
  v_mfma_f32_32x32x16_bf16 v[128:143], v[164:167], a[68:71], v[128:143]
  v_mfma_f32_32x32x16_bf16 v[144:159], v[164:167], a[228:231], v[144:159]
  s_add_u32 m0, s45, 5120
  s_add_u32 s5, s44, 640
  buffer_load_dwordx4 v3, s[12:15], s5 offen lds
  ds_read_b128 v[164:167], v5 offset:5120
  s_waitcnt lgkmcnt(3)
  v_mfma_f32_32x32x16_bf16 v[128:143], v[168:171], a[72:75], v[128:143]
  v_mfma_f32_32x32x16_bf16 v[144:159], v[168:171], a[232:235], v[144:159]
  ds_read_b128 v[168:171], v6 offset:5120
  s_waitcnt lgkmcnt(3)
  v_mfma_f32_32x32x16_bf16 v[128:143], v[172:175], a[76:79], v[128:143]
  v_mfma_f32_32x32x16_bf16 v[144:159], v[172:175], a[236:239], v[144:159]
  ds_read_b128 v[172:175], v7 offset:5120
  s_waitcnt lgkmcnt(3)
  v_mfma_f32_32x32x16_bf16 v[128:143], v[160:163], a[80:83], v[128:143]
  v_mfma_f32_32x32x16_bf16 v[144:159], v[160:163], a[240:243], v[144:159]
  s_add_u32 m0, s45, 6144
  s_add_u32 s5, s44, 768
  buffer_load_dwordx4 v3, s[12:15], s5 offen lds
  ds_read_b128 v[160:163], v4 offset:6144
  s_waitcnt lgkmcnt(3)
  v_mfma_f32_32x32x16_bf16 v[128:143], v[164:167], a[84:87], v[128:143]
  v_mfma_f32_32x32x16_bf16 v[144:159], v[164:167], a[244:247], v[144:159]
  ds_read_b128 v[164:167], v5 offset:6144
  s_waitcnt lgkmcnt(3)
  v_mfma_f32_32x32x16_bf16 v[128:143], v[168:171], a[88:91], v[128:143]
  v_mfma_f32_32x32x16_bf16 v[144:159], v[168:171], a[248:251], v[144:159]
  ds_read_b128 v[168:171], v6 offset:6144
  s_waitcnt lgkmcnt(3)
  v_mfma_f32_32x32x16_bf16 v[128:143], v[172:175], a[92:95], v[128:143]
  v_mfma_f32_32x32x16_bf16 v[144:159], v[172:175], a[252:255], v[144:159]
  s_add_u32 m0, s45, 7168
  s_add_u32 s5, s44, 896
  buffer_load_dwordx4 v3, s[12:15], s5 offen lds
  ds_read_b128 v[172:175], v7 offset:6144
  s_waitcnt lgkmcnt(3)
  v_mfma_f32_32x32x16_bf16 v[128:143], v[160:163], a[96:99], v[128:143]
  v_mfma_f32_32x32x16_bf16 v[144:159], v[160:163], v[192:195], v[144:159]
  ds_read_b128 v[160:163], v4 offset:7168
  s_waitcnt lgkmcnt(3)
  v_mfma_f32_32x32x16_bf16 v[128:143], v[164:167], a[100:103], v[128:143]
  v_mfma_f32_32x32x16_bf16 v[144:159], v[164:167], v[196:199], v[144:159]
  ds_read_b128 v[164:167], v5 offset:7168
  s_waitcnt lgkmcnt(3)
  v_mfma_f32_32x32x16_bf16 v[128:143], v[168:171], a[104:107], v[128:143]
  v_mfma_f32_32x32x16_bf16 v[144:159], v[168:171], v[200:203], v[144:159]
  s_add_u32 m0, s45, 8192
  s_add_u32 s5, s44, 1024
  buffer_load_dwordx4 v3, s[12:15], s5 offen lds
  ds_read_b128 v[168:171], v6 offset:7168
  s_waitcnt lgkmcnt(3)
  v_mfma_f32_32x32x16_bf16 v[128:143], v[172:175], a[108:111], v[128:143]
  v_mfma_f32_32x32x16_bf16 v[144:159], v[172:175], v[204:207], v[144:159]
  ds_read_b128 v[172:175], v7 offset:7168
  s_waitcnt lgkmcnt(3)
  v_mfma_f32_32x32x16_bf16 v[128:143], v[160:163], a[112:115], v[128:143]
  v_mfma_f32_32x32x16_bf16 v[144:159], v[160:163], v[208:211], v[144:159]
  ds_read_b128 v[160:163], v4 offset:8192
  s_waitcnt lgkmcnt(3)
  v_mfma_f32_32x32x16_bf16 v[128:143], v[164:167], a[116:119], v[128:143]
  v_mfma_f32_32x32x16_bf16 v[144:159], v[164:167], v[212:215], v[144:159]
  s_add_u32 m0, s45, 9216
  s_add_u32 s5, s44, 1152
  buffer_load_dwordx4 v3, s[12:15], s5 offen lds
  ds_read_b128 v[164:167], v5 offset:8192
  s_waitcnt lgkmcnt(3)
  v_mfma_f32_32x32x16_bf16 v[128:143], v[168:171], a[120:123], v[128:143]
  v_mfma_f32_32x32x16_bf16 v[144:159], v[168:171], v[216:219], v[144:159]
  ds_read_b128 v[168:171], v6 offset:8192
  s_waitcnt lgkmcnt(3)
  v_mfma_f32_32x32x16_bf16 v[128:143], v[172:175], a[124:127], v[128:143]
  v_mfma_f32_32x32x16_bf16 v[144:159], v[172:175], v[220:223], v[144:159]
  ds_read_b128 v[172:175], v7 offset:8192
  s_waitcnt lgkmcnt(3)
  v_mfma_f32_32x32x16_bf16 v[128:143], v[160:163], a[128:131], v[128:143]
  v_mfma_f32_32x32x16_bf16 v[144:159], v[160:163], v[224:227], v[144:159]
  ds_read_b128 v[160:163], v4 offset:9216
  s_waitcnt lgkmcnt(3)
  v_mfma_f32_32x32x16_bf16 v[128:143], v[164:167], a[132:135], v[128:143]
  v_mfma_f32_32x32x16_bf16 v[144:159], v[164:167], v[228:231], v[144:159]
  ds_read_b128 v[164:167], v5 offset:9216
  s_waitcnt lgkmcnt(3)
  v_mfma_f32_32x32x16_bf16 v[128:143], v[168:171], a[136:139], v[128:143]
  v_mfma_f32_32x32x16_bf16 v[144:159], v[168:171], v[232:235], v[144:159]
  ds_read_b128 v[168:171], v6 offset:9216
  s_waitcnt lgkmcnt(3)
  v_mfma_f32_32x32x16_bf16 v[128:143], v[172:175], a[140:143], v[128:143]
  v_mfma_f32_32x32x16_bf16 v[144:159], v[172:175], v[236:239], v[144:159]
  ds_read_b128 v[172:175], v7 offset:9216
  s_waitcnt lgkmcnt(3)
  v_mfma_f32_32x32x16_bf16 v[128:143], v[160:163], a[144:147], v[128:143]
  v_mfma_f32_32x32x16_bf16 v[144:159], v[160:163], v[240:243], v[144:159]
  s_waitcnt lgkmcnt(2)
  v_mfma_f32_32x32x16_bf16 v[128:143], v[164:167], a[148:151], v[128:143]
  v_mfma_f32_32x32x16_bf16 v[144:159], v[164:167], v[244:247], v[144:159]
  s_waitcnt lgkmcnt(1)
  v_mfma_f32_32x32x16_bf16 v[128:143], v[168:171], a[152:155], v[128:143]
  v_mfma_f32_32x32x16_bf16 v[144:159], v[168:171], v[248:251], v[144:159]
  s_waitcnt lgkmcnt(0)
  v_mfma_f32_32x32x16_bf16 v[128:143], v[172:175], a[156:159], v[128:143]
  v_mfma_f32_32x32x16_bf16 v[144:159], v[172:175], v[252:255], v[144:159]
  s_add_u32 s49, s49, 1
  s_cmp_eq_u32 s49, 3
  s_cselect_b32 s51, s52, s53
  s_cselect_b32 s49, 0, s49
  v_add_u32 v4, s51, v4
  v_add_u32 v5, s51, v5
  v_add_u32 v6, s51, v6
  v_add_u32 v7, s51, v7
  s_nop 2
  v_cvt_pk_bf16_f32 v176, v128, v129
  v_cvt_pk_bf16_f32 v177, v130, v131
  v_cvt_pk_bf16_f32 v178, v132, v133
  v_cvt_pk_bf16_f32 v179, v134, v135
  v_cvt_pk_bf16_f32 v180, v136, v137
  v_cvt_pk_bf16_f32 v181, v138, v139
  v_cvt_pk_bf16_f32 v182, v140, v141
  v_cvt_pk_bf16_f32 v183, v142, v143
  v_cvt_pk_bf16_f32 v184, v144, v145
  v_cvt_pk_bf16_f32 v185, v146, v147
  v_cvt_pk_bf16_f32 v186, v148, v149
  v_cvt_pk_bf16_f32 v187, v150, v151
  v_cvt_pk_bf16_f32 v188, v152, v153
  v_cvt_pk_bf16_f32 v189, v154, v155
  v_cvt_pk_bf16_f32 v190, v156, v157
  v_cvt_pk_bf16_f32 v191, v158, v159
  buffer_store_dwordx4 v[176:179], v8, s[8:11], s47 offen offset:0 sc1
  buffer_store_dwordx4 v[180:183], v8, s[8:11], s47 offen offset:256 sc1
  buffer_store_dwordx4 v[184:187], v8, s[8:11], s47 offen offset:2048 sc1
  buffer_store_dwordx4 v[188:191], v8, s[8:11], s47 offen offset:2304 sc1
  s_cmp_eq_u32 s46, 0
  s_cbranch_scc1 KV_W0_73
  s_waitcnt vmcnt(14)
  s_mov_b32 s54, s46
  s_branch KV_W1_74
KV_W0_73:
  s_waitcnt vmcnt(0)
  s_mov_b32 s54, 1
KV_W1_74:
  s_barrier
  s_cmp_lg_u32 s28, 0
  s_cbranch_scc1 KV_NF_75
  v_mov_b32 v15, s54
  v_mov_b32 v16, 0
  s_mov_b64 exec, 1
  buffer_store_dword v15, v16, s[8:11], s50 offen sc1
  s_mov_b64 exec, -1
KV_NF_75:
  s_add_u32 s44, s44, 40960
  s_add_u32 s45, s45, 40960
  s_add_u32 s48, s48, 1
  s_cmp_eq_u32 s48, 3
  s_cselect_b32 s48, 0, s48
  s_cselect_b32 s51, 122880, 0
  s_sub_u32 s45, s45, s51
  s_add_u32 s47, s47, 524288
  s_add_u32 s46, s46, 1
  s_cmp_lt_u32 s46, 64
  s_cbranch_scc1 KV_LOOP_72
  s_waitcnt vmcnt(0)
  s_barrier
  s_cmp_lg_u32 s28, 0
  s_cbranch_scc1 KV_DONE_66
  v_mov_b32 v15, 64
  v_mov_b32 v16, 0
  s_mov_b64 exec, 1
  buffer_store_dword v15, v16, s[8:11], s50 offen sc1
  s_mov_b64 exec, -1
  s_waitcnt vmcnt(0)
  s_branch KV_DONE_66
KV_DONE_66:
  s_branch L_END
L_QA:
  s_mul_i32 s4, s26, 56
  s_add_u32 s30, s0, s4
  s_addc_u32 s31, s1, 0
  s_lshl_b32 s4, s26, 5
  s_add_u32 s4, s4, s27
  s_lshl_b32 s4, s4, 7
  s_add_u32 s4, s4, 166739968
  v_mov_b32 v12, 0
  v_mov_b32 v13, 0
  s_mov_b64 exec, 1
  buffer_store_dword v12, v13, s[8:11], s4 offen sc1
  s_mov_b64 exec, -1
  s_waitcnt vmcnt(0)
  s_barrier
  s_cmp_lg_u32 s28, 0
  s_cbranch_scc1 IA_77
  v_mov_b32 v12, 32
  v_mov_b32 v13, 1
  s_mov_b64 exec, 1
  global_atomic_add v12, v13, s[24:25]
  s_mov_b64 exec, -1
  s_waitcnt vmcnt(0)
IA_77:
  v_mov_b32 v13, 32
  s_mov_b32 s7, 0
IW_78:
  global_load_dword v12, v13, s[24:25] sc1
  s_add_u32 s7, s7, 1
  s_cmp_gt_u32 s7, 0x400000
  s_cbranch_scc1 IWX_79
  s_waitcnt vmcnt(0)
  v_readfirstlane_b32 s6, v12
  s_nop 0
  s_cmp_ge_u32 s6, 256
  s_cbranch_scc1 IWX_79
  s_sleep 2
  s_branch IW_78
IWX_79:
  s_waitcnt vmcnt(0)
  s_lshl_b32 s4, s26, 5
  s_add_u32 s4, s4, s27
  s_lshl_b32 s4, s4, 7
  s_add_u32 s59, s4, 166723584
  s_mov_b32 s55, 1
  s_mov_b32 s7, 0
  v_mov_b32 v13, 0
QA_PS_80:
  buffer_load_dword v12, v13, s[8:11], s59 offen sc1
  s_add_u32 s7, s7, 1
  s_cmp_gt_u32 s7, 0x40000
  s_cbranch_scc1 QA_PSX_81
  s_waitcnt vmcnt(0)
  v_readfirstlane_b32 s6, v12
  s_nop 0
  s_cmp_ge_u32 s6, s55
  s_cbranch_scc1 QA_PSX_81
  s_sleep 8
  s_branch QA_PS_80
QA_PSX_81:
  s_waitcnt vmcnt(0)
  s_load_dwordx2 s[4:5], s[30:31], 0
  s_waitcnt lgkmcnt(0)
  s_mov_b32 s12, s4
  s_and_b32 s13, s5, 0xffff
  s_mov_b32 s14, 0x280000
  s_mov_b32 s15, 0x20000
  s_load_dwordx2 s[4:5], s[30:31], 16
  s_waitcnt lgkmcnt(0)
  s_mov_b32 s16, s4
  s_and_b32 s17, s5, 0xffff
  s_mov_b32 s18, 0x500000
  s_mov_b32 s19, 0x20000
  v_lshlrev_b32 v1, 4, v2
  v_lshrrev_b32 v12, 4, v2
  v_lshlrev_b32 v13, 2, v12
  v_and_b32 v14, 15, v2
  v_xor_b32 v13, v13, v14
  v_lshlrev_b32 v13, 4, v13
  v_lshl_add_u32 v9, v12, 13, v13
  s_lshl_b32 s40, s27, 8
  s_lshl_b32 s43, s28, 17
  s_add_u32 s40, s40, s43
  s_lshl_b32 s41, s28, 12
  s_add_u32 m0, s41, 0
  s_add_u32 s5, s40, 0
  buffer_load_dwordx4 v9, s[16:19], s5 offen nt lds
  s_add_u32 m0, s41, 1024
  s_add_u32 s5, s40, 32768
  buffer_load_dwordx4 v9, s[16:19], s5 offen nt lds
  s_add_u32 m0, s41, 2048
  s_add_u32 s5, s40, 65536
  buffer_load_dwordx4 v9, s[16:19], s5 offen nt lds
  s_add_u32 m0, s41, 3072
  s_add_u32 s5, s40, 98304
  buffer_load_dwordx4 v9, s[16:19], s5 offen nt lds
  s_add_u32 m0, s41, 16384
  s_add_u32 s5, s40, 524288
  buffer_load_dwordx4 v9, s[16:19], s5 offen nt lds
  s_add_u32 m0, s41, 17408
  s_add_u32 s5, s40, 557056
  buffer_load_dwordx4 v9, s[16:19], s5 offen nt lds
  s_add_u32 m0, s41, 18432
  s_add_u32 s5, s40, 589824
  buffer_load_dwordx4 v9, s[16:19], s5 offen nt lds
  s_add_u32 m0, s41, 19456
  s_add_u32 s5, s40, 622592
  buffer_load_dwordx4 v9, s[16:19], s5 offen nt lds
  s_add_u32 m0, s41, 32768
  s_add_u32 s5, s40, 1048576
  buffer_load_dwordx4 v9, s[16:19], s5 offen nt lds
  s_add_u32 m0, s41, 33792
  s_add_u32 s5, s40, 1081344
  buffer_load_dwordx4 v9, s[16:19], s5 offen nt lds
  s_add_u32 m0, s41, 34816
  s_add_u32 s5, s40, 1114112
  buffer_load_dwordx4 v9, s[16:19], s5 offen nt lds
  s_add_u32 m0, s41, 35840
  s_add_u32 s5, s40, 1146880
  buffer_load_dwordx4 v9, s[16:19], s5 offen nt lds
  s_add_u32 m0, s41, 49152
  s_add_u32 s5, s40, 1572864
  buffer_load_dwordx4 v9, s[16:19], s5 offen nt lds
  s_add_u32 m0, s41, 50176
  s_add_u32 s5, s40, 1605632
  buffer_load_dwordx4 v9, s[16:19], s5 offen nt lds
  s_add_u32 m0, s41, 51200
  s_add_u32 s5, s40, 1638400
  buffer_load_dwordx4 v9, s[16:19], s5 offen nt lds
  s_add_u32 m0, s41, 52224
  s_add_u32 s5, s40, 1671168
  buffer_load_dwordx4 v9, s[16:19], s5 offen nt lds
  s_add_u32 m0, s41, 65536
  s_add_u32 s5, s40, 2097152
  buffer_load_dwordx4 v9, s[16:19], s5 offen nt lds
  s_add_u32 m0, s41, 66560
  s_add_u32 s5, s40, 2129920
  buffer_load_dwordx4 v9, s[16:19], s5 offen nt lds
  s_add_u32 m0, s41, 67584
  s_add_u32 s5, s40, 2162688
  buffer_load_dwordx4 v9, s[16:19], s5 offen nt lds
  s_add_u32 m0, s41, 68608
  s_add_u32 s5, s40, 2195456
  buffer_load_dwordx4 v9, s[16:19], s5 offen nt lds
  s_add_u32 m0, s41, 81920
  s_add_u32 s5, s40, 2621440
  buffer_load_dwordx4 v9, s[16:19], s5 offen nt lds
  s_add_u32 m0, s41, 82944
  s_add_u32 s5, s40, 2654208
  buffer_load_dwordx4 v9, s[16:19], s5 offen nt lds
  s_add_u32 m0, s41, 83968
  s_add_u32 s5, s40, 2686976
  buffer_load_dwordx4 v9, s[16:19], s5 offen nt lds
  s_add_u32 m0, s41, 84992
  s_add_u32 s5, s40, 2719744
  buffer_load_dwordx4 v9, s[16:19], s5 offen nt lds
  s_add_u32 m0, s41, 98304
  s_add_u32 s5, s40, 3145728
  buffer_load_dwordx4 v9, s[16:19], s5 offen nt lds
  s_add_u32 m0, s41, 99328
  s_add_u32 s5, s40, 3178496
  buffer_load_dwordx4 v9, s[16:19], s5 offen nt lds
  s_add_u32 m0, s41, 100352
  s_add_u32 s5, s40, 3211264
  buffer_load_dwordx4 v9, s[16:19], s5 offen nt lds
  s_add_u32 m0, s41, 101376
  s_add_u32 s5, s40, 3244032
  buffer_load_dwordx4 v9, s[16:19], s5 offen nt lds
  v_bfe_u32 v12, v2, 4, 1
  v_and_b32 v13, 1, v2
  v_bfe_u32 v14, v2, 1, 1
  v_lshl_or_b32 v12, v13, 1, v12
  v_lshlrev_b32 v13, 3, v14
  s_lshl_b32 s42, s28, 2
  v_or_b32 v12, s42, v12
  v_bfe_u32 v14, v2, 2, 2
  v_lshlrev_b32 v10, 2, v14
  v_xor_b32 v12, v12, v10
  v_lshl_add_u32 v13, v12, 4, v13
  v_lshl_add_u32 v13, v14, 8, v13
  v_lshrrev_b32 v14, 5, v2
  v_lshl_add_u32 v10, v14, 11, v13
  s_waitcnt vmcnt(24) lgkmcnt(0)
  s_barrier
  v_add_u32 v15, 0, v10
  ds_read_b64_tr_b16 a[0:1], v15 offset:0
  ds_read_b64_tr_b16 a[2:3], v15 offset:1024
  ds_read_b64_tr_b16 a[4:5], v15 offset:4096
  ds_read_b64_tr_b16 a[6:7], v15 offset:5120
  ds_read_b64_tr_b16 a[8:9], v15 offset:8192
  ds_read_b64_tr_b16 a[10:11], v15 offset:9216
  ds_read_b64_tr_b16 a[12:13], v15 offset:12288
  ds_read_b64_tr_b16 a[14:15], v15 offset:13312
  s_waitcnt vmcnt(20) lgkmcnt(0)
  s_barrier
  s_add_u32 m0, s41, 114688
  s_add_u32 s5, s40, 3670016
  buffer_load_dwordx4 v9, s[16:19], s5 offen nt lds
  s_add_u32 m0, s41, 115712
  s_add_u32 s5, s40, 3702784
  buffer_load_dwordx4 v9, s[16:19], s5 offen nt lds
  s_add_u32 m0, s41, 116736
  s_add_u32 s5, s40, 3735552
  buffer_load_dwordx4 v9, s[16:19], s5 offen nt lds
  s_add_u32 m0, s41, 117760
  s_add_u32 s5, s40, 3768320
  buffer_load_dwordx4 v9, s[16:19], s5 offen nt lds
  v_add_u32 v15, 16384, v10
  ds_read_b64_tr_b16 a[16:17], v15 offset:0
  ds_read_b64_tr_b16 a[18:19], v15 offset:1024
  ds_read_b64_tr_b16 a[20:21], v15 offset:4096
  ds_read_b64_tr_b16 a[22:23], v15 offset:5120
  ds_read_b64_tr_b16 a[24:25], v15 offset:8192
  ds_read_b64_tr_b16 a[26:27], v15 offset:9216
  ds_read_b64_tr_b16 a[28:29], v15 offset:12288
  ds_read_b64_tr_b16 a[30:31], v15 offset:13312
  s_waitcnt vmcnt(20) lgkmcnt(0)
  s_barrier
  s_add_u32 m0, s41, 0
  s_add_u32 s5, s40, 4194304
  buffer_load_dwordx4 v9, s[16:19], s5 offen nt lds
  s_add_u32 m0, s41, 1024
  s_add_u32 s5, s40, 4227072
  buffer_load_dwordx4 v9, s[16:19], s5 offen nt lds
  s_add_u32 m0, s41, 2048
  s_add_u32 s5, s40, 4259840
  buffer_load_dwordx4 v9, s[16:19], s5 offen nt lds
  s_add_u32 m0, s41, 3072
  s_add_u32 s5, s40, 4292608
  buffer_load_dwordx4 v9, s[16:19], s5 offen nt lds
  v_add_u32 v15, 32768, v10
  ds_read_b64_tr_b16 a[32:33], v15 offset:0
  ds_read_b64_tr_b16 a[34:35], v15 offset:1024
  ds_read_b64_tr_b16 a[36:37], v15 offset:4096
  ds_read_b64_tr_b16 a[38:39], v15 offset:5120
  ds_read_b64_tr_b16 a[40:41], v15 offset:8192
  ds_read_b64_tr_b16 a[42:43], v15 offset:9216
  ds_read_b64_tr_b16 a[44:45], v15 offset:12288
  ds_read_b64_tr_b16 a[46:47], v15 offset:13312
  s_waitcnt vmcnt(20) lgkmcnt(0)
  s_barrier
  s_add_u32 m0, s41, 16384
  s_add_u32 s5, s40, 4718592
  buffer_load_dwordx4 v9, s[16:19], s5 offen nt lds
  s_add_u32 m0, s41, 17408
  s_add_u32 s5, s40, 4751360
  buffer_load_dwordx4 v9, s[16:19], s5 offen nt lds
  s_add_u32 m0, s41, 18432
  s_add_u32 s5, s40, 4784128
  buffer_load_dwordx4 v9, s[16:19], s5 offen nt lds
  s_add_u32 m0, s41, 19456
  s_add_u32 s5, s40, 4816896
  buffer_load_dwordx4 v9, s[16:19], s5 offen nt lds
  v_add_u32 v15, 49152, v10
  ds_read_b64_tr_b16 a[48:49], v15 offset:0
  ds_read_b64_tr_b16 a[50:51], v15 offset:1024
  ds_read_b64_tr_b16 a[52:53], v15 offset:4096
  ds_read_b64_tr_b16 a[54:55], v15 offset:5120
  ds_read_b64_tr_b16 a[56:57], v15 offset:8192
  ds_read_b64_tr_b16 a[58:59], v15 offset:9216
  ds_read_b64_tr_b16 a[60:61], v15 offset:12288
  ds_read_b64_tr_b16 a[62:63], v15 offset:13312
  s_waitcnt vmcnt(20) lgkmcnt(0)
  s_barrier
  v_add_u32 v15, 65536, v10
  ds_read_b64_tr_b16 a[64:65], v15 offset:0
  ds_read_b64_tr_b16 a[66:67], v15 offset:1024
  ds_read_b64_tr_b16 a[68:69], v15 offset:4096
  ds_read_b64_tr_b16 a[70:71], v15 offset:5120
  ds_read_b64_tr_b16 a[72:73], v15 offset:8192
  ds_read_b64_tr_b16 a[74:75], v15 offset:9216
  ds_read_b64_tr_b16 a[76:77], v15 offset:12288
  ds_read_b64_tr_b16 a[78:79], v15 offset:13312
  s_waitcnt vmcnt(16) lgkmcnt(0)
  s_barrier
  v_add_u32 v15, 81920, v10
  ds_read_b64_tr_b16 a[80:81], v15 offset:0
  ds_read_b64_tr_b16 a[82:83], v15 offset:1024
  ds_read_b64_tr_b16 a[84:85], v15 offset:4096
  ds_read_b64_tr_b16 a[86:87], v15 offset:5120
  ds_read_b64_tr_b16 a[88:89], v15 offset:8192
  ds_read_b64_tr_b16 a[90:91], v15 offset:9216
  ds_read_b64_tr_b16 a[92:93], v15 offset:12288
  ds_read_b64_tr_b16 a[94:95], v15 offset:13312
  s_waitcnt vmcnt(12) lgkmcnt(0)
  s_barrier
  v_add_u32 v15, 98304, v10
  ds_read_b64_tr_b16 a[96:97], v15 offset:0
  ds_read_b64_tr_b16 a[98:99], v15 offset:1024
  ds_read_b64_tr_b16 a[100:101], v15 offset:4096
  ds_read_b64_tr_b16 a[102:103], v15 offset:5120
  ds_read_b64_tr_b16 a[104:105], v15 offset:8192
  ds_read_b64_tr_b16 a[106:107], v15 offset:9216
  ds_read_b64_tr_b16 a[108:109], v15 offset:12288
  ds_read_b64_tr_b16 a[110:111], v15 offset:13312
  s_waitcnt vmcnt(8) lgkmcnt(0)
  s_barrier
  v_add_u32 v15, 114688, v10
  ds_read_b64_tr_b16 a[112:113], v15 offset:0
  ds_read_b64_tr_b16 a[114:115], v15 offset:1024
  ds_read_b64_tr_b16 a[116:117], v15 offset:4096
  ds_read_b64_tr_b16 a[118:119], v15 offset:5120
  ds_read_b64_tr_b16 a[120:121], v15 offset:8192
  ds_read_b64_tr_b16 a[122:123], v15 offset:9216
  ds_read_b64_tr_b16 a[124:125], v15 offset:12288
  ds_read_b64_tr_b16 a[126:127], v15 offset:13312
  s_waitcnt vmcnt(4) lgkmcnt(0)
  s_barrier
  v_add_u32 v15, 0, v10
  ds_read_b64_tr_b16 a[128:129], v15 offset:0
  ds_read_b64_tr_b16 a[130:131], v15 offset:1024
  ds_read_b64_tr_b16 a[132:133], v15 offset:4096
  ds_read_b64_tr_b16 a[134:135], v15 offset:5120
  ds_read_b64_tr_b16 a[136:137], v15 offset:8192
  ds_read_b64_tr_b16 a[138:139], v15 offset:9216
  ds_read_b64_tr_b16 a[140:141], v15 offset:12288
  ds_read_b64_tr_b16 a[142:143], v15 offset:13312
  s_waitcnt vmcnt(0) lgkmcnt(0)
  s_barrier
  v_add_u32 v15, 16384, v10
  ds_read_b64_tr_b16 a[144:145], v15 offset:0
  ds_read_b64_tr_b16 a[146:147], v15 offset:1024
  ds_read_b64_tr_b16 a[148:149], v15 offset:4096
  ds_read_b64_tr_b16 a[150:151], v15 offset:5120
  ds_read_b64_tr_b16 a[152:153], v15 offset:8192
  ds_read_b64_tr_b16 a[154:155], v15 offset:9216
  ds_read_b64_tr_b16 a[156:157], v15 offset:12288
  ds_read_b64_tr_b16 a[158:159], v15 offset:13312
  s_waitcnt vmcnt(0) lgkmcnt(0)
  s_barrier
  s_lshl_b32 s4, s28, 3
  v_lshrrev_b32 v12, 3, v2
  v_add_u32 v12, s4, v12
  v_bfe_u32 v13, v12, 1, 3
  v_and_b32 v3, 7, v2
  v_xor_b32 v13, v13, v3
  v_lshlrev_b32 v13, 4, v13
  v_mul_u32_u24 v12, 1280, v12
  v_add_u32 v3, v12, v13
  v_and_b32 v12, 31, v2
  v_lshrrev_b32 v13, 3, v12
  v_mul_u32_u24 v13, 10240, v13
  v_and_b32 v14, 7, v12
  v_lshl_add_u32 v13, v14, 7, v13
  v_bfe_u32 v14, v12, 1, 3
  v_lshrrev_b32 v12, 5, v2
  v_xor_b32 v14, v14, v12
  v_xor_b32 v12, 0, v14
  v_lshl_add_u32 v4, v12, 4, v13
  v_xor_b32 v12, 2, v14
  v_lshl_add_u32 v5, v12, 4, v13
  v_xor_b32 v12, 4, v14
  v_lshl_add_u32 v6, v12, 4, v13
  v_xor_b32 v12, 6, v14
  v_lshl_add_u32 v7, v12, 4, v13
  v_bfe_u32 v12, v2, 4, 1
  v_lshlrev_b32 v12, 10, v12
  v_lshrrev_b32 v13, 5, v2
  v_lshl_add_u32 v12, v13, 9, v12
  v_and_b32 v13, 15, v2
  v_lshl_add_u32 v12, v13, 4, v12
  s_lshl_b32 s4, s28, 11
  s_add_u32 s4, s4, 81920
  v_add_u32 v8, s4, v12
  v_and_b32 v12, 3, v2
  v_lshlrev_b32 v12, 4, v12
  v_bfe_u32 v13, v2, 4, 1
  v_lshl_add_u32 v12, v13, 3, v12
  v_bfe_u32 v13, v2, 2, 2
  v_add_u32 v12, v12, v13
  v_lshlrev_b32 v12, 4, v12
  v_lshrrev_b32 v13, 5, v2
  v_lshl_add_u32 v11, v13, 3, v12
  v_and_b32 v12, 15, v2
  v_lshrrev_b32 v13, 4, v2
  v_lshlrev_b32 v13, 2, v13
  v_add_u32 v14, 0, v13
  v_cmp_le_u32 s[64:65], v14, v12
  v_add_u32 v14, 1, v13
  v_cmp_le_u32 s[66:67], v14, v12
  v_add_u32 v14, 2, v13
  v_cmp_le_u32 s[68:69], v14, v12
  v_add_u32 v14, 3, v13
  v_cmp_le_u32 s[70:71], v14, v12
  s_and_b32 s4, s28, 1
  s_cmp_eq_u32 s4, 1
  s_cselect_b64 s[72:73], s[64:65], 0
  s_cselect_b64 s[74:75], s[66:67], 0
  s_cselect_b64 s[76:77], s[68:69], 0
  s_cselect_b64 s[78:79], s[70:71], 0
  s_cselect_b64 s[64:65], -1, s[64:65]
  s_cselect_b64 s[66:67], -1, s[66:67]
  s_cselect_b64 s[68:69], -1, s[68:69]
  s_cselect_b64 s[70:71], -1, s[70:71]
  s_mov_b32 s50, 0x3e0293ee
  s_lshl_b32 s4, s26, 11
  s_add_u32 s4, s4, s27
  s_lshl_b32 s33, s4, 14
  s_lshl_b32 s5, s28, 12
  s_add_u32 s33, s33, s5
  s_lshl_b32 s34, s4, 12
  s_lshl_b32 s5, s28, 10
  s_add_u32 s34, s34, s5
  s_add_u32 s34, s34, 67108864
  s_lshl_b32 s35, s4, 13
  s_and_b32 s5, s28, 1
  s_lshl_b32 s5, s5, 12
  s_add_u32 s35, s35, s5
  s_lshr_b32 s5, s28, 1
  s_lshl_b32 s5, s5, 11
  s_add_u32 s35, s35, s5
  s_add_u32 s35, s35, 83886080
  s_lshl_b32 s4, s26, 5
  s_add_u32 s4, s4, s27
  s_lshl_b32 s4, s4, 7
  s_add_u32 s58, s4, 166731776
  s_add_u32 s59, s4, 166723584
  s_add_u32 s57, s4, 166739968
  s_mul_i32 s45, s28, 10240
  s_mov_b32 s44, 0
  s_mov_b32 s32, 0
  s_mov_b32 s60, 0
  s_add_u32 m0, s45, 0
  s_add_u32 s5, s44, 0
  buffer_load_dwordx4 v3, s[12:15], s5 offen lds
  s_add_u32 m0, s45, 1024
  s_add_u32 s5, s44, 128
  buffer_load_dwordx4 v3, s[12:15], s5 offen lds
  s_add_u32 m0, s45, 2048
  s_add_u32 s5, s44, 256
  buffer_load_dwordx4 v3, s[12:15], s5 offen lds
  s_add_u32 m0, s45, 3072
  s_add_u32 s5, s44, 384
  buffer_load_dwordx4 v3, s[12:15], s5 offen lds
  s_add_u32 m0, s45, 4096
  s_add_u32 s5, s44, 512
  buffer_load_dwordx4 v3, s[12:15], s5 offen lds
  s_add_u32 m0, s45, 5120
  s_add_u32 s5, s44, 640
  buffer_load_dwordx4 v3, s[12:15], s5 offen lds
  s_add_u32 m0, s45, 6144
  s_add_u32 s5, s44, 768
  buffer_load_dwordx4 v3, s[12:15], s5 offen lds
  s_add_u32 m0, s45, 7168
  s_add_u32 s5, s44, 896
  buffer_load_dwordx4 v3, s[12:15], s5 offen lds
  s_add_u32 m0, s45, 8192
  s_add_u32 s5, s44, 1024
  buffer_load_dwordx4 v3, s[12:15], s5 offen lds
  s_add_u32 m0, s45, 9216
  s_add_u32 s5, s44, 1152
  buffer_load_dwordx4 v3, s[12:15], s5 offen lds
  s_add_u32 s44, s44, 40960
  s_add_u32 s45, s45, 40960
  s_add_u32 m0, s45, 0
  s_add_u32 s5, s44, 0
  buffer_load_dwordx4 v3, s[12:15], s5 offen lds
  s_add_u32 m0, s45, 1024
  s_add_u32 s5, s44, 128
  buffer_load_dwordx4 v3, s[12:15], s5 offen lds
  s_add_u32 m0, s45, 2048
  s_add_u32 s5, s44, 256
  buffer_load_dwordx4 v3, s[12:15], s5 offen lds
  s_add_u32 m0, s45, 3072
  s_add_u32 s5, s44, 384
  buffer_load_dwordx4 v3, s[12:15], s5 offen lds
  s_add_u32 m0, s45, 4096
  s_add_u32 s5, s44, 512
  buffer_load_dwordx4 v3, s[12:15], s5 offen lds
  s_add_u32 m0, s45, 5120
  s_add_u32 s5, s44, 640
  buffer_load_dwordx4 v3, s[12:15], s5 offen lds
  s_add_u32 m0, s45, 6144
  s_add_u32 s5, s44, 768
  buffer_load_dwordx4 v3, s[12:15], s5 offen lds
  s_add_u32 m0, s45, 7168
  s_add_u32 s5, s44, 896
  buffer_load_dwordx4 v3, s[12:15], s5 offen lds
  s_add_u32 m0, s45, 8192
  s_add_u32 s5, s44, 1024
  buffer_load_dwordx4 v3, s[12:15], s5 offen lds
  s_add_u32 m0, s45, 9216
  s_add_u32 s5, s44, 1152
  buffer_load_dwordx4 v3, s[12:15], s5 offen lds
  s_add_u32 s44, s44, 40960
  s_sub_u32 s45, s45, 40960
  s_mov_b32 s55, 1
  s_mov_b32 s7, 0
  v_mov_b32 v17, 0
QA_P0_82:
  buffer_load_dword v16, v17, s[8:11], s59 offen sc1
  s_add_u32 s7, s7, 1
  s_cmp_gt_u32 s7, 0x40000
  s_cbranch_scc1 QA_P0X_83
  s_waitcnt vmcnt(0)
  v_readfirstlane_b32 s6, v16
  s_nop 0
  s_cmp_ge_u32 s6, s55
  s_cbranch_scc1 QA_P0X_83
  s_sleep 1
  s_branch QA_P0_82
QA_P0X_83:
  s_waitcnt vmcnt(0)
  s_lshl_b32 s36, s28, 12
  s_add_u32 s36, s36, 98304
  s_add_u32 m0, s36, 0
  s_add_u32 s5, s33, 0
  buffer_load_dwordx4 v1, s[8:11], s5 offen sc1 lds
  s_add_u32 m0, s36, 1024
  s_add_u32 s5, s33, 1024
  buffer_load_dwordx4 v1, s[8:11], s5 offen sc1 lds
  s_add_u32 m0, s36, 2048
  s_add_u32 s5, s33, 2048
  buffer_load_dwordx4 v1, s[8:11], s5 offen sc1 lds
  s_add_u32 m0, s36, 3072
  s_add_u32 s5, s33, 3072
  buffer_load_dwordx4 v1, s[8:11], s5 offen sc1 lds
  s_waitcnt vmcnt(0)
  s_barrier
  ds_read_b128 v[144:147], v4 offset:0
  ds_read_b128 v[148:151], v5 offset:0
  ds_read_b128 v[152:155], v6 offset:0
  ds_read_b128 v[156:159], v7 offset:0
  s_waitcnt lgkmcnt(3)
  v_mfma_f32_32x32x16_bf16 v[128:143], a[0:3], v[144:147], 0
  ds_read_b128 v[144:147], v4 offset:1024
  s_waitcnt lgkmcnt(3)
  v_mfma_f32_32x32x16_bf16 v[128:143], a[4:7], v[148:151], v[128:143]
  ds_read_b128 v[148:151], v5 offset:1024
  s_waitcnt lgkmcnt(3)
  v_mfma_f32_32x32x16_bf16 v[128:143], a[8:11], v[152:155], v[128:143]
  ds_read_b128 v[152:155], v6 offset:1024
  s_waitcnt lgkmcnt(3)
  v_mfma_f32_32x32x16_bf16 v[128:143], a[12:15], v[156:159], v[128:143]
  ds_read_b128 v[156:159], v7 offset:1024
  s_waitcnt lgkmcnt(3)
  v_mfma_f32_32x32x16_bf16 v[128:143], a[16:19], v[144:147], v[128:143]
  ds_read_b128 v[144:147], v4 offset:2048
  s_waitcnt lgkmcnt(3)
  v_mfma_f32_32x32x16_bf16 v[128:143], a[20:23], v[148:151], v[128:143]
  ds_read_b128 v[148:151], v5 offset:2048
  s_waitcnt lgkmcnt(3)
  v_mfma_f32_32x32x16_bf16 v[128:143], a[24:27], v[152:155], v[128:143]
  ds_read_b128 v[152:155], v6 offset:2048
  s_waitcnt lgkmcnt(3)
  v_mfma_f32_32x32x16_bf16 v[128:143], a[28:31], v[156:159], v[128:143]
  ds_read_b128 v[156:159], v7 offset:2048
  s_waitcnt lgkmcnt(3)
  v_mfma_f32_32x32x16_bf16 v[128:143], a[32:35], v[144:147], v[128:143]
  ds_read_b128 v[144:147], v4 offset:3072
  s_waitcnt lgkmcnt(3)
  v_mfma_f32_32x32x16_bf16 v[128:143], a[36:39], v[148:151], v[128:143]
  ds_read_b128 v[148:151], v5 offset:3072
  s_waitcnt lgkmcnt(3)
  v_mfma_f32_32x32x16_bf16 v[128:143], a[40:43], v[152:155], v[128:143]
  ds_read_b128 v[152:155], v6 offset:3072
  s_waitcnt lgkmcnt(3)
  v_mfma_f32_32x32x16_bf16 v[128:143], a[44:47], v[156:159], v[128:143]
  ds_read_b128 v[156:159], v7 offset:3072
  s_waitcnt lgkmcnt(3)
  v_mfma_f32_32x32x16_bf16 v[128:143], a[48:51], v[144:147], v[128:143]
  ds_read_b128 v[144:147], v4 offset:4096
  s_waitcnt lgkmcnt(3)
  v_mfma_f32_32x32x16_bf16 v[128:143], a[52:55], v[148:151], v[128:143]
  ds_read_b128 v[148:151], v5 offset:4096
  s_waitcnt lgkmcnt(3)
  v_mfma_f32_32x32x16_bf16 v[128:143], a[56:59], v[152:155], v[128:143]
  ds_read_b128 v[152:155], v6 offset:4096
  s_waitcnt lgkmcnt(3)
  v_mfma_f32_32x32x16_bf16 v[128:143], a[60:63], v[156:159], v[128:143]
  ds_read_b128 v[156:159], v7 offset:4096
  s_waitcnt lgkmcnt(3)
  v_mfma_f32_32x32x16_bf16 v[128:143], a[64:67], v[144:147], v[128:143]
  ds_read_b128 v[144:147], v4 offset:5120
  s_waitcnt lgkmcnt(3)
  v_mfma_f32_32x32x16_bf16 v[128:143], a[68:71], v[148:151], v[128:143]
  ds_read_b128 v[148:151], v5 offset:5120
  s_waitcnt lgkmcnt(3)
  v_mfma_f32_32x32x16_bf16 v[128:143], a[72:75], v[152:155], v[128:143]
  ds_read_b128 v[152:155], v6 offset:5120
  s_waitcnt lgkmcnt(3)
  v_mfma_f32_32x32x16_bf16 v[128:143], a[76:79], v[156:159], v[128:143]
  ds_read_b128 v[156:159], v7 offset:5120
  s_waitcnt lgkmcnt(3)
  v_mfma_f32_32x32x16_bf16 v[128:143], a[80:83], v[144:147], v[128:143]
  ds_read_b128 v[144:147], v4 offset:6144
  s_waitcnt lgkmcnt(3)
  v_mfma_f32_32x32x16_bf16 v[128:143], a[84:87], v[148:151], v[128:143]
  ds_read_b128 v[148:151], v5 offset:6144
  s_waitcnt lgkmcnt(3)
  v_mfma_f32_32x32x16_bf16 v[128:143], a[88:91], v[152:155], v[128:143]
  ds_read_b128 v[152:155], v6 offset:6144
  s_waitcnt lgkmcnt(3)
  v_mfma_f32_32x32x16_bf16 v[128:143], a[92:95], v[156:159], v[128:143]
  ds_read_b128 v[156:159], v7 offset:6144
  s_waitcnt lgkmcnt(3)
  v_mfma_f32_32x32x16_bf16 v[128:143], a[96:99], v[144:147], v[128:143]
  ds_read_b128 v[144:147], v4 offset:7168
  s_waitcnt lgkmcnt(3)
  v_mfma_f32_32x32x16_bf16 v[128:143], a[100:103], v[148:151], v[128:143]
  ds_read_b128 v[148:151], v5 offset:7168
  s_waitcnt lgkmcnt(3)
  v_mfma_f32_32x32x16_bf16 v[128:143], a[104:107], v[152:155], v[128:143]
  ds_read_b128 v[152:155], v6 offset:7168
  s_waitcnt lgkmcnt(3)
  v_mfma_f32_32x32x16_bf16 v[128:143], a[108:111], v[156:159], v[128:143]
  ds_read_b128 v[156:159], v7 offset:7168
  s_waitcnt lgkmcnt(3)
  v_mfma_f32_32x32x16_bf16 v[128:143], a[112:115], v[144:147], v[128:143]
  ds_read_b128 v[144:147], v4 offset:8192
  s_waitcnt lgkmcnt(3)
  v_mfma_f32_32x32x16_bf16 v[128:143], a[116:119], v[148:151], v[128:143]
  ds_read_b128 v[148:151], v5 offset:8192
  s_waitcnt lgkmcnt(3)
  v_mfma_f32_32x32x16_bf16 v[128:143], a[120:123], v[152:155], v[128:143]
  ds_read_b128 v[152:155], v6 offset:8192
  s_waitcnt lgkmcnt(3)
  v_mfma_f32_32x32x16_bf16 v[128:143], a[124:127], v[156:159], v[128:143]
  ds_read_b128 v[156:159], v7 offset:8192
  s_waitcnt lgkmcnt(3)
  v_mfma_f32_32x32x16_bf16 v[128:143], a[128:131], v[144:147], v[128:143]
  ds_read_b128 v[144:147], v4 offset:9216
  s_waitcnt lgkmcnt(3)
  v_mfma_f32_32x32x16_bf16 v[128:143], a[132:135], v[148:151], v[128:143]
  ds_read_b128 v[148:151], v5 offset:9216
  s_waitcnt lgkmcnt(3)
  v_mfma_f32_32x32x16_bf16 v[128:143], a[136:139], v[152:155], v[128:143]
  ds_read_b128 v[152:155], v6 offset:9216
  s_waitcnt lgkmcnt(3)
  v_mfma_f32_32x32x16_bf16 v[128:143], a[140:143], v[156:159], v[128:143]
  ds_read_b128 v[156:159], v7 offset:9216
  s_waitcnt lgkmcnt(3)
  v_mfma_f32_32x32x16_bf16 v[128:143], a[144:147], v[144:147], v[128:143]
  s_waitcnt lgkmcnt(2)
  v_mfma_f32_32x32x16_bf16 v[128:143], a[148:151], v[148:151], v[128:143]
  s_waitcnt lgkmcnt(1)
  v_mfma_f32_32x32x16_bf16 v[128:143], a[152:155], v[152:155], v[128:143]
  s_waitcnt lgkmcnt(0)
  v_mfma_f32_32x32x16_bf16 v[128:143], a[156:159], v[156:159], v[128:143]
  s_nop 7
  s_nop 3
  v_cvt_pk_bf16_f32 v160, v128, v129
  v_cvt_pk_bf16_f32 v161, v130, v131
  v_cvt_pk_bf16_f32 v162, v132, v133
  v_cvt_pk_bf16_f32 v163, v134, v135
  v_cvt_pk_bf16_f32 v164, v136, v137
  v_cvt_pk_bf16_f32 v165, v138, v139
  v_cvt_pk_bf16_f32 v166, v140, v141
  v_cvt_pk_bf16_f32 v167, v142, v143
  ds_write_b128 v8, v[160:163]
  ds_write_b128 v8, v[164:167] offset:256
  v_add_u32 v4, 40960, v4
  v_add_u32 v5, 40960, v5
  v_add_u32 v6, 40960, v6
  v_add_u32 v7, 40960, v7
  v_add_u32 v8, 8192, v8
  s_mov_b32 s37, 0
  s_waitcnt lgkmcnt(0)
  s_barrier
QA_LOOP_84:
  s_add_u32 s55, s32, 1
  s_mov_b32 s7, 0
  v_mov_b32 v17, 0
QA_P1_86:
  buffer_load_dword v16, v17, s[8:11], s58 offen sc1
  s_add_u32 s7, s7, 1
  s_cmp_gt_u32 s7, 0x40000
  s_cbranch_scc1 QA_P1X_87
  s_waitcnt vmcnt(0)
  v_readfirstlane_b32 s6, v16
  s_nop 0
  s_cmp_ge_u32 s6, s55
  s_cbranch_scc1 QA_P1X_87
  s_sleep 1
  s_branch QA_P1_86
QA_P1X_87:
  s_waitcnt vmcnt(0)
  s_lshl_b32 s4, s37, 12
  s_lshl_b32 s5, s28, 10
  s_add_u32 s4, s4, s5
  s_add_u32 m0, s4, 131072
  s_nop 0
  buffer_load_dwordx4 v1, s[8:11], s34 offen sc1 lds
  s_cmp_ge_u32 s32, 63
  s_cbranch_scc1 QA_NK_88
  s_add_u32 s55, s32, 2
  s_cmp_ge_u32 s60, s55
  s_cbranch_scc1 QA_SEEN_89
  s_mov_b32 s7, 0
  v_mov_b32 v17, 0
QA_P2_90:
  buffer_load_dword v16, v17, s[8:11], s59 offen sc1
  s_add_u32 s7, s7, 1
  s_cmp_gt_u32 s7, 0x40000
  s_cbranch_scc1 QA_P2X_91
  s_waitcnt vmcnt(0)
  v_readfirstlane_b32 s6, v16
  s_nop 0
  s_cmp_ge_u32 s6, s55
  s_cbranch_scc1 QA_P2X_91
  s_sleep 1
  s_branch QA_P2_90
QA_P2X_91:
  s_waitcnt vmcnt(0)
  s_mov_b32 s60, s6
QA_SEEN_89:
  s_add_u32 s38, s33, 524288
  s_xor_b32 s4, s37, 1
  s_lshl_b32 s4, s4, 14
  s_lshl_b32 s5, s28, 12
  s_add_u32 s4, s4, s5
  s_add_u32 s39, s4, 98304
  s_add_u32 m0, s39, 0
  s_add_u32 s5, s38, 0
  buffer_load_dwordx4 v1, s[8:11], s5 offen sc1 lds
  s_add_u32 m0, s39, 1024
  s_add_u32 s5, s38, 1024
  buffer_load_dwordx4 v1, s[8:11], s5 offen sc1 lds
  s_add_u32 m0, s39, 2048
  s_add_u32 s5, s38, 2048
  buffer_load_dwordx4 v1, s[8:11], s5 offen sc1 lds
  s_add_u32 m0, s39, 3072
  s_add_u32 s5, s38, 3072
  buffer_load_dwordx4 v1, s[8:11], s5 offen sc1 lds
QA_NK_88:
  s_mul_i32 s4, s37, 40960
  s_mul_i32 s5, s28, 10240
  s_add_u32 s45, s4, s5
  s_cmp_ge_u32 s32, 63
  s_cbranch_scc1 QA_NQ_92
  ds_read_b128 v[144:147], v4 offset:0
  ds_read_b128 v[148:151], v5 offset:0
  ds_read_b128 v[152:155], v6 offset:0
  ds_read_b128 v[156:159], v7 offset:0
  s_waitcnt lgkmcnt(3)
  v_mfma_f32_32x32x16_bf16 v[128:143], a[0:3], v[144:147], 0
  ds_read_b128 v[144:147], v4 offset:1024
  s_waitcnt lgkmcnt(3)
  v_mfma_f32_32x32x16_bf16 v[128:143], a[4:7], v[148:151], v[128:143]
  s_add_u32 m0, s45, 0
  s_add_u32 s5, s44, 0
  buffer_load_dwordx4 v3, s[12:15], s5 offen lds
  ds_read_b128 v[148:151], v5 offset:1024
  s_waitcnt lgkmcnt(3)
  v_mfma_f32_32x32x16_bf16 v[128:143], a[8:11], v[152:155], v[128:143]
  ds_read_b128 v[152:155], v6 offset:1024
  s_waitcnt lgkmcnt(3)
  v_mfma_f32_32x32x16_bf16 v[128:143], a[12:15], v[156:159], v[128:143]
  s_add_u32 m0, s45, 1024
  s_add_u32 s5, s44, 128
  buffer_load_dwordx4 v3, s[12:15], s5 offen lds
  ds_read_b128 v[156:159], v7 offset:1024
  s_waitcnt lgkmcnt(3)
  v_mfma_f32_32x32x16_bf16 v[128:143], a[16:19], v[144:147], v[128:143]
  ds_read_b128 v[144:147], v4 offset:2048
  s_waitcnt lgkmcnt(3)
  v_mfma_f32_32x32x16_bf16 v[128:143], a[20:23], v[148:151], v[128:143]
  s_add_u32 m0, s45, 2048
  s_add_u32 s5, s44, 256
  buffer_load_dwordx4 v3, s[12:15], s5 offen lds
  ds_read_b128 v[148:151], v5 offset:2048
  s_waitcnt lgkmcnt(3)
  v_mfma_f32_32x32x16_bf16 v[128:143], a[24:27], v[152:155], v[128:143]
  ds_read_b128 v[152:155], v6 offset:2048
  s_waitcnt lgkmcnt(3)
  v_mfma_f32_32x32x16_bf16 v[128:143], a[28:31], v[156:159], v[128:143]
  s_add_u32 m0, s45, 3072
  s_add_u32 s5, s44, 384
  buffer_load_dwordx4 v3, s[12:15], s5 offen lds
  ds_read_b128 v[156:159], v7 offset:2048
  s_waitcnt lgkmcnt(3)
  v_mfma_f32_32x32x16_bf16 v[128:143], a[32:35], v[144:147], v[128:143]
  ds_read_b128 v[144:147], v4 offset:3072
  s_waitcnt lgkmcnt(3)
  v_mfma_f32_32x32x16_bf16 v[128:143], a[36:39], v[148:151], v[128:143]
  s_add_u32 m0, s45, 4096
  s_add_u32 s5, s44, 512
  buffer_load_dwordx4 v3, s[12:15], s5 offen lds
  ds_read_b128 v[148:151], v5 offset:3072
  s_waitcnt lgkmcnt(3)
  v_mfma_f32_32x32x16_bf16 v[128:143], a[40:43], v[152:155], v[128:143]
  ds_read_b128 v[152:155], v6 offset:3072
  s_waitcnt lgkmcnt(3)
  v_mfma_f32_32x32x16_bf16 v[128:143], a[44:47], v[156:159], v[128:143]
  s_add_u32 m0, s45, 5120
  s_add_u32 s5, s44, 640
  buffer_load_dwordx4 v3, s[12:15], s5 offen lds
  ds_read_b128 v[156:159], v7 offset:3072
  s_waitcnt lgkmcnt(3)
  v_mfma_f32_32x32x16_bf16 v[128:143], a[48:51], v[144:147], v[128:143]
  ds_read_b128 v[144:147], v4 offset:4096
  s_waitcnt lgkmcnt(3)
  v_mfma_f32_32x32x16_bf16 v[128:143], a[52:55], v[148:151], v[128:143]
  s_add_u32 m0, s45, 6144
  s_add_u32 s5, s44, 768
  buffer_load_dwordx4 v3, s[12:15], s5 offen lds
  ds_read_b128 v[148:151], v5 offset:4096
  s_waitcnt lgkmcnt(3)
  v_mfma_f32_32x32x16_bf16 v[128:143], a[56:59], v[152:155], v[128:143]
  ds_read_b128 v[152:155], v6 offset:4096
  s_waitcnt lgkmcnt(3)
  v_mfma_f32_32x32x16_bf16 v[128:143], a[60:63], v[156:159], v[128:143]
  s_add_u32 m0, s45, 7168
  s_add_u32 s5, s44, 896
  buffer_load_dwordx4 v3, s[12:15], s5 offen lds
  ds_read_b128 v[156:159], v7 offset:4096
  s_waitcnt lgkmcnt(3)
  v_mfma_f32_32x32x16_bf16 v[128:143], a[64:67], v[144:147], v[128:143]
  ds_read_b128 v[144:147], v4 offset:5120
  s_waitcnt lgkmcnt(3)
  v_mfma_f32_32x32x16_bf16 v[128:143], a[68:71], v[148:151], v[128:143]
  s_add_u32 m0, s45, 8192
  s_add_u32 s5, s44, 1024
  buffer_load_dwordx4 v3, s[12:15], s5 offen lds
  ds_read_b128 v[148:151], v5 offset:5120
  s_waitcnt lgkmcnt(3)
  v_mfma_f32_32x32x16_bf16 v[128:143], a[72:75], v[152:155], v[128:143]
  ds_read_b128 v[152:155], v6 offset:5120
  s_waitcnt lgkmcnt(3)
  v_mfma_f32_32x32x16_bf16 v[128:143], a[76:79], v[156:159], v[128:143]
  s_add_u32 m0, s45, 9216
  s_add_u32 s5, s44, 1152
  buffer_load_dwordx4 v3, s[12:15], s5 offen lds
  ds_read_b128 v[156:159], v7 offset:5120
  s_waitcnt lgkmcnt(3)
  v_mfma_f32_32x32x16_bf16 v[128:143], a[80:83], v[144:147], v[128:143]
  ds_read_b128 v[144:147], v4 offset:6144
  s_waitcnt lgkmcnt(3)
  v_mfma_f32_32x32x16_bf16 v[128:143], a[84:87], v[148:151], v[128:143]
  ds_read_b128 v[148:151], v5 offset:6144
  s_waitcnt lgkmcnt(3)
  v_mfma_f32_32x32x16_bf16 v[128:143], a[88:91], v[152:155], v[128:143]
  ds_read_b128 v[152:155], v6 offset:6144
  s_waitcnt lgkmcnt(3)
  v_mfma_f32_32x32x16_bf16 v[128:143], a[92:95], v[156:159], v[128:143]
  ds_read_b128 v[156:159], v7 offset:6144
  s_waitcnt lgkmcnt(3)
  v_mfma_f32_32x32x16_bf16 v[128:143], a[96:99], v[144:147], v[128:143]
  ds_read_b128 v[144:147], v4 offset:7168
  s_waitcnt lgkmcnt(3)
  v_mfma_f32_32x32x16_bf16 v[128:143], a[100:103], v[148:151], v[128:143]
  ds_read_b128 v[148:151], v5 offset:7168
  s_waitcnt lgkmcnt(3)
  v_mfma_f32_32x32x16_bf16 v[128:143], a[104:107], v[152:155], v[128:143]
  ds_read_b128 v[152:155], v6 offset:7168
  s_waitcnt lgkmcnt(3)
  v_mfma_f32_32x32x16_bf16 v[128:143], a[108:111], v[156:159], v[128:143]
  ds_read_b128 v[156:159], v7 offset:7168
  s_waitcnt lgkmcnt(3)
  v_mfma_f32_32x32x16_bf16 v[128:143], a[112:115], v[144:147], v[128:143]
  ds_read_b128 v[144:147], v4 offset:8192
  s_waitcnt lgkmcnt(3)
  v_mfma_f32_32x32x16_bf16 v[128:143], a[116:119], v[148:151], v[128:143]
  ds_read_b128 v[148:151], v5 offset:8192
  s_waitcnt lgkmcnt(3)
  v_mfma_f32_32x32x16_bf16 v[128:143], a[120:123], v[152:155], v[128:143]
  ds_read_b128 v[152:155], v6 offset:8192
  s_waitcnt lgkmcnt(3)
  v_mfma_f32_32x32x16_bf16 v[128:143], a[124:127], v[156:159], v[128:143]
  ds_read_b128 v[156:159], v7 offset:8192
  s_waitcnt lgkmcnt(3)
  v_mfma_f32_32x32x16_bf16 v[128:143], a[128:131], v[144:147], v[128:143]
  ds_read_b128 v[144:147], v4 offset:9216
  s_waitcnt lgkmcnt(3)
  v_mfma_f32_32x32x16_bf16 v[128:143], a[132:135], v[148:151], v[128:143]
  ds_read_b128 v[148:151], v5 offset:9216
  s_waitcnt lgkmcnt(3)
  v_mfma_f32_32x32x16_bf16 v[128:143], a[136:139], v[152:155], v[128:143]
  ds_read_b128 v[152:155], v6 offset:9216
  s_waitcnt lgkmcnt(3)
  v_mfma_f32_32x32x16_bf16 v[128:143], a[140:143], v[156:159], v[128:143]
  ds_read_b128 v[156:159], v7 offset:9216
  s_waitcnt lgkmcnt(3)
  v_mfma_f32_32x32x16_bf16 v[128:143], a[144:147], v[144:147], v[128:143]
  s_waitcnt lgkmcnt(2)
  v_mfma_f32_32x32x16_bf16 v[128:143], a[148:151], v[148:151], v[128:143]
  s_waitcnt lgkmcnt(1)
  v_mfma_f32_32x32x16_bf16 v[128:143], a[152:155], v[152:155], v[128:143]
  s_waitcnt lgkmcnt(0)
  v_mfma_f32_32x32x16_bf16 v[128:143], a[156:159], v[156:159], v[128:143]
  s_nop 7
  s_nop 3
  v_cvt_pk_bf16_f32 v160, v128, v129
  v_cvt_pk_bf16_f32 v161, v130, v131
  v_cvt_pk_bf16_f32 v162, v132, v133
  v_cvt_pk_bf16_f32 v163, v134, v135
  v_cvt_pk_bf16_f32 v164, v136, v137
  v_cvt_pk_bf16_f32 v165, v138, v139
  v_cvt_pk_bf16_f32 v166, v140, v141
  v_cvt_pk_bf16_f32 v167, v142, v143
  ds_write_b128 v8, v[160:163]
  ds_write_b128 v8, v[164:167] offset:256
  s_branch QA_QD_93
QA_NQ_92:
  s_add_u32 m0, s45, 0
  s_add_u32 s5, s44, 0
  buffer_load_dwordx4 v3, s[12:15], s5 offen lds
  s_add_u32 m0, s45, 1024
  s_add_u32 s5, s44, 128
  buffer_load_dwordx4 v3, s[12:15], s5 offen lds
  s_add_u32 m0, s45, 2048
  s_add_u32 s5, s44, 256
  buffer_load_dwordx4 v3, s[12:15], s5 offen lds
  s_add_u32 m0, s45, 3072
  s_add_u32 s5, s44, 384
  buffer_load_dwordx4 v3, s[12:15], s5 offen lds
  s_add_u32 m0, s45, 4096
  s_add_u32 s5, s44, 512
  buffer_load_dwordx4 v3, s[12:15], s5 offen lds
  s_add_u32 m0, s45, 5120
  s_add_u32 s5, s44, 640
  buffer_load_dwordx4 v3, s[12:15], s5 offen lds
  s_add_u32 m0, s45, 6144
  s_add_u32 s5, s44, 768
  buffer_load_dwordx4 v3, s[12:15], s5 offen lds
  s_add_u32 m0, s45, 7168
  s_add_u32 s5, s44, 896
  buffer_load_dwordx4 v3, s[12:15], s5 offen lds
  s_add_u32 m0, s45, 8192
  s_add_u32 s5, s44, 1024
  buffer_load_dwordx4 v3, s[12:15], s5 offen lds
  s_add_u32 m0, s45, 9216
  s_add_u32 s5, s44, 1152
  buffer_load_dwordx4 v3, s[12:15], s5 offen lds
QA_QD_93:
  s_cmp_eq_u32 s37, 0
  s_cselect_b32 s5, -1, 1
  s_mul_i32 s4, s5, 40960
  v_add_u32 v4, s4, v4
  v_add_u32 v5, s4, v5
  v_add_u32 v6, s4, v6
  v_add_u32 v7, s4, v7
  s_lshl_b32 s4, s5, 13
  v_add_u32 v8, s4, v8
  s_cmp_ge_u32 s32, 63
  s_cbranch_scc1 QA_W1_94
  s_waitcnt vmcnt(14) lgkmcnt(0)
  s_branch QA_W2_95
QA_W1_94:
  s_waitcnt vmcnt(10) lgkmcnt(0)
QA_W2_95:
  s_barrier
  s_cmp_lg_u32 s28, 0
  s_cbranch_scc1 QA_NF0_96
  s_cmp_gt_u32 s32, 62
  s_cbranch_scc1 QA_NF0_96
  v_mov_b32 v16, s32
  v_mov_b32 v17, 0
  s_mov_b64 exec, 1
  buffer_store_dword v16, v17, s[8:11], s57 offen sc1
  s_mov_b64 exec, -1
QA_NF0_96:
  s_and_b32 s4, s28, 1
  s_lshl_b32 s4, s4, 10
  s_lshl_b32 s5, s37, 13
  s_add_u32 s4, s4, s5
  s_add_u32 s4, s4, 81920
  v_add_u32 v20, s4, v1
  s_lshl_b32 s5, s37, 14
  s_add_u32 s5, s5, 98304
  v_add_u32 v21, s5, v1
  s_lshl_b32 s5, s37, 12
  s_add_u32 s5, s5, 131072
  v_add_u32 v22, s5, v11
  v_add_u32 v23, s5, v1
  ds_read_b128 v[24:27], v20 offset:0
  ds_read_b128 v[40:43], v21 offset:0
  ds_read_b128 v[56:59], v21 offset:1024
  ds_read_b64_tr_b16 v[72:73], v22 offset:0
  ds_read_b64_tr_b16 v[74:75], v22 offset:64
  ds_read_b128 v[28:31], v20 offset:2048
  ds_read_b128 v[44:47], v21 offset:2048
  ds_read_b128 v[60:63], v21 offset:3072
  ds_read_b64_tr_b16 v[76:77], v22 offset:1024
  ds_read_b64_tr_b16 v[78:79], v22 offset:1088
  ds_read_b128 v[32:35], v20 offset:4096
  ds_read_b128 v[48:51], v21 offset:4096
  ds_read_b128 v[64:67], v21 offset:5120
  ds_read_b64_tr_b16 v[80:81], v22 offset:2048
  ds_read_b64_tr_b16 v[82:83], v22 offset:2112
  ds_read_b128 v[36:39], v20 offset:6144
  ds_read_b128 v[52:55], v21 offset:6144
  ds_read_b128 v[68:71], v21 offset:7168
  ds_read_b64_tr_b16 v[84:85], v22 offset:3072
  ds_read_b64_tr_b16 v[86:87], v22 offset:3136
  s_waitcnt lgkmcnt(15)
  v_mfma_f32_16x16x32_bf16 v[88:91], v[40:43], v[24:27], 0
  s_waitcnt lgkmcnt(15)
  v_mfma_f32_16x16x32_bf16 v[92:95], v[56:59], v[24:27], 0
  s_waitcnt lgkmcnt(15)
  v_mfma_f32_16x16x32_bf16 v[96:99], v[72:75], v[24:27], 0
  s_waitcnt lgkmcnt(13)
  v_mfma_f32_16x16x32_bf16 v[88:91], v[44:47], v[28:31], v[88:91]
  s_waitcnt lgkmcnt(12)
  v_mfma_f32_16x16x32_bf16 v[92:95], v[60:63], v[28:31], v[92:95]
  s_waitcnt lgkmcnt(10)
  v_mfma_f32_16x16x32_bf16 v[96:99], v[76:79], v[28:31], v[96:99]
  s_waitcnt lgkmcnt(8)
  v_mfma_f32_16x16x32_bf16 v[88:91], v[48:51], v[32:35], v[88:91]
  s_waitcnt lgkmcnt(7)
  v_mfma_f32_16x16x32_bf16 v[92:95], v[64:67], v[32:35], v[92:95]
  s_waitcnt lgkmcnt(5)
  v_mfma_f32_16x16x32_bf16 v[96:99], v[80:83], v[32:35], v[96:99]
  s_waitcnt lgkmcnt(3)
  v_mfma_f32_16x16x32_bf16 v[88:91], v[52:55], v[36:39], v[88:91]
  s_waitcnt lgkmcnt(2)
  v_mfma_f32_16x16x32_bf16 v[92:95], v[68:71], v[36:39], v[92:95]
  s_waitcnt lgkmcnt(0)
  v_mfma_f32_16x16x32_bf16 v[96:99], v[84:87], v[36:39], v[96:99]
  s_lshr_b32 s4, s28, 1
  s_lshl_b32 s5, s4, 12
  v_add_u32 v24, s5, v21
  ds_read_b128 v[26:29], v24 offset:8192
  ds_read_b128 v[30:33], v24 offset:9216
  ds_read_b128 v[34:37], v24 offset:10240
  ds_read_b128 v[38:41], v24 offset:11264
  s_lshl_b32 s5, s4, 11
  v_add_u32 v24, s5, v23
  ds_read_b128 v[42:45], v24 offset:0
  ds_read_b128 v[46:49], v24 offset:1024
  v_mov_b32 v24, 0xff800000
  v_cndmask_b32 v88, v24, v88, s[64:65]
  v_cndmask_b32 v89, v24, v89, s[66:67]
  v_cndmask_b32 v90, v24, v90, s[68:69]
  v_cndmask_b32 v91, v24, v91, s[70:71]
  v_cndmask_b32 v92, v24, v92, s[72:73]
  v_cndmask_b32 v93, v24, v93, s[74:75]
  v_cndmask_b32 v94, v24, v94, s[76:77]
  v_cndmask_b32 v95, v24, v95, s[78:79]
  v_max3_f32 v25, v88, v89, v90
  v_max3_f32 v25, v25, v91, v92
  v_max3_f32 v25, v25, v93, v94
  v_max3_f32 v25, v25, v95, v96
  v_max_f32 v25, v25, v97
  v_mov_b32 v50, v25
  s_nop 1
  v_permlane16_swap_b32 v25, v50
  v_max_f32 v25, v25, v50
  v_mov_b32 v50, v25
  s_nop 1
  v_permlane32_swap_b32 v25, v50
  v_max_f32 v25, v25, v50
  v_mul_f32 v25, s50, v25
  v_fma_f32 v88, v88, s50, -v25
  v_fma_f32 v89, v89, s50, -v25
  v_fma_f32 v90, v90, s50, -v25
  v_fma_f32 v91, v91, s50, -v25
  v_fma_f32 v92, v92, s50, -v25
  v_fma_f32 v93, v93, s50, -v25
  v_fma_f32 v94, v94, s50, -v25
  v_fma_f32 v95, v95, s50, -v25
  v_fma_f32 v96, v96, s50, -v25
  v_fma_f32 v97, v97, s50, -v25
  v_exp_f32 v88, v88
  v_exp_f32 v89, v89
  v_exp_f32 v90, v90
  v_exp_f32 v91, v91
  v_exp_f32 v92, v92
  v_exp_f32 v93, v93
  v_exp_f32 v94, v94
  v_exp_f32 v95, v95
  v_exp_f32 v96, v96
  v_exp_f32 v97, v97
  v_cvt_pk_bf16_f32 v52, v88, v89
  v_cvt_pk_bf16_f32 v53, v90, v91
  v_cvt_pk_bf16_f32 v54, v92, v93
  v_cvt_pk_bf16_f32 v55, v94, v95
  v_mov_b32 v56, 0
  v_cvt_pk_bf16_f32 v57, v96, v97
  s_waitcnt lgkmcnt(5)
  v_mfma_f32_16x16x32_bf16 v[58:61], v[26:29], v[52:55], 0
  s_waitcnt lgkmcnt(4)
  v_mfma_f32_16x16x32_bf16 v[62:65], v[30:33], v[52:55], 0
  s_waitcnt lgkmcnt(3)
  v_mfma_f32_16x16x32_bf16 v[66:69], v[34:37], v[52:55], 0
  s_waitcnt lgkmcnt(2)
  v_mfma_f32_16x16x32_bf16 v[70:73], v[38:41], v[52:55], 0
  s_waitcnt lgkmcnt(1)
  v_mfma_f32_16x16x16_bf16 v[58:61], v[42:43], v[56:57], v[58:61]
  v_mfma_f32_16x16x16_bf16 v[62:65], v[44:45], v[56:57], v[62:65]
  s_waitcnt lgkmcnt(0)
  v_mfma_f32_16x16x16_bf16 v[66:69], v[46:47], v[56:57], v[66:69]
  v_mfma_f32_16x16x16_bf16 v[70:73], v[48:49], v[56:57], v[70:73]
  v_add_f32 v88, v88, v89
  v_add_f32 v90, v90, v91
  v_add_f32 v92, v92, v93
  v_add_f32 v94, v94, v95
  v_add_f32 v96, v96, v97
  v_add_f32 v88, v88, v90
  v_add_f32 v92, v92, v94
  v_add_f32 v88, v88, v92
  v_add_f32 v88, v88, v96
  v_mov_b32 v50, v88
  s_nop 1
  v_permlane16_swap_b32 v88, v50
  v_add_f32 v88, v88, v50
  v_mov_b32 v50, v88
  s_nop 1
  v_permlane32_swap_b32 v88, v50
  v_add_f32 v88, v88, v50
  v_rcp_f32 v88, v88
  s_nop 0
  v_mul_f32 v58, v58, v88
  v_mul_f32 v59, v59, v88
  v_mul_f32 v60, v60, v88
  v_mul_f32 v61, v61, v88
  v_cvt_pk_bf16_f32 v74, v58, v59
  v_cvt_pk_bf16_f32 v75, v60, v61
  v_mul_f32 v62, v62, v88
  v_mul_f32 v63, v63, v88
  v_mul_f32 v64, v64, v88
  v_mul_f32 v65, v65, v88
  v_cvt_pk_bf16_f32 v76, v62, v63
  v_cvt_pk_bf16_f32 v77, v64, v65
  buffer_store_dwordx4 v[74:77], v1, s[8:11], s35 offen offset:0 sc1
  v_mul_f32 v66, v66, v88
  v_mul_f32 v67, v67, v88
  v_mul_f32 v68, v68, v88
  v_mul_f32 v69, v69, v88
  v_cvt_pk_bf16_f32 v78, v66, v67
  v_cvt_pk_bf16_f32 v79, v68, v69
  v_mul_f32 v70, v70, v88
  v_mul_f32 v71, v71, v88
  v_mul_f32 v72, v72, v88
  v_mul_f32 v73, v73, v88
  v_cvt_pk_bf16_f32 v80, v70, v71
  v_cvt_pk_bf16_f32 v81, v72, v73
  buffer_store_dwordx4 v[78:81], v1, s[8:11], s35 offen offset:1024 sc1
  s_cmp_ge_u32 s32, 62
  s_cbranch_scc1 QA_E0_97
  s_waitcnt vmcnt(2) lgkmcnt(0)
  s_barrier
  s_branch QA_NF_99
QA_E0_97:
  s_waitcnt vmcnt(0) lgkmcnt(0)
  s_barrier
  s_cmp_lg_u32 s28, 0
  s_cbranch_scc1 QA_NF_99
  s_add_u32 s5, s32, 1
  v_mov_b32 v16, s5
  v_mov_b32 v17, 0
  s_mov_b64 exec, 1
  buffer_store_dword v16, v17, s[8:11], s57 offen sc1
  s_mov_b64 exec, -1
QA_NF_99:
  s_add_u32 s32, s32, 1
  s_xor_b32 s37, s37, 1
  s_add_u32 s33, s33, 524288
  s_add_u32 s34, s34, 131072
  s_add_u32 s35, s35, 262144
  s_add_u32 s44, s44, 40960
  s_cmp_lt_u32 s32, 64
  s_cbranch_scc1 QA_LOOP_84
  s_waitcnt vmcnt(0)
  s_branch L_END
L_WO:
  s_mul_i32 s4, s26, 20
  s_add_u32 s4, s4, s27
  s_lshl_b32 s4, s4, 7
  s_add_u32 s4, s4, 166748160
  s_cmp_ge_u32 s27, 20
  s_cbranch_scc1 WO_Z_100
  v_mov_b32 v12, 0
  v_mov_b32 v13, 0
  s_mov_b64 exec, 1
  buffer_store_dword v12, v13, s[8:11], s4 offen sc1
  s_mov_b64 exec, -1
WO_Z_100:
  s_waitcnt vmcnt(0)
  s_barrier
  s_cmp_lg_u32 s28, 0
  s_cbranch_scc1 IA_101
  v_mov_b32 v12, 32
  v_mov_b32 v13, 1
  s_mov_b64 exec, 1
  global_atomic_add v12, v13, s[24:25]
  s_mov_b64 exec, -1
  s_waitcnt vmcnt(0)
IA_101:
  s_cmp_ge_u32 s27, 20
  s_cbranch_scc1 L_END
  v_mov_b32 v13, 32
  s_mov_b32 s7, 0
IW_102:
  global_load_dword v12, v13, s[24:25] sc1
  s_add_u32 s7, s7, 1
  s_cmp_gt_u32 s7, 0x400000
  s_cbranch_scc1 IWX_103
  s_waitcnt vmcnt(0)
  v_readfirstlane_b32 s6, v12
  s_nop 0
  s_cmp_ge_u32 s6, 256
  s_cbranch_scc1 IWX_103
  s_sleep 2
  s_branch IW_102
IWX_103:
  s_waitcnt vmcnt(0)
  s_lshl_b32 s4, s26, 5
  s_add_u32 s4, s4, s27
  s_lshl_b32 s4, s4, 7
  s_add_u32 s59, s4, 166723584
  s_add_u32 s4, s26, 6
  s_lshl_b32 s4, s4, 2
  v_mov_b32 v13, s4
  global_load_dword v12, v13, s[24:25] sc1
  s_waitcnt vmcnt(0)
  v_readfirstlane_b32 s6, v12
  s_nop 0
  s_cmp_ge_u32 s6, 32
  s_cselect_b32 s78, 1, 0
  s_mov_b32 s78, 0
  s_mov_b32 s55, 1
  s_mov_b32 s7, 0
  v_mov_b32 v13, 0
WO_PS_104:
  buffer_load_dword v12, v13, s[8:11], s59 offen sc1
  s_add_u32 s7, s7, 1
  s_cmp_gt_u32 s7, 0x40000
  s_cbranch_scc1 WO_PSX_105
  s_waitcnt vmcnt(0)
  v_readfirstlane_b32 s6, v12
  s_nop 0
  s_cmp_ge_u32 s6, s55
  s_cbranch_scc1 WO_PSX_105
  s_sleep 8
  s_branch WO_PS_104
WO_PSX_105:
  s_waitcnt vmcnt(0)
  s_mul_i32 s4, s26, 56
  s_add_u32 s30, s0, s4
  s_addc_u32 s31, s1, 0
  s_load_dwordx2 s[4:5], s[30:31], 40
  s_waitcnt lgkmcnt(0)
  s_mov_b32 s16, s4
  s_and_b32 s17, s5, 0xffff
  s_mov_b32 s18, 0x500000
  s_mov_b32 s19, 0x20000
  s_load_dwordx2 s[4:5], s[0:1], 112
  s_waitcnt lgkmcnt(0)
  s_mov_b32 s12, s4
  s_and_b32 s13, s5, 0xffff
  s_mov_b32 s14, 0x500000
  s_mov_b32 s15, 0x20000
  v_lshlrev_b32 v1, 4, v2
  s_mul_i32 s4, s27, 52429
  s_lshr_b32 s38, s4, 18
  s_mul_i32 s4, s38, 5
  s_sub_u32 s39, s27, s4
  v_lshrrev_b32 v12, 4, v2
  s_and_b32 s4, s28, 1
  s_lshl_b32 s4, s4, 2
  v_add_u32 v13, s4, v12
  v_lshlrev_b32 v13, 1, v13
  v_and_b32 v14, 15, v2
  v_xor_b32 v13, v13, v14
  v_lshlrev_b32 v13, 4, v13
  s_lshl_b32 s4, s28, 2
  v_add_u32 v12, s4, v12
  v_mul_u32_u24 v12, 1280, v12
  v_add_u32 v3, v12, v13
  s_mul_i32 s40, s38, 1310720
  s_lshl_b32 s4, s39, 8
  s_add_u32 s40, s40, s4
  s_lshl_b32 s41, s28, 10
  s_add_u32 m0, s41, 0
  s_add_u32 s5, s40, 0
  buffer_load_dwordx4 v3, s[16:19], s5 offen nt lds
  s_add_u32 m0, s41, 4096
  s_add_u32 s5, s40, 20480
  buffer_load_dwordx4 v3, s[16:19], s5 offen nt lds
  s_add_u32 m0, s41, 8192
  s_add_u32 s5, s40, 40960
  buffer_load_dwordx4 v3, s[16:19], s5 offen nt lds
  s_add_u32 m0, s41, 12288
  s_add_u32 s5, s40, 61440
  buffer_load_dwordx4 v3, s[16:19], s5 offen nt lds
  s_add_u32 m0, s41, 16384
  s_add_u32 s5, s40, 81920
  buffer_load_dwordx4 v3, s[16:19], s5 offen nt lds
  s_add_u32 m0, s41, 20480
  s_add_u32 s5, s40, 102400
  buffer_load_dwordx4 v3, s[16:19], s5 offen nt lds
  s_add_u32 m0, s41, 24576
  s_add_u32 s5, s40, 122880
  buffer_load_dwordx4 v3, s[16:19], s5 offen nt lds
  s_add_u32 m0, s41, 28672
  s_add_u32 s5, s40, 143360
  buffer_load_dwordx4 v3, s[16:19], s5 offen nt lds
  s_add_u32 m0, s41, 32768
  s_add_u32 s5, s40, 163840
  buffer_load_dwordx4 v3, s[16:19], s5 offen nt lds
  s_add_u32 m0, s41, 36864
  s_add_u32 s5, s40, 184320
  buffer_load_dwordx4 v3, s[16:19], s5 offen nt lds
  s_add_u32 m0, s41, 40960
  s_add_u32 s5, s40, 204800
  buffer_load_dwordx4 v3, s[16:19], s5 offen nt lds
  s_add_u32 m0, s41, 45056
  s_add_u32 s5, s40, 225280
  buffer_load_dwordx4 v3, s[16:19], s5 offen nt lds
  s_add_u32 m0, s41, 49152
  s_add_u32 s5, s40, 245760
  buffer_load_dwordx4 v3, s[16:19], s5 offen nt lds
  s_add_u32 m0, s41, 53248
  s_add_u32 s5, s40, 266240
  buffer_load_dwordx4 v3, s[16:19], s5 offen nt lds
  s_add_u32 m0, s41, 57344
  s_add_u32 s5, s40, 286720
  buffer_load_dwordx4 v3, s[16:19], s5 offen nt lds
  s_add_u32 m0, s41, 61440
  s_add_u32 s5, s40, 307200
  buffer_load_dwordx4 v3, s[16:19], s5 offen nt lds
  s_add_u32 m0, s41, 65536
  s_add_u32 s5, s40, 327680
  buffer_load_dwordx4 v3, s[16:19], s5 offen nt lds
  s_add_u32 m0, s41, 69632
  s_add_u32 s5, s40, 348160
  buffer_load_dwordx4 v3, s[16:19], s5 offen nt lds
  s_add_u32 m0, s41, 73728
  s_add_u32 s5, s40, 368640
  buffer_load_dwordx4 v3, s[16:19], s5 offen nt lds
  s_add_u32 m0, s41, 77824
  s_add_u32 s5, s40, 389120
  buffer_load_dwordx4 v3, s[16:19], s5 offen nt lds
  s_add_u32 m0, s41, 81920
  s_add_u32 s5, s40, 409600
  buffer_load_dwordx4 v3, s[16:19], s5 offen nt lds
  s_add_u32 m0, s41, 86016
  s_add_u32 s5, s40, 430080
  buffer_load_dwordx4 v3, s[16:19], s5 offen nt lds
  s_add_u32 m0, s41, 90112
  s_add_u32 s5, s40, 450560
  buffer_load_dwordx4 v3, s[16:19], s5 offen nt lds
  s_add_u32 m0, s41, 94208
  s_add_u32 s5, s40, 471040
  buffer_load_dwordx4 v3, s[16:19], s5 offen nt lds
  s_add_u32 m0, s41, 98304
  s_add_u32 s5, s40, 491520
  buffer_load_dwordx4 v3, s[16:19], s5 offen nt lds
  s_add_u32 m0, s41, 102400
  s_add_u32 s5, s40, 512000
  buffer_load_dwordx4 v3, s[16:19], s5 offen nt lds
  s_add_u32 m0, s41, 106496
  s_add_u32 s5, s40, 532480
  buffer_load_dwordx4 v3, s[16:19], s5 offen nt lds
  s_add_u32 m0, s41, 110592
  s_add_u32 s5, s40, 552960
  buffer_load_dwordx4 v3, s[16:19], s5 offen nt lds
  s_add_u32 m0, s41, 114688
  s_add_u32 s5, s40, 573440
  buffer_load_dwordx4 v3, s[16:19], s5 offen nt lds
  s_add_u32 m0, s41, 118784
  s_add_u32 s5, s40, 593920
  buffer_load_dwordx4 v3, s[16:19], s5 offen nt lds
  s_add_u32 m0, s41, 122880
  s_add_u32 s5, s40, 614400
  buffer_load_dwordx4 v3, s[16:19], s5 offen nt lds
  s_add_u32 m0, s41, 126976
  s_add_u32 s5, s40, 634880
  buffer_load_dwordx4 v3, s[16:19], s5 offen nt lds
  v_lshrrev_b32 v12, 4, v2
  v_bfe_u32 v13, v2, 2, 2
  v_lshl_add_u32 v12, v12, 2, v13
  v_and_b32 v13, 7, v12
  s_lshl_b32 s4, s28, 1
  v_xor_b32 v13, s4, v13
  v_lshlrev_b32 v13, 5, v13
  v_lshl_add_u32 v12, v12, 8, v13
  v_and_b32 v13, 3, v2
  v_lshl_add_u32 v4, v13, 3, v12
  v_xor_b32 v5, 32, v4
  s_waitcnt vmcnt(24) lgkmcnt(0)
  s_barrier
  v_add_u32 v8, 0, v4
  v_add_u32 v9, 0, v5
  ds_read_b64_tr_b16 a[0:1], v8 offset:0
  ds_read_b64_tr_b16 a[2:3], v8 offset:4096
  ds_read_b64_tr_b16 a[4:5], v9 offset:0
  ds_read_b64_tr_b16 a[6:7], v9 offset:4096
  ds_read_b64_tr_b16 a[8:9], v8 offset:8192
  ds_read_b64_tr_b16 a[10:11], v8 offset:12288
  ds_read_b64_tr_b16 a[12:13], v9 offset:8192
  ds_read_b64_tr_b16 a[14:15], v9 offset:12288
  ds_read_b64_tr_b16 a[16:17], v8 offset:16384
  ds_read_b64_tr_b16 a[18:19], v8 offset:20480
  ds_read_b64_tr_b16 a[20:21], v9 offset:16384
  ds_read_b64_tr_b16 a[22:23], v9 offset:20480
  ds_read_b64_tr_b16 a[24:25], v8 offset:24576
  ds_read_b64_tr_b16 a[26:27], v8 offset:28672
  ds_read_b64_tr_b16 a[28:29], v9 offset:24576
  ds_read_b64_tr_b16 a[30:31], v9 offset:28672
  s_waitcnt vmcnt(16) lgkmcnt(0)
  s_barrier
  s_add_u32 m0, s41, 0
  s_add_u32 s5, s40, 655360
  buffer_load_dwordx4 v3, s[16:19], s5 offen nt lds
  s_add_u32 m0, s41, 4096
  s_add_u32 s5, s40, 675840
  buffer_load_dwordx4 v3, s[16:19], s5 offen nt lds
  s_add_u32 m0, s41, 8192
  s_add_u32 s5, s40, 696320
  buffer_load_dwordx4 v3, s[16:19], s5 offen nt lds
  s_add_u32 m0, s41, 12288
  s_add_u32 s5, s40, 716800
  buffer_load_dwordx4 v3, s[16:19], s5 offen nt lds
  s_add_u32 m0, s41, 16384
  s_add_u32 s5, s40, 737280
  buffer_load_dwordx4 v3, s[16:19], s5 offen nt lds
  s_add_u32 m0, s41, 20480
  s_add_u32 s5, s40, 757760
  buffer_load_dwordx4 v3, s[16:19], s5 offen nt lds
  s_add_u32 m0, s41, 24576
  s_add_u32 s5, s40, 778240
  buffer_load_dwordx4 v3, s[16:19], s5 offen nt lds
  s_add_u32 m0, s41, 28672
  s_add_u32 s5, s40, 798720
  buffer_load_dwordx4 v3, s[16:19], s5 offen nt lds
  v_add_u32 v8, 32768, v4
  v_add_u32 v9, 32768, v5
  ds_read_b64_tr_b16 a[32:33], v8 offset:0
  ds_read_b64_tr_b16 a[34:35], v8 offset:4096
  ds_read_b64_tr_b16 a[36:37], v9 offset:0
  ds_read_b64_tr_b16 a[38:39], v9 offset:4096
  ds_read_b64_tr_b16 a[40:41], v8 offset:8192
  ds_read_b64_tr_b16 a[42:43], v8 offset:12288
  ds_read_b64_tr_b16 a[44:45], v9 offset:8192
  ds_read_b64_tr_b16 a[46:47], v9 offset:12288
  ds_read_b64_tr_b16 a[48:49], v8 offset:16384
  ds_read_b64_tr_b16 a[50:51], v8 offset:20480
  ds_read_b64_tr_b16 a[52:53], v9 offset:16384
  ds_read_b64_tr_b16 a[54:55], v9 offset:20480
  ds_read_b64_tr_b16 a[56:57], v8 offset:24576
  ds_read_b64_tr_b16 a[58:59], v8 offset:28672
  ds_read_b64_tr_b16 a[60:61], v9 offset:24576
  ds_read_b64_tr_b16 a[62:63], v9 offset:28672
  s_waitcnt vmcnt(16) lgkmcnt(0)
  s_barrier
  s_add_u32 m0, s41, 32768
  s_add_u32 s5, s40, 819200
  buffer_load_dwordx4 v3, s[16:19], s5 offen nt lds
  s_add_u32 m0, s41, 36864
  s_add_u32 s5, s40, 839680
  buffer_load_dwordx4 v3, s[16:19], s5 offen nt lds
  s_add_u32 m0, s41, 40960
  s_add_u32 s5, s40, 860160
  buffer_load_dwordx4 v3, s[16:19], s5 offen nt lds
  s_add_u32 m0, s41, 45056
  s_add_u32 s5, s40, 880640
  buffer_load_dwordx4 v3, s[16:19], s5 offen nt lds
  s_add_u32 m0, s41, 49152
  s_add_u32 s5, s40, 901120
  buffer_load_dwordx4 v3, s[16:19], s5 offen nt lds
  s_add_u32 m0, s41, 53248
  s_add_u32 s5, s40, 921600
  buffer_load_dwordx4 v3, s[16:19], s5 offen nt lds
  s_add_u32 m0, s41, 57344
  s_add_u32 s5, s40, 942080
  buffer_load_dwordx4 v3, s[16:19], s5 offen nt lds
  s_add_u32 m0, s41, 61440
  s_add_u32 s5, s40, 962560
  buffer_load_dwordx4 v3, s[16:19], s5 offen nt lds
  v_add_u32 v8, 65536, v4
  v_add_u32 v9, 65536, v5
  ds_read_b64_tr_b16 a[64:65], v8 offset:0
  ds_read_b64_tr_b16 a[66:67], v8 offset:4096
  ds_read_b64_tr_b16 a[68:69], v9 offset:0
  ds_read_b64_tr_b16 a[70:71], v9 offset:4096
  ds_read_b64_tr_b16 a[72:73], v8 offset:8192
  ds_read_b64_tr_b16 a[74:75], v8 offset:12288
  ds_read_b64_tr_b16 a[76:77], v9 offset:8192
  ds_read_b64_tr_b16 a[78:79], v9 offset:12288
  ds_read_b64_tr_b16 a[80:81], v8 offset:16384
  ds_read_b64_tr_b16 a[82:83], v8 offset:20480
  ds_read_b64_tr_b16 a[84:85], v9 offset:16384
  ds_read_b64_tr_b16 a[86:87], v9 offset:20480
  ds_read_b64_tr_b16 a[88:89], v8 offset:24576
  ds_read_b64_tr_b16 a[90:91], v8 offset:28672
  ds_read_b64_tr_b16 a[92:93], v9 offset:24576
  ds_read_b64_tr_b16 a[94:95], v9 offset:28672
  s_waitcnt vmcnt(16) lgkmcnt(0)
  s_barrier
  s_add_u32 m0, s41, 65536
  s_add_u32 s5, s40, 983040
  buffer_load_dwordx4 v3, s[16:19], s5 offen nt lds
  s_add_u32 m0, s41, 69632
  s_add_u32 s5, s40, 1003520
  buffer_load_dwordx4 v3, s[16:19], s5 offen nt lds
  s_add_u32 m0, s41, 73728
  s_add_u32 s5, s40, 1024000
  buffer_load_dwordx4 v3, s[16:19], s5 offen nt lds
  s_add_u32 m0, s41, 77824
  s_add_u32 s5, s40, 1044480
  buffer_load_dwordx4 v3, s[16:19], s5 offen nt lds
  s_add_u32 m0, s41, 81920
  s_add_u32 s5, s40, 1064960
  buffer_load_dwordx4 v3, s[16:19], s5 offen nt lds
  s_add_u32 m0, s41, 86016
  s_add_u32 s5, s40, 1085440
  buffer_load_dwordx4 v3, s[16:19], s5 offen nt lds
  s_add_u32 m0, s41, 90112
  s_add_u32 s5, s40, 1105920
  buffer_load_dwordx4 v3, s[16:19], s5 offen nt lds
  s_add_u32 m0, s41, 94208
  s_add_u32 s5, s40, 1126400
  buffer_load_dwordx4 v3, s[16:19], s5 offen nt lds
  v_add_u32 v8, 98304, v4
  v_add_u32 v9, 98304, v5
  ds_read_b64_tr_b16 a[96:97], v8 offset:0
  ds_read_b64_tr_b16 a[98:99], v8 offset:4096
  ds_read_b64_tr_b16 a[100:101], v9 offset:0
  ds_read_b64_tr_b16 a[102:103], v9 offset:4096
  ds_read_b64_tr_b16 a[104:105], v8 offset:8192
  ds_read_b64_tr_b16 a[106:107], v8 offset:12288
  ds_read_b64_tr_b16 a[108:109], v9 offset:8192
  ds_read_b64_tr_b16 a[110:111], v9 offset:12288
  ds_read_b64_tr_b16 a[112:113], v8 offset:16384
  ds_read_b64_tr_b16 a[114:115], v8 offset:20480
  ds_read_b64_tr_b16 a[116:117], v9 offset:16384
  ds_read_b64_tr_b16 a[118:119], v9 offset:20480
  ds_read_b64_tr_b16 a[120:121], v8 offset:24576
  ds_read_b64_tr_b16 a[122:123], v8 offset:28672
  ds_read_b64_tr_b16 a[124:125], v9 offset:24576
  ds_read_b64_tr_b16 a[126:127], v9 offset:28672
  s_waitcnt vmcnt(16) lgkmcnt(0)
  s_barrier
  s_add_u32 m0, s41, 98304
  s_add_u32 s5, s40, 1146880
  buffer_load_dwordx4 v3, s[16:19], s5 offen nt lds
  s_add_u32 m0, s41, 102400
  s_add_u32 s5, s40, 1167360
  buffer_load_dwordx4 v3, s[16:19], s5 offen nt lds
  s_add_u32 m0, s41, 106496
  s_add_u32 s5, s40, 1187840
  buffer_load_dwordx4 v3, s[16:19], s5 offen nt lds
  s_add_u32 m0, s41, 110592
  s_add_u32 s5, s40, 1208320
  buffer_load_dwordx4 v3, s[16:19], s5 offen nt lds
  s_add_u32 m0, s41, 114688
  s_add_u32 s5, s40, 1228800
  buffer_load_dwordx4 v3, s[16:19], s5 offen nt lds
  s_add_u32 m0, s41, 118784
  s_add_u32 s5, s40, 1249280
  buffer_load_dwordx4 v3, s[16:19], s5 offen nt lds
  s_add_u32 m0, s41, 122880
  s_add_u32 s5, s40, 1269760
  buffer_load_dwordx4 v3, s[16:19], s5 offen nt lds
  s_add_u32 m0, s41, 126976
  s_add_u32 s5, s40, 1290240
  buffer_load_dwordx4 v3, s[16:19], s5 offen nt lds
  v_add_u32 v8, 0, v4
  v_add_u32 v9, 0, v5
  ds_read_b64_tr_b16 a[128:129], v8 offset:0
  ds_read_b64_tr_b16 a[130:131], v8 offset:4096
  ds_read_b64_tr_b16 a[132:133], v9 offset:0
  ds_read_b64_tr_b16 a[134:135], v9 offset:4096
  ds_read_b64_tr_b16 a[136:137], v8 offset:8192
  ds_read_b64_tr_b16 a[138:139], v8 offset:12288
  ds_read_b64_tr_b16 a[140:141], v9 offset:8192
  ds_read_b64_tr_b16 a[142:143], v9 offset:12288
  ds_read_b64_tr_b16 a[144:145], v8 offset:16384
  ds_read_b64_tr_b16 a[146:147], v8 offset:20480
  ds_read_b64_tr_b16 a[148:149], v9 offset:16384
  ds_read_b64_tr_b16 a[150:151], v9 offset:20480
  ds_read_b64_tr_b16 a[152:153], v8 offset:24576
  ds_read_b64_tr_b16 a[154:155], v8 offset:28672
  ds_read_b64_tr_b16 a[156:157], v9 offset:24576
  ds_read_b64_tr_b16 a[158:159], v9 offset:28672
  s_waitcnt vmcnt(16) lgkmcnt(0)
  s_barrier
  v_add_u32 v8, 32768, v4
  v_add_u32 v9, 32768, v5
  ds_read_b64_tr_b16 a[160:161], v8 offset:0
  ds_read_b64_tr_b16 a[162:163], v8 offset:4096
  ds_read_b64_tr_b16 a[164:165], v9 offset:0
  ds_read_b64_tr_b16 a[166:167], v9 offset:4096
  ds_read_b64_tr_b16 a[168:169], v8 offset:8192
  ds_read_b64_tr_b16 a[170:171], v8 offset:12288
  ds_read_b64_tr_b16 a[172:173], v9 offset:8192
  ds_read_b64_tr_b16 a[174:175], v9 offset:12288
  ds_read_b64_tr_b16 a[176:177], v8 offset:16384
  ds_read_b64_tr_b16 a[178:179], v8 offset:20480
  ds_read_b64_tr_b16 a[180:181], v9 offset:16384
  ds_read_b64_tr_b16 a[182:183], v9 offset:20480
  ds_read_b64_tr_b16 a[184:185], v8 offset:24576
  ds_read_b64_tr_b16 a[186:187], v8 offset:28672
  ds_read_b64_tr_b16 a[188:189], v9 offset:24576
  ds_read_b64_tr_b16 a[190:191], v9 offset:28672
  s_waitcnt vmcnt(8) lgkmcnt(0)
  s_barrier
  v_add_u32 v8, 65536, v4
  v_add_u32 v9, 65536, v5
  ds_read_b64_tr_b16 a[192:193], v8 offset:0
  ds_read_b64_tr_b16 a[194:195], v8 offset:4096
  ds_read_b64_tr_b16 a[196:197], v9 offset:0
  ds_read_b64_tr_b16 a[198:199], v9 offset:4096
  ds_read_b64_tr_b16 a[200:201], v8 offset:8192
  ds_read_b64_tr_b16 a[202:203], v8 offset:12288
  ds_read_b64_tr_b16 a[204:205], v9 offset:8192
  ds_read_b64_tr_b16 a[206:207], v9 offset:12288
  ds_read_b64_tr_b16 a[208:209], v8 offset:16384
  ds_read_b64_tr_b16 a[210:211], v8 offset:20480
  ds_read_b64_tr_b16 a[212:213], v9 offset:16384
  ds_read_b64_tr_b16 a[214:215], v9 offset:20480
  ds_read_b64_tr_b16 a[216:217], v8 offset:24576
  ds_read_b64_tr_b16 a[218:219], v8 offset:28672
  ds_read_b64_tr_b16 a[220:221], v9 offset:24576
  ds_read_b64_tr_b16 a[222:223], v9 offset:28672
  s_waitcnt vmcnt(0) lgkmcnt(0)
  s_barrier
  v_add_u32 v8, 98304, v4
  v_add_u32 v9, 98304, v5
  ds_read_b64_tr_b16 a[224:225], v8 offset:0
  ds_read_b64_tr_b16 a[226:227], v8 offset:4096
  ds_read_b64_tr_b16 a[228:229], v9 offset:0
  ds_read_b64_tr_b16 a[230:231], v9 offset:4096
  ds_read_b64_tr_b16 a[232:233], v8 offset:8192
  ds_read_b64_tr_b16 a[234:235], v8 offset:12288
  ds_read_b64_tr_b16 a[236:237], v9 offset:8192
  ds_read_b64_tr_b16 a[238:239], v9 offset:12288
  ds_read_b64_tr_b16 a[240:241], v8 offset:16384
  ds_read_b64_tr_b16 a[242:243], v8 offset:20480
  ds_read_b64_tr_b16 a[244:245], v9 offset:16384
  ds_read_b64_tr_b16 a[246:247], v9 offset:20480
  ds_read_b64_tr_b16 a[248:249], v8 offset:24576
  ds_read_b64_tr_b16 a[250:251], v8 offset:28672
  ds_read_b64_tr_b16 a[252:253], v9 offset:24576
  ds_read_b64_tr_b16 a[254:255], v9 offset:28672
  s_waitcnt vmcnt(0) lgkmcnt(0)
  s_barrier
  v_lshlrev_b32 v6, 7, v2
  s_lshl_b32 s4, s26, 11
  s_lshl_b32 s5, s38, 3
  s_add_u32 s4, s4, s5
  s_lshl_b32 s33, s4, 13
  s_lshl_b32 s5, s28, 10
  s_add_u32 s33, s33, s5
  s_add_u32 s33, s33, 83886080
  s_lshl_b32 s4, s26, 5
  s_lshl_b32 s5, s38, 3
  s_add_u32 s4, s4, s5
  s_lshl_b32 s4, s4, 7
  s_add_u32 s57, s4, 166739968
  s_mul_i32 s4, s26, 320
  s_add_u32 s4, s4, s39
  s_lshl_b32 s4, s4, 2
  s_add_u32 s4, s4, s28
  s_lshl_b32 s4, s4, 14
  s_add_u32 s34, s4, 117440512
  s_lshl_b32 s5, s38, 10
  s_add_u32 s35, s34, s5
  s_lshl_b32 s5, s38, 12
  s_add_u32 s36, s34, s5
  s_mul_i32 s4, s26, 20
  s_lshl_b32 s5, s39, 2
  s_add_u32 s4, s4, s5
  s_lshl_b32 s4, s4, 7
  s_add_u32 s58, s4, 166748160
  s_lshl_b32 s5, s38, 7
  s_add_u32 s59, s58, s5
  v_and_b32 v12, 15, v2
  v_mul_u32_u24 v12, 2560, v12
  v_lshrrev_b32 v13, 4, v2
  v_lshl_add_u32 v7, v13, 3, v12
  s_mul_i32 s37, s26, 1280
  s_lshl_b32 s4, s39, 8
  s_add_u32 s37, s37, s4
  s_lshl_b32 s4, s28, 6
  s_add_u32 s37, s37, s4
  s_lshr_b32 s4, s38, 1
  s_lshl_b32 s4, s4, 5
  s_add_u32 s37, s37, s4
  s_and_b32 s4, s38, 1
  s_mul_i32 s4, s4, 40960
  s_add_u32 s37, s37, s4
  s_mov_b32 s32, 0
  v_lshlrev_b32 v10, 7, v2
  v_add_u32 v10, s57, v10
  v_subrev_u32 v12, 8, v2
  v_lshlrev_b32 v12, 7, v12
  v_add_u32 v12, s58, v12
  v_cmp_gt_u32 vcc, 8, v2
  s_nop 1
  v_cndmask_b32 v10, v12, v10, vcc
  s_mov_b64 s[60:61], vcc
  v_mov_b32 v18, v1
  s_mov_b32 s62, 0
  s_mov_b32 s63, 0
  s_mov_b32 s64, 0
WO_LOOP_106:
  s_add_u32 s55, s32, 1
  s_cmp_lg_u32 s62, 0
  s_cselect_b32 s55, 0, s55
  s_sub_u32 s56, s32, 2
  s_cmp_lt_u32 s32, 3
  s_cselect_b32 s56, 0, s56
  s_cmp_eq_u32 s63, 1
  s_cselect_b32 s56, 0, s56
  s_or_b32 s4, s55, s56
  s_cmp_eq_u32 s4, 0
  s_cbranch_scc1 WO_P2OK_107
  v_mov_b32 v11, s56
  v_mov_b32 v16, s55
  v_cndmask_b32 v11, v11, v16, s[60:61]
  s_mov_b32 s7, 0
  s_mov_b64 exec, 0xfff
WO_P0_110:
  buffer_load_dword v15, v10, s[8:11], 0 offen sc1
  s_add_u32 s7, s7, 1
  s_cmp_gt_u32 s7, 0x40000
  s_cbranch_scc1 WO_P0X_111
  s_waitcnt vmcnt(0)
  v_cmp_gt_u32 vcc, v11, v15
  s_cbranch_vccz WO_P0X_111
  s_sleep 1
  s_branch WO_P0_110
WO_P0X_111:
  s_waitcnt vmcnt(0)
  s_mov_b64 exec, -1
WO_P2OK_107:
  s_cmp_eq_u32 s62, 1
  s_cbranch_scc1 WO_FAST_108
  s_add_u32 s65, s41, s64
  s_cmp_eq_u32 s62, 2
  s_cbranch_scc1 WO_S1_112
  s_add_u32 m0, s65, 0
  s_add_u32 s5, s33, 0
  buffer_load_dwordx4 v1, s[8:11], s5 offen sc1 lds
  s_add_u32 m0, s65, 4096
  s_add_u32 s5, s33, 4096
  buffer_load_dwordx4 v1, s[8:11], s5 offen sc1 lds
  s_add_u32 m0, s65, 8192
  s_add_u32 s5, s33, 8192
  buffer_load_dwordx4 v1, s[8:11], s5 offen sc1 lds
  s_add_u32 m0, s65, 12288
  s_add_u32 s5, s33, 12288
  buffer_load_dwordx4 v1, s[8:11], s5 offen sc1 lds
  s_add_u32 m0, s65, 16384
  s_add_u32 s5, s33, 16384
  buffer_load_dwordx4 v1, s[8:11], s5 offen sc1 lds
  s_add_u32 m0, s65, 20480
  s_add_u32 s5, s33, 20480
  buffer_load_dwordx4 v1, s[8:11], s5 offen sc1 lds
  s_add_u32 m0, s65, 24576
  s_add_u32 s5, s33, 24576
  buffer_load_dwordx4 v1, s[8:11], s5 offen sc1 lds
  s_add_u32 m0, s65, 28672
  s_add_u32 s5, s33, 28672
  buffer_load_dwordx4 v1, s[8:11], s5 offen sc1 lds
  s_waitcnt vmcnt(4)
  s_branch WO_S2_113
WO_S1_112:
  s_waitcnt vmcnt(8)
WO_S2_113:
  s_barrier
  ds_read_b128 v[144:147], v18 offset:0
  ds_read_b128 v[148:151], v18 offset:4096
  ds_read_b128 v[152:155], v18 offset:1024
  ds_read_b128 v[156:159], v18 offset:5120
  ds_read_b128 v[160:163], v18 offset:2048
  ds_read_b128 v[164:167], v18 offset:6144
  ds_read_b128 v[168:171], v18 offset:3072
  ds_read_b128 v[172:175], v18 offset:7168
  s_waitcnt lgkmcnt(6)
  v_mfma_f32_16x16x32_bf16 v[128:131], a[0:3], v[144:147], 0
  v_mfma_f32_16x16x32_bf16 v[136:139], a[4:7], v[144:147], 0
  v_mfma_f32_16x16x32_bf16 v[132:135], a[0:3], v[148:151], 0
  v_mfma_f32_16x16x32_bf16 v[140:143], a[4:7], v[148:151], 0
  s_add_u32 m0, s65, 32768
  s_add_u32 s5, s33, 32768
  buffer_load_dwordx4 v1, s[8:11], s5 offen sc1 lds
  ds_read_b128 v[144:147], v18 offset:8192
  ds_read_b128 v[148:151], v18 offset:12288
  s_waitcnt lgkmcnt(6)
  v_mfma_f32_16x16x32_bf16 v[128:131], a[8:11], v[152:155], v[128:131]
  v_mfma_f32_16x16x32_bf16 v[136:139], a[12:15], v[152:155], v[136:139]
  v_mfma_f32_16x16x32_bf16 v[132:135], a[8:11], v[156:159], v[132:135]
  v_mfma_f32_16x16x32_bf16 v[140:143], a[12:15], v[156:159], v[140:143]
  s_add_u32 m0, s65, 36864
  s_add_u32 s5, s33, 36864
  buffer_load_dwordx4 v1, s[8:11], s5 offen sc1 lds
  ds_read_b128 v[152:155], v18 offset:9216
  ds_read_b128 v[156:159], v18 offset:13312
  s_waitcnt lgkmcnt(6)
  v_mfma_f32_16x16x32_bf16 v[128:131], a[16:19], v[160:163], v[128:131]
  v_mfma_f32_16x16x32_bf16 v[136:139], a[20:23], v[160:163], v[136:139]
  v_mfma_f32_16x16x32_bf16 v[132:135], a[16:19], v[164:167], v[132:135]
  v_mfma_f32_16x16x32_bf16 v[140:143], a[20:23], v[164:167], v[140:143]
  s_add_u32 m0, s65, 40960
  s_add_u32 s5, s33, 40960
  buffer_load_dwordx4 v1, s[8:11], s5 offen sc1 lds
  ds_read_b128 v[160:163], v18 offset:10240
  ds_read_b128 v[164:167], v18 offset:14336
  s_waitcnt lgkmcnt(6)
  v_mfma_f32_16x16x32_bf16 v[128:131], a[24:27], v[168:171], v[128:131]
  v_mfma_f32_16x16x32_bf16 v[136:139], a[28:31], v[168:171], v[136:139]
  v_mfma_f32_16x16x32_bf16 v[132:135], a[24:27], v[172:175], v[132:135]
  v_mfma_f32_16x16x32_bf16 v[140:143], a[28:31], v[172:175], v[140:143]
  s_add_u32 m0, s65, 45056
  s_add_u32 s5, s33, 45056
  buffer_load_dwordx4 v1, s[8:11], s5 offen sc1 lds
  ds_read_b128 v[168:171], v18 offset:11264
  ds_read_b128 v[172:175], v18 offset:15360
  s_waitcnt lgkmcnt(6)
  v_mfma_f32_16x16x32_bf16 v[128:131], a[32:35], v[144:147], v[128:131]
  v_mfma_f32_16x16x32_bf16 v[136:139], a[36:39], v[144:147], v[136:139]
  v_mfma_f32_16x16x32_bf16 v[132:135], a[32:35], v[148:151], v[132:135]
  v_mfma_f32_16x16x32_bf16 v[140:143], a[36:39], v[148:151], v[140:143]
  s_add_u32 m0, s65, 49152
  s_add_u32 s5, s33, 49152
  buffer_load_dwordx4 v1, s[8:11], s5 offen sc1 lds
  s_waitcnt lgkmcnt(4)
  v_mfma_f32_16x16x32_bf16 v[128:131], a[40:43], v[152:155], v[128:131]
  v_mfma_f32_16x16x32_bf16 v[136:139], a[44:47], v[152:155], v[136:139]
  v_mfma_f32_16x16x32_bf16 v[132:135], a[40:43], v[156:159], v[132:135]
  v_mfma_f32_16x16x32_bf16 v[140:143], a[44:47], v[156:159], v[140:143]
  s_add_u32 m0, s65, 53248
  s_add_u32 s5, s33, 53248
  buffer_load_dwordx4 v1, s[8:11], s5 offen sc1 lds
  s_waitcnt lgkmcnt(2)
  v_mfma_f32_16x16x32_bf16 v[128:131], a[48:51], v[160:163], v[128:131]
  v_mfma_f32_16x16x32_bf16 v[136:139], a[52:55], v[160:163], v[136:139]
  v_mfma_f32_16x16x32_bf16 v[132:135], a[48:51], v[164:167], v[132:135]
  v_mfma_f32_16x16x32_bf16 v[140:143], a[52:55], v[164:167], v[140:143]
  s_add_u32 m0, s65, 57344
  s_add_u32 s5, s33, 57344
  buffer_load_dwordx4 v1, s[8:11], s5 offen sc1 lds
  s_waitcnt lgkmcnt(0)
  v_mfma_f32_16x16x32_bf16 v[128:131], a[56:59], v[168:171], v[128:131]
  v_mfma_f32_16x16x32_bf16 v[136:139], a[60:63], v[168:171], v[136:139]
  v_mfma_f32_16x16x32_bf16 v[132:135], a[56:59], v[172:175], v[132:135]
  v_mfma_f32_16x16x32_bf16 v[140:143], a[60:63], v[172:175], v[140:143]
  s_add_u32 m0, s65, 61440
  s_add_u32 s5, s33, 61440
  buffer_load_dwordx4 v1, s[8:11], s5 offen sc1 lds
  buffer_load_dwordx4 v[176:179], v1, s[8:11], s36 offen offset:0 sc1
  buffer_load_dwordx4 v[180:183], v1, s[8:11], s36 offen offset:1024 sc1
  buffer_load_dwordx4 v[184:187], v1, s[8:11], s36 offen offset:2048 sc1
  buffer_load_dwordx4 v[188:191], v1, s[8:11], s36 offen offset:3072 sc1
  s_mov_b64 exec, 0xfff
  buffer_load_dword v15, v10, s[8:11], 0 offen sc1
  s_mov_b64 exec, -1
  s_cmp_eq_u32 s62, 2
  s_cbranch_scc1 WO_S3_114
  s_waitcnt vmcnt(13)
  s_branch WO_S4_115
WO_S3_114:
  s_waitcnt vmcnt(17)
WO_S4_115:
  s_barrier
  ds_read_b128 v[144:147], v18 offset:16384
  ds_read_b128 v[148:151], v18 offset:20480
  ds_read_b128 v[152:155], v18 offset:17408
  ds_read_b128 v[156:159], v18 offset:21504
  ds_read_b128 v[160:163], v18 offset:18432
  ds_read_b128 v[164:167], v18 offset:22528
  ds_read_b128 v[168:171], v18 offset:19456
  ds_read_b128 v[172:175], v18 offset:23552
  s_waitcnt lgkmcnt(6)
  v_mfma_f32_16x16x32_bf16 v[128:131], a[64:67], v[144:147], v[128:131]
  v_mfma_f32_16x16x32_bf16 v[136:139], a[68:71], v[144:147], v[136:139]
  v_mfma_f32_16x16x32_bf16 v[132:135], a[64:67], v[148:151], v[132:135]
  v_mfma_f32_16x16x32_bf16 v[140:143], a[68:71], v[148:151], v[140:143]
  ds_read_b128 v[144:147], v18 offset:24576
  ds_read_b128 v[148:151], v18 offset:28672
  s_waitcnt lgkmcnt(6)
  v_mfma_f32_16x16x32_bf16 v[128:131], a[72:75], v[152:155], v[128:131]
  v_mfma_f32_16x16x32_bf16 v[136:139], a[76:79], v[152:155], v[136:139]
  v_mfma_f32_16x16x32_bf16 v[132:135], a[72:75], v[156:159], v[132:135]
  v_mfma_f32_16x16x32_bf16 v[140:143], a[76:79], v[156:159], v[140:143]
  ds_read_b128 v[152:155], v18 offset:25600
  ds_read_b128 v[156:159], v18 offset:29696
  s_waitcnt lgkmcnt(6)
  v_mfma_f32_16x16x32_bf16 v[128:131], a[80:83], v[160:163], v[128:131]
  v_mfma_f32_16x16x32_bf16 v[136:139], a[84:87], v[160:163], v[136:139]
  v_mfma_f32_16x16x32_bf16 v[132:135], a[80:83], v[164:167], v[132:135]
  v_mfma_f32_16x16x32_bf16 v[140:143], a[84:87], v[164:167], v[140:143]
  ds_read_b128 v[160:163], v18 offset:26624
  ds_read_b128 v[164:167], v18 offset:30720
  s_waitcnt lgkmcnt(6)
  v_mfma_f32_16x16x32_bf16 v[128:131], a[88:91], v[168:171], v[128:131]
  v_mfma_f32_16x16x32_bf16 v[136:139], a[92:95], v[168:171], v[136:139]
  v_mfma_f32_16x16x32_bf16 v[132:135], a[88:91], v[172:175], v[132:135]
  v_mfma_f32_16x16x32_bf16 v[140:143], a[92:95], v[172:175], v[140:143]
  ds_read_b128 v[168:171], v18 offset:27648
  ds_read_b128 v[172:175], v18 offset:31744
  s_waitcnt lgkmcnt(6)
  v_mfma_f32_16x16x32_bf16 v[128:131], a[96:99], v[144:147], v[128:131]
  v_mfma_f32_16x16x32_bf16 v[136:139], a[100:103], v[144:147], v[136:139]
  v_mfma_f32_16x16x32_bf16 v[132:135], a[96:99], v[148:151], v[132:135]
  v_mfma_f32_16x16x32_bf16 v[140:143], a[100:103], v[148:151], v[140:143]
  s_waitcnt lgkmcnt(4)
  v_mfma_f32_16x16x32_bf16 v[128:131], a[104:107], v[152:155], v[128:131]
  v_mfma_f32_16x16x32_bf16 v[136:139], a[108:111], v[152:155], v[136:139]
  v_mfma_f32_16x16x32_bf16 v[132:135], a[104:107], v[156:159], v[132:135]
  v_mfma_f32_16x16x32_bf16 v[140:143], a[108:111], v[156:159], v[140:143]
  s_waitcnt lgkmcnt(2)
  v_mfma_f32_16x16x32_bf16 v[128:131], a[112:115], v[160:163], v[128:131]
  v_mfma_f32_16x16x32_bf16 v[136:139], a[116:119], v[160:163], v[136:139]
  v_mfma_f32_16x16x32_bf16 v[132:135], a[112:115], v[164:167], v[132:135]
  v_mfma_f32_16x16x32_bf16 v[140:143], a[116:119], v[164:167], v[140:143]
  s_waitcnt lgkmcnt(0)
  v_mfma_f32_16x16x32_bf16 v[128:131], a[120:123], v[168:171], v[128:131]
  v_mfma_f32_16x16x32_bf16 v[136:139], a[124:127], v[168:171], v[136:139]
  v_mfma_f32_16x16x32_bf16 v[132:135], a[120:123], v[172:175], v[132:135]
  v_mfma_f32_16x16x32_bf16 v[140:143], a[124:127], v[172:175], v[140:143]
  s_branch WO_MID_109
WO_FAST_108:
  buffer_load_dwordx4 v[176:179], v1, s[8:11], s36 offen offset:0 sc1
  buffer_load_dwordx4 v[180:183], v1, s[8:11], s36 offen offset:1024 sc1
  buffer_load_dwordx4 v[184:187], v1, s[8:11], s36 offen offset:2048 sc1
  buffer_load_dwordx4 v[188:191], v1, s[8:11], s36 offen offset:3072 sc1
  s_mov_b64 exec, 0xfff
  buffer_load_dword v15, v10, s[8:11], 0 offen sc1
  s_mov_b64 exec, -1
  s_waitcnt vmcnt(22)
  s_barrier
  ds_read_b128 v[144:147], v18 offset:0
  ds_read_b128 v[148:151], v18 offset:4096
  ds_read_b128 v[152:155], v18 offset:1024
  ds_read_b128 v[156:159], v18 offset:5120
  ds_read_b128 v[160:163], v18 offset:2048
  ds_read_b128 v[164:167], v18 offset:6144
  ds_read_b128 v[168:171], v18 offset:3072
  ds_read_b128 v[172:175], v18 offset:7168
  s_waitcnt lgkmcnt(6)
  v_mfma_f32_16x16x32_bf16 v[128:131], a[0:3], v[144:147], 0
  v_mfma_f32_16x16x32_bf16 v[136:139], a[4:7], v[144:147], 0
  v_mfma_f32_16x16x32_bf16 v[132:135], a[0:3], v[148:151], 0
  v_mfma_f32_16x16x32_bf16 v[140:143], a[4:7], v[148:151], 0
  ds_read_b128 v[144:147], v18 offset:8192
  ds_read_b128 v[148:151], v18 offset:12288
  s_waitcnt lgkmcnt(6)
  v_mfma_f32_16x16x32_bf16 v[128:131], a[8:11], v[152:155], v[128:131]
  v_mfma_f32_16x16x32_bf16 v[136:139], a[12:15], v[152:155], v[136:139]
  v_mfma_f32_16x16x32_bf16 v[132:135], a[8:11], v[156:159], v[132:135]
  v_mfma_f32_16x16x32_bf16 v[140:143], a[12:15], v[156:159], v[140:143]
  ds_read_b128 v[152:155], v18 offset:9216
  ds_read_b128 v[156:159], v18 offset:13312
  s_waitcnt lgkmcnt(6)
  v_mfma_f32_16x16x32_bf16 v[128:131], a[16:19], v[160:163], v[128:131]
  v_mfma_f32_16x16x32_bf16 v[136:139], a[20:23], v[160:163], v[136:139]
  v_mfma_f32_16x16x32_bf16 v[132:135], a[16:19], v[164:167], v[132:135]
  v_mfma_f32_16x16x32_bf16 v[140:143], a[20:23], v[164:167], v[140:143]
  ds_read_b128 v[160:163], v18 offset:10240
  ds_read_b128 v[164:167], v18 offset:14336
  s_waitcnt lgkmcnt(6)
  v_mfma_f32_16x16x32_bf16 v[128:131], a[24:27], v[168:171], v[128:131]
  v_mfma_f32_16x16x32_bf16 v[136:139], a[28:31], v[168:171], v[136:139]
  v_mfma_f32_16x16x32_bf16 v[132:135], a[24:27], v[172:175], v[132:135]
  v_mfma_f32_16x16x32_bf16 v[140:143], a[28:31], v[172:175], v[140:143]
  ds_read_b128 v[168:171], v18 offset:11264
  ds_read_b128 v[172:175], v18 offset:15360
  s_waitcnt lgkmcnt(6)
  v_mfma_f32_16x16x32_bf16 v[128:131], a[32:35], v[144:147], v[128:131]
  v_mfma_f32_16x16x32_bf16 v[136:139], a[36:39], v[144:147], v[136:139]
  v_mfma_f32_16x16x32_bf16 v[132:135], a[32:35], v[148:151], v[132:135]
  v_mfma_f32_16x16x32_bf16 v[140:143], a[36:39], v[148:151], v[140:143]
  s_waitcnt lgkmcnt(4)
  v_mfma_f32_16x16x32_bf16 v[128:131], a[40:43], v[152:155], v[128:131]
  v_mfma_f32_16x16x32_bf16 v[136:139], a[44:47], v[152:155], v[136:139]
  v_mfma_f32_16x16x32_bf16 v[132:135], a[40:43], v[156:159], v[132:135]
  v_mfma_f32_16x16x32_bf16 v[140:143], a[44:47], v[156:159], v[140:143]
  s_waitcnt lgkmcnt(2)
  v_mfma_f32_16x16x32_bf16 v[128:131], a[48:51], v[160:163], v[128:131]
  v_mfma_f32_16x16x32_bf16 v[136:139], a[52:55], v[160:163], v[136:139]
  v_mfma_f32_16x16x32_bf16 v[132:135], a[48:51], v[164:167], v[132:135]
  v_mfma_f32_16x16x32_bf16 v[140:143], a[52:55], v[164:167], v[140:143]
  s_waitcnt lgkmcnt(0)
  v_mfma_f32_16x16x32_bf16 v[128:131], a[56:59], v[168:171], v[128:131]
  v_mfma_f32_16x16x32_bf16 v[136:139], a[60:63], v[168:171], v[136:139]
  v_mfma_f32_16x16x32_bf16 v[132:135], a[56:59], v[172:175], v[132:135]
  v_mfma_f32_16x16x32_bf16 v[140:143], a[60:63], v[172:175], v[140:143]
  s_waitcnt vmcnt(18)
  s_barrier
  ds_read_b128 v[144:147], v18 offset:16384
  ds_read_b128 v[148:151], v18 offset:20480
  ds_read_b128 v[152:155], v18 offset:17408
  ds_read_b128 v[156:159], v18 offset:21504
  ds_read_b128 v[160:163], v18 offset:18432
  ds_read_b128 v[164:167], v18 offset:22528
  ds_read_b128 v[168:171], v18 offset:19456
  ds_read_b128 v[172:175], v18 offset:23552
  s_waitcnt lgkmcnt(6)
  v_mfma_f32_16x16x32_bf16 v[128:131], a[64:67], v[144:147], v[128:131]
  v_mfma_f32_16x16x32_bf16 v[136:139], a[68:71], v[144:147], v[136:139]
  v_mfma_f32_16x16x32_bf16 v[132:135], a[64:67], v[148:151], v[132:135]
  v_mfma_f32_16x16x32_bf16 v[140:143], a[68:71], v[148:151], v[140:143]
  ds_read_b128 v[144:147], v18 offset:24576
  ds_read_b128 v[148:151], v18 offset:28672
  s_waitcnt lgkmcnt(6)
  v_mfma_f32_16x16x32_bf16 v[128:131], a[72:75], v[152:155], v[128:131]
  v_mfma_f32_16x16x32_bf16 v[136:139], a[76:79], v[152:155], v[136:139]
  v_mfma_f32_16x16x32_bf16 v[132:135], a[72:75], v[156:159], v[132:135]
  v_mfma_f32_16x16x32_bf16 v[140:143], a[76:79], v[156:159], v[140:143]
  ds_read_b128 v[152:155], v18 offset:25600
  ds_read_b128 v[156:159], v18 offset:29696
  s_waitcnt lgkmcnt(6)
  v_mfma_f32_16x16x32_bf16 v[128:131], a[80:83], v[160:163], v[128:131]
  v_mfma_f32_16x16x32_bf16 v[136:139], a[84:87], v[160:163], v[136:139]
  v_mfma_f32_16x16x32_bf16 v[132:135], a[80:83], v[164:167], v[132:135]
  v_mfma_f32_16x16x32_bf16 v[140:143], a[84:87], v[164:167], v[140:143]
  ds_read_b128 v[160:163], v18 offset:26624
  ds_read_b128 v[164:167], v18 offset:30720
  s_waitcnt lgkmcnt(6)
  v_mfma_f32_16x16x32_bf16 v[128:131], a[88:91], v[168:171], v[128:131]
  v_mfma_f32_16x16x32_bf16 v[136:139], a[92:95], v[168:171], v[136:139]
  v_mfma_f32_16x16x32_bf16 v[132:135], a[88:91], v[172:175], v[132:135]
  v_mfma_f32_16x16x32_bf16 v[140:143], a[92:95], v[172:175], v[140:143]
  ds_read_b128 v[168:171], v18 offset:27648
  ds_read_b128 v[172:175], v18 offset:31744
  s_waitcnt lgkmcnt(6)
  v_mfma_f32_16x16x32_bf16 v[128:131], a[96:99], v[144:147], v[128:131]
  v_mfma_f32_16x16x32_bf16 v[136:139], a[100:103], v[144:147], v[136:139]
  v_mfma_f32_16x16x32_bf16 v[132:135], a[96:99], v[148:151], v[132:135]
  v_mfma_f32_16x16x32_bf16 v[140:143], a[100:103], v[148:151], v[140:143]
  s_waitcnt lgkmcnt(4)
  v_mfma_f32_16x16x32_bf16 v[128:131], a[104:107], v[152:155], v[128:131]
  v_mfma_f32_16x16x32_bf16 v[136:139], a[108:111], v[152:155], v[136:139]
  v_mfma_f32_16x16x32_bf16 v[132:135], a[104:107], v[156:159], v[132:135]
  v_mfma_f32_16x16x32_bf16 v[140:143], a[108:111], v[156:159], v[140:143]
  s_waitcnt lgkmcnt(2)
  v_mfma_f32_16x16x32_bf16 v[128:131], a[112:115], v[160:163], v[128:131]
  v_mfma_f32_16x16x32_bf16 v[136:139], a[116:119], v[160:163], v[136:139]
  v_mfma_f32_16x16x32_bf16 v[132:135], a[112:115], v[164:167], v[132:135]
  v_mfma_f32_16x16x32_bf16 v[140:143], a[116:119], v[164:167], v[140:143]
  s_waitcnt lgkmcnt(0)
  v_mfma_f32_16x16x32_bf16 v[128:131], a[120:123], v[168:171], v[128:131]
  v_mfma_f32_16x16x32_bf16 v[136:139], a[124:127], v[168:171], v[136:139]
  v_mfma_f32_16x16x32_bf16 v[132:135], a[120:123], v[172:175], v[132:135]
  v_mfma_f32_16x16x32_bf16 v[140:143], a[124:127], v[172:175], v[140:143]
WO_MID_109:
  s_waitcnt vmcnt(0)
  s_cmp_lg_u32 s28, 0
  s_cbranch_scc1 WO_DEC_118
  s_add_u32 s55, s32, 2
  s_sub_u32 s56, s32, 1
  s_max_i32 s56, s56, 0
  v_mov_b32 v11, s56
  v_mov_b32 v16, s55
  v_cndmask_b32 v11, v11, v16, s[60:61]
  s_mov_b64 exec, 0xfff
  v_cmp_gt_u32 vcc, v11, v15
  s_mov_b64 exec, -1
  s_nop 1
  v_mov_b32 v16, vcc_lo
  v_mov_b32 v17, 131072
  ds_write_b32 v17, v16
WO_DEC_118:
  s_waitcnt lgkmcnt(0)
  s_barrier
  v_mov_b32 v20, 131072
  ds_read_b32 v19, v20
  s_cmp_lg_u32 s28, 0
  s_cbranch_scc1 WO_NF_119
  v_mov_b32 v16, s32
  v_mov_b32 v17, 0
  s_mov_b64 exec, 1
  s_cmp_eq_u32 s78, 1
  s_cbranch_scc1 WO_FS_120
  buffer_store_dword v16, v17, s[8:11], s59 offen sc1
  s_branch WO_FD_121
WO_FS_120:
  buffer_store_dword v16, v17, s[8:11], s59 offen
WO_FD_121:
  s_mov_b64 exec, -1
WO_NF_119:
  s_waitcnt lgkmcnt(0)
  v_readfirstlane_b32 s6, v19
  s_nop 0
  s_and_b32 s4, s6, 0xf00
  s_cmp_eq_u32 s4, 0
  s_cselect_b32 s63, 1, 0
  s_and_b32 s4, s6, 0xff
  s_cmp_eq_u32 s4, 0
  s_cselect_b32 s62, 1, 0
  s_cmp_ge_u32 s32, 63
  s_cselect_b32 s62, 0, s62
  s_cmp_eq_u32 s62, 0
  s_cbranch_scc1 WO_NOPRE_116
  s_xor_b32 s65, s64, 65536
  s_add_u32 s65, s65, s41
  s_add_u32 s66, s33, 262144
  ds_read_b128 v[144:147], v18 offset:32768
  ds_read_b128 v[148:151], v18 offset:36864
  ds_read_b128 v[152:155], v18 offset:33792
  ds_read_b128 v[156:159], v18 offset:37888
  ds_read_b128 v[160:163], v18 offset:34816
  ds_read_b128 v[164:167], v18 offset:38912
  ds_read_b128 v[168:171], v18 offset:35840
  ds_read_b128 v[172:175], v18 offset:39936
  s_waitcnt lgkmcnt(6)
  v_mfma_f32_16x16x32_bf16 v[128:131], a[128:131], v[144:147], v[128:131]
  v_mfma_f32_16x16x32_bf16 v[136:139], a[132:135], v[144:147], v[136:139]
  v_mfma_f32_16x16x32_bf16 v[132:135], a[128:131], v[148:151], v[132:135]
  v_mfma_f32_16x16x32_bf16 v[140:143], a[132:135], v[148:151], v[140:143]
  s_add_u32 m0, s65, 0
  s_add_u32 s5, s66, 0
  buffer_load_dwordx4 v1, s[8:11], s5 offen sc1 lds
  ds_read_b128 v[144:147], v18 offset:40960
  ds_read_b128 v[148:151], v18 offset:45056
  s_waitcnt lgkmcnt(6)
  v_mfma_f32_16x16x32_bf16 v[128:131], a[136:139], v[152:155], v[128:131]
  v_mfma_f32_16x16x32_bf16 v[136:139], a[140:143], v[152:155], v[136:139]
  v_mfma_f32_16x16x32_bf16 v[132:135], a[136:139], v[156:159], v[132:135]
  v_mfma_f32_16x16x32_bf16 v[140:143], a[140:143], v[156:159], v[140:143]
  s_add_u32 m0, s65, 4096
  s_add_u32 s5, s66, 4096
  buffer_load_dwordx4 v1, s[8:11], s5 offen sc1 lds
  ds_read_b128 v[152:155], v18 offset:41984
  ds_read_b128 v[156:159], v18 offset:46080
  s_waitcnt lgkmcnt(6)
  v_mfma_f32_16x16x32_bf16 v[128:131], a[144:147], v[160:163], v[128:131]
  v_mfma_f32_16x16x32_bf16 v[136:139], a[148:151], v[160:163], v[136:139]
  v_mfma_f32_16x16x32_bf16 v[132:135], a[144:147], v[164:167], v[132:135]
  v_mfma_f32_16x16x32_bf16 v[140:143], a[148:151], v[164:167], v[140:143]
  s_add_u32 m0, s65, 8192
  s_add_u32 s5, s66, 8192
  buffer_load_dwordx4 v1, s[8:11], s5 offen sc1 lds
  ds_read_b128 v[160:163], v18 offset:43008
  ds_read_b128 v[164:167], v18 offset:47104
  s_waitcnt lgkmcnt(6)
  v_mfma_f32_16x16x32_bf16 v[128:131], a[152:155], v[168:171], v[128:131]
  v_mfma_f32_16x16x32_bf16 v[136:139], a[156:159], v[168:171], v[136:139]
  v_mfma_f32_16x16x32_bf16 v[132:135], a[152:155], v[172:175], v[132:135]
  v_mfma_f32_16x16x32_bf16 v[140:143], a[156:159], v[172:175], v[140:143]
  s_add_u32 m0, s65, 12288
  s_add_u32 s5, s66, 12288
  buffer_load_dwordx4 v1, s[8:11], s5 offen sc1 lds
  ds_read_b128 v[168:171], v18 offset:44032
  ds_read_b128 v[172:175], v18 offset:48128
  s_waitcnt lgkmcnt(6)
  v_mfma_f32_16x16x32_bf16 v[128:131], a[160:163], v[144:147], v[128:131]
  v_mfma_f32_16x16x32_bf16 v[136:139], a[164:167], v[144:147], v[136:139]
  v_mfma_f32_16x16x32_bf16 v[132:135], a[160:163], v[148:151], v[132:135]
  v_mfma_f32_16x16x32_bf16 v[140:143], a[164:167], v[148:151], v[140:143]
  s_add_u32 m0, s65, 16384
  s_add_u32 s5, s66, 16384
  buffer_load_dwordx4 v1, s[8:11], s5 offen sc1 lds
  ds_read_b128 v[144:147], v18 offset:49152
  ds_read_b128 v[148:151], v18 offset:53248
  s_waitcnt lgkmcnt(6)
  v_mfma_f32_16x16x32_bf16 v[128:131], a[168:171], v[152:155], v[128:131]
  v_mfma_f32_16x16x32_bf16 v[136:139], a[172:175], v[152:155], v[136:139]
  v_mfma_f32_16x16x32_bf16 v[132:135], a[168:171], v[156:159], v[132:135]
  v_mfma_f32_16x16x32_bf16 v[140:143], a[172:175], v[156:159], v[140:143]
  s_add_u32 m0, s65, 20480
  s_add_u32 s5, s66, 20480
  buffer_load_dwordx4 v1, s[8:11], s5 offen sc1 lds
  ds_read_b128 v[152:155], v18 offset:50176
  ds_read_b128 v[156:159], v18 offset:54272
  s_waitcnt lgkmcnt(6)
  v_mfma_f32_16x16x32_bf16 v[128:131], a[176:179], v[160:163], v[128:131]
  v_mfma_f32_16x16x32_bf16 v[136:139], a[180:183], v[160:163], v[136:139]
  v_mfma_f32_16x16x32_bf16 v[132:135], a[176:179], v[164:167], v[132:135]
  v_mfma_f32_16x16x32_bf16 v[140:143], a[180:183], v[164:167], v[140:143]
  s_add_u32 m0, s65, 24576
  s_add_u32 s5, s66, 24576
  buffer_load_dwordx4 v1, s[8:11], s5 offen sc1 lds
  ds_read_b128 v[160:163], v18 offset:51200
  ds_read_b128 v[164:167], v18 offset:55296
  s_waitcnt lgkmcnt(6)
  v_mfma_f32_16x16x32_bf16 v[128:131], a[184:187], v[168:171], v[128:131]
  v_mfma_f32_16x16x32_bf16 v[136:139], a[188:191], v[168:171], v[136:139]
  v_mfma_f32_16x16x32_bf16 v[132:135], a[184:187], v[172:175], v[132:135]
  v_mfma_f32_16x16x32_bf16 v[140:143], a[188:191], v[172:175], v[140:143]
  s_add_u32 m0, s65, 28672
  s_add_u32 s5, s66, 28672
  buffer_load_dwordx4 v1, s[8:11], s5 offen sc1 lds
  ds_read_b128 v[168:171], v18 offset:52224
  ds_read_b128 v[172:175], v18 offset:56320
  s_waitcnt lgkmcnt(6)
  v_mfma_f32_16x16x32_bf16 v[128:131], a[192:195], v[144:147], v[128:131]
  v_mfma_f32_16x16x32_bf16 v[136:139], a[196:199], v[144:147], v[136:139]
  v_mfma_f32_16x16x32_bf16 v[132:135], a[192:195], v[148:151], v[132:135]
  v_mfma_f32_16x16x32_bf16 v[140:143], a[196:199], v[148:151], v[140:143]
  s_add_u32 m0, s65, 32768
  s_add_u32 s5, s66, 32768
  buffer_load_dwordx4 v1, s[8:11], s5 offen sc1 lds
  ds_read_b128 v[144:147], v18 offset:57344
  ds_read_b128 v[148:151], v18 offset:61440
  s_waitcnt lgkmcnt(6)
  v_mfma_f32_16x16x32_bf16 v[128:131], a[200:203], v[152:155], v[128:131]
  v_mfma_f32_16x16x32_bf16 v[136:139], a[204:207], v[152:155], v[136:139]
  v_mfma_f32_16x16x32_bf16 v[132:135], a[200:203], v[156:159], v[132:135]
  v_mfma_f32_16x16x32_bf16 v[140:143], a[204:207], v[156:159], v[140:143]
  s_add_u32 m0, s65, 36864
  s_add_u32 s5, s66, 36864
  buffer_load_dwordx4 v1, s[8:11], s5 offen sc1 lds
  ds_read_b128 v[152:155], v18 offset:58368
  ds_read_b128 v[156:159], v18 offset:62464
  s_waitcnt lgkmcnt(6)
  v_mfma_f32_16x16x32_bf16 v[128:131], a[208:211], v[160:163], v[128:131]
  v_mfma_f32_16x16x32_bf16 v[136:139], a[212:215], v[160:163], v[136:139]
  v_mfma_f32_16x16x32_bf16 v[132:135], a[208:211], v[164:167], v[132:135]
  v_mfma_f32_16x16x32_bf16 v[140:143], a[212:215], v[164:167], v[140:143]
  s_add_u32 m0, s65, 40960
  s_add_u32 s5, s66, 40960
  buffer_load_dwordx4 v1, s[8:11], s5 offen sc1 lds
  ds_read_b128 v[160:163], v18 offset:59392
  ds_read_b128 v[164:167], v18 offset:63488
  s_waitcnt lgkmcnt(6)
  v_mfma_f32_16x16x32_bf16 v[128:131], a[216:219], v[168:171], v[128:131]
  v_mfma_f32_16x16x32_bf16 v[136:139], a[220:223], v[168:171], v[136:139]
  v_mfma_f32_16x16x32_bf16 v[132:135], a[216:219], v[172:175], v[132:135]
  v_mfma_f32_16x16x32_bf16 v[140:143], a[220:223], v[172:175], v[140:143]
  s_add_u32 m0, s65, 45056
  s_add_u32 s5, s66, 45056
  buffer_load_dwordx4 v1, s[8:11], s5 offen sc1 lds
  ds_read_b128 v[168:171], v18 offset:60416
  ds_read_b128 v[172:175], v18 offset:64512
  s_waitcnt lgkmcnt(6)
  v_mfma_f32_16x16x32_bf16 v[128:131], a[224:227], v[144:147], v[128:131]
  v_mfma_f32_16x16x32_bf16 v[136:139], a[228:231], v[144:147], v[136:139]
  v_mfma_f32_16x16x32_bf16 v[132:135], a[224:227], v[148:151], v[132:135]
  v_mfma_f32_16x16x32_bf16 v[140:143], a[228:231], v[148:151], v[140:143]
  s_add_u32 m0, s65, 49152
  s_add_u32 s5, s66, 49152
  buffer_load_dwordx4 v1, s[8:11], s5 offen sc1 lds
  s_waitcnt lgkmcnt(4)
  v_mfma_f32_16x16x32_bf16 v[128:131], a[232:235], v[152:155], v[128:131]
  v_mfma_f32_16x16x32_bf16 v[136:139], a[236:239], v[152:155], v[136:139]
  v_mfma_f32_16x16x32_bf16 v[132:135], a[232:235], v[156:159], v[132:135]
  v_mfma_f32_16x16x32_bf16 v[140:143], a[236:239], v[156:159], v[140:143]
  s_add_u32 m0, s65, 53248
  s_add_u32 s5, s66, 53248
  buffer_load_dwordx4 v1, s[8:11], s5 offen sc1 lds
  s_waitcnt lgkmcnt(2)
  v_mfma_f32_16x16x32_bf16 v[128:131], a[240:243], v[160:163], v[128:131]
  v_mfma_f32_16x16x32_bf16 v[136:139], a[244:247], v[160:163], v[136:139]
  v_mfma_f32_16x16x32_bf16 v[132:135], a[240:243], v[164:167], v[132:135]
  v_mfma_f32_16x16x32_bf16 v[140:143], a[244:247], v[164:167], v[140:143]
  s_add_u32 m0, s65, 57344
  s_add_u32 s5, s66, 57344
  buffer_load_dwordx4 v1, s[8:11], s5 offen sc1 lds
  s_waitcnt lgkmcnt(0)
  v_mfma_f32_16x16x32_bf16 v[128:131], a[248:251], v[168:171], v[128:131]
  v_mfma_f32_16x16x32_bf16 v[136:139], a[252:255], v[168:171], v[136:139]
  v_mfma_f32_16x16x32_bf16 v[132:135], a[248:251], v[172:175], v[132:135]
  v_mfma_f32_16x16x32_bf16 v[140:143], a[252:255], v[172:175], v[140:143]
  s_add_u32 m0, s65, 61440
  s_add_u32 s5, s66, 61440
  buffer_load_dwordx4 v1, s[8:11], s5 offen sc1 lds
  s_cmp_ge_u32 s32, 3
  s_cselect_b64 s[68:69], -1, 0
  v_add_f32 v176, v176, v180
  v_add_f32 v184, v184, v188
  v_add_f32 v177, v177, v181
  v_add_f32 v185, v185, v189
  v_add_f32 v178, v178, v182
  v_add_f32 v186, v186, v190
  v_add_f32 v179, v179, v183
  v_add_f32 v187, v187, v191
  v_add_f32 v176, v176, v184
  v_add_f32 v177, v177, v185
  v_add_f32 v178, v178, v186
  v_add_f32 v179, v179, v187
  v_cvt_pk_bf16_f32 v180, v176, v177
  v_cvt_pk_bf16_f32 v181, v178, v179
  s_mov_b64 exec, s[68:69]
  buffer_store_dwordx2 v[180:181], v7, s[12:15], s37 offen
  s_mov_b64 exec, -1
  s_cmp_ge_u32 s32, 3
  s_cselect_b32 s4, 327680, 0
  s_add_u32 s36, s36, s4
  s_cmp_ge_u32 s32, 3
  s_cselect_b32 s4, 81920, 0
  s_add_u32 s37, s37, s4
  s_branch WO_EPI_117
WO_NOPRE_116:
  s_mov_b64 exec, 0xfff
  buffer_load_dword v15, v10, s[8:11], 0 offen sc1
  s_mov_b64 exec, -1
  ds_read_b128 v[144:147], v18 offset:32768
  ds_read_b128 v[148:151], v18 offset:36864
  ds_read_b128 v[152:155], v18 offset:33792
  ds_read_b128 v[156:159], v18 offset:37888
  ds_read_b128 v[160:163], v18 offset:34816
  ds_read_b128 v[164:167], v18 offset:38912
  ds_read_b128 v[168:171], v18 offset:35840
  ds_read_b128 v[172:175], v18 offset:39936
  s_waitcnt lgkmcnt(6)
  v_mfma_f32_16x16x32_bf16 v[128:131], a[128:131], v[144:147], v[128:131]
  v_mfma_f32_16x16x32_bf16 v[136:139], a[132:135], v[144:147], v[136:139]
  v_mfma_f32_16x16x32_bf16 v[132:135], a[128:131], v[148:151], v[132:135]
  v_mfma_f32_16x16x32_bf16 v[140:143], a[132:135], v[148:151], v[140:143]
  ds_read_b128 v[144:147], v18 offset:40960
  ds_read_b128 v[148:151], v18 offset:45056
  s_waitcnt lgkmcnt(6)
  v_mfma_f32_16x16x32_bf16 v[128:131], a[136:139], v[152:155], v[128:131]
  v_mfma_f32_16x16x32_bf16 v[136:139], a[140:143], v[152:155], v[136:139]
  v_mfma_f32_16x16x32_bf16 v[132:135], a[136:139], v[156:159], v[132:135]
  v_mfma_f32_16x16x32_bf16 v[140:143], a[140:143], v[156:159], v[140:143]
  ds_read_b128 v[152:155], v18 offset:41984
  ds_read_b128 v[156:159], v18 offset:46080
  s_waitcnt lgkmcnt(6)
  v_mfma_f32_16x16x32_bf16 v[128:131], a[144:147], v[160:163], v[128:131]
  v_mfma_f32_16x16x32_bf16 v[136:139], a[148:151], v[160:163], v[136:139]
  v_mfma_f32_16x16x32_bf16 v[132:135], a[144:147], v[164:167], v[132:135]
  v_mfma_f32_16x16x32_bf16 v[140:143], a[148:151], v[164:167], v[140:143]
  s_cmp_ge_u32 s32, 3
  s_cselect_b64 s[68:69], -1, 0
  v_add_f32 v176, v176, v180
  v_add_f32 v184, v184, v188
  v_add_f32 v177, v177, v181
  v_add_f32 v185, v185, v189
  v_add_f32 v178, v178, v182
  v_add_f32 v186, v186, v190
  v_add_f32 v179, v179, v183
  v_add_f32 v187, v187, v191
  v_add_f32 v176, v176, v184
  v_add_f32 v177, v177, v185
  v_add_f32 v178, v178, v186
  v_add_f32 v179, v179, v187
  v_cvt_pk_bf16_f32 v180, v176, v177
  v_cvt_pk_bf16_f32 v181, v178, v179
  s_mov_b64 exec, s[68:69]
  buffer_store_dwordx2 v[180:181], v7, s[12:15], s37 offen
  s_mov_b64 exec, -1
  s_cmp_ge_u32 s32, 3
  s_cselect_b32 s4, 327680, 0
  s_add_u32 s36, s36, s4
  s_cmp_ge_u32 s32, 3
  s_cselect_b32 s4, 81920, 0
  s_add_u32 s37, s37, s4
  ds_read_b128 v[160:163], v18 offset:43008
  ds_read_b128 v[164:167], v18 offset:47104
  s_waitcnt lgkmcnt(6)
  v_mfma_f32_16x16x32_bf16 v[128:131], a[152:155], v[168:171], v[128:131]
  v_mfma_f32_16x16x32_bf16 v[136:139], a[156:159], v[168:171], v[136:139]
  v_mfma_f32_16x16x32_bf16 v[132:135], a[152:155], v[172:175], v[132:135]
  v_mfma_f32_16x16x32_bf16 v[140:143], a[156:159], v[172:175], v[140:143]
  ds_read_b128 v[168:171], v18 offset:44032
  ds_read_b128 v[172:175], v18 offset:48128
  s_waitcnt lgkmcnt(6)
  v_mfma_f32_16x16x32_bf16 v[128:131], a[160:163], v[144:147], v[128:131]
  v_mfma_f32_16x16x32_bf16 v[136:139], a[164:167], v[144:147], v[136:139]
  v_mfma_f32_16x16x32_bf16 v[132:135], a[160:163], v[148:151], v[132:135]
  v_mfma_f32_16x16x32_bf16 v[140:143], a[164:167], v[148:151], v[140:143]
  ds_read_b128 v[144:147], v18 offset:49152
  ds_read_b128 v[148:151], v18 offset:53248
  s_waitcnt lgkmcnt(6)
  v_mfma_f32_16x16x32_bf16 v[128:131], a[168:171], v[152:155], v[128:131]
  v_mfma_f32_16x16x32_bf16 v[136:139], a[172:175], v[152:155], v[136:139]
  v_mfma_f32_16x16x32_bf16 v[132:135], a[168:171], v[156:159], v[132:135]
  v_mfma_f32_16x16x32_bf16 v[140:143], a[172:175], v[156:159], v[140:143]
  ds_read_b128 v[152:155], v18 offset:50176
  ds_read_b128 v[156:159], v18 offset:54272
  s_waitcnt lgkmcnt(6)
  v_mfma_f32_16x16x32_bf16 v[128:131], a[176:179], v[160:163], v[128:131]
  v_mfma_f32_16x16x32_bf16 v[136:139], a[180:183], v[160:163], v[136:139]
  v_mfma_f32_16x16x32_bf16 v[132:135], a[176:179], v[164:167], v[132:135]
  v_mfma_f32_16x16x32_bf16 v[140:143], a[180:183], v[164:167], v[140:143]
  ds_read_b128 v[160:163], v18 offset:51200
  ds_read_b128 v[164:167], v18 offset:55296
  s_waitcnt lgkmcnt(6)
  v_mfma_f32_16x16x32_bf16 v[128:131], a[184:187], v[168:171], v[128:131]
  v_mfma_f32_16x16x32_bf16 v[136:139], a[188:191], v[168:171], v[136:139]
  v_mfma_f32_16x16x32_bf16 v[132:135], a[184:187], v[172:175], v[132:135]
  v_mfma_f32_16x16x32_bf16 v[140:143], a[188:191], v[172:175], v[140:143]
  ds_read_b128 v[168:171], v18 offset:52224
  ds_read_b128 v[172:175], v18 offset:56320
  s_waitcnt lgkmcnt(6)
  v_mfma_f32_16x16x32_bf16 v[128:131], a[192:195], v[144:147], v[128:131]
  v_mfma_f32_16x16x32_bf16 v[136:139], a[196:199], v[144:147], v[136:139]
  v_mfma_f32_16x16x32_bf16 v[132:135], a[192:195], v[148:151], v[132:135]
  v_mfma_f32_16x16x32_bf16 v[140:143], a[196:199], v[148:151], v[140:143]
  ds_read_b128 v[144:147], v18 offset:57344
  ds_read_b128 v[148:151], v18 offset:61440
  s_waitcnt lgkmcnt(6)
  v_mfma_f32_16x16x32_bf16 v[128:131], a[200:203], v[152:155], v[128:131]
  v_mfma_f32_16x16x32_bf16 v[136:139], a[204:207], v[152:155], v[136:139]
  v_mfma_f32_16x16x32_bf16 v[132:135], a[200:203], v[156:159], v[132:135]
  v_mfma_f32_16x16x32_bf16 v[140:143], a[204:207], v[156:159], v[140:143]
  ds_read_b128 v[152:155], v18 offset:58368
  ds_read_b128 v[156:159], v18 offset:62464
  s_waitcnt lgkmcnt(6)
  v_mfma_f32_16x16x32_bf16 v[128:131], a[208:211], v[160:163], v[128:131]
  v_mfma_f32_16x16x32_bf16 v[136:139], a[212:215], v[160:163], v[136:139]
  v_mfma_f32_16x16x32_bf16 v[132:135], a[208:211], v[164:167], v[132:135]
  v_mfma_f32_16x16x32_bf16 v[140:143], a[212:215], v[164:167], v[140:143]
  ds_read_b128 v[160:163], v18 offset:59392
  ds_read_b128 v[164:167], v18 offset:63488
  s_waitcnt lgkmcnt(6)
  v_mfma_f32_16x16x32_bf16 v[128:131], a[216:219], v[168:171], v[128:131]
  v_mfma_f32_16x16x32_bf16 v[136:139], a[220:223], v[168:171], v[136:139]
  v_mfma_f32_16x16x32_bf16 v[132:135], a[216:219], v[172:175], v[132:135]
  v_mfma_f32_16x16x32_bf16 v[140:143], a[220:223], v[172:175], v[140:143]
  ds_read_b128 v[168:171], v18 offset:60416
  ds_read_b128 v[172:175], v18 offset:64512
  s_waitcnt lgkmcnt(6)
  v_mfma_f32_16x16x32_bf16 v[128:131], a[224:227], v[144:147], v[128:131]
  v_mfma_f32_16x16x32_bf16 v[136:139], a[228:231], v[144:147], v[136:139]
  v_mfma_f32_16x16x32_bf16 v[132:135], a[224:227], v[148:151], v[132:135]
  v_mfma_f32_16x16x32_bf16 v[140:143], a[228:231], v[148:151], v[140:143]
  s_waitcnt lgkmcnt(4)
  v_mfma_f32_16x16x32_bf16 v[128:131], a[232:235], v[152:155], v[128:131]
  v_mfma_f32_16x16x32_bf16 v[136:139], a[236:239], v[152:155], v[136:139]
  v_mfma_f32_16x16x32_bf16 v[132:135], a[232:235], v[156:159], v[132:135]
  v_mfma_f32_16x16x32_bf16 v[140:143], a[236:239], v[156:159], v[140:143]
  s_waitcnt lgkmcnt(2)
  v_mfma_f32_16x16x32_bf16 v[128:131], a[240:243], v[160:163], v[128:131]
  v_mfma_f32_16x16x32_bf16 v[136:139], a[244:247], v[160:163], v[136:139]
  v_mfma_f32_16x16x32_bf16 v[132:135], a[240:243], v[164:167], v[132:135]
  v_mfma_f32_16x16x32_bf16 v[140:143], a[244:247], v[164:167], v[140:143]
  s_waitcnt lgkmcnt(0)
  v_mfma_f32_16x16x32_bf16 v[128:131], a[248:251], v[168:171], v[128:131]
  v_mfma_f32_16x16x32_bf16 v[136:139], a[252:255], v[168:171], v[136:139]
  v_mfma_f32_16x16x32_bf16 v[132:135], a[248:251], v[172:175], v[132:135]
  v_mfma_f32_16x16x32_bf16 v[140:143], a[252:255], v[172:175], v[140:143]
  s_waitcnt vmcnt(1)
  s_cmp_lg_u32 s28, 0
  s_cbranch_scc1 WO_DEC2_122
  s_add_u32 s55, s32, 2
  s_mov_b64 exec, 0xff
  v_cmp_gt_u32 vcc, s55, v15
  s_mov_b64 exec, -1
  s_nop 1
  v_mov_b32 v16, vcc_lo
  v_mov_b32 v17, 131076
  ds_write_b32 v17, v16
WO_DEC2_122:
  s_waitcnt lgkmcnt(0)
  s_barrier
  v_mov_b32 v20, 131076
  ds_read_b32 v19, v20
  s_waitcnt lgkmcnt(0)
  v_readfirstlane_b32 s6, v19
  s_nop 0
  s_and_b32 s4, s6, 0xff
  s_cmp_eq_u32 s4, 0
  s_cselect_b32 s62, 2, 0
  s_cmp_ge_u32 s32, 63
  s_cselect_b32 s62, 0, s62
  s_cmp_eq_u32 s62, 0
  s_cbranch_scc1 WO_NO2_123
  s_xor_b32 s65, s64, 65536
  s_add_u32 s65, s65, s41
  s_add_u32 s66, s33, 262144
  s_add_u32 m0, s65, 0
  s_add_u32 s5, s66, 0
  buffer_load_dwordx4 v1, s[8:11], s5 offen sc1 lds
  s_add_u32 m0, s65, 4096
  s_add_u32 s5, s66, 4096
  buffer_load_dwordx4 v1, s[8:11], s5 offen sc1 lds
  s_add_u32 m0, s65, 8192
  s_add_u32 s5, s66, 8192
  buffer_load_dwordx4 v1, s[8:11], s5 offen sc1 lds
  s_add_u32 m0, s65, 12288
  s_add_u32 s5, s66, 12288
  buffer_load_dwordx4 v1, s[8:11], s5 offen sc1 lds
  s_add_u32 m0, s65, 16384
  s_add_u32 s5, s66, 16384
  buffer_load_dwordx4 v1, s[8:11], s5 offen sc1 lds
  s_add_u32 m0, s65, 20480
  s_add_u32 s5, s66, 20480
  buffer_load_dwordx4 v1, s[8:11], s5 offen sc1 lds
  s_add_u32 m0, s65, 24576
  s_add_u32 s5, s66, 24576
  buffer_load_dwordx4 v1, s[8:11], s5 offen sc1 lds
  s_add_u32 m0, s65, 28672
  s_add_u32 s5, s66, 28672
  buffer_load_dwordx4 v1, s[8:11], s5 offen sc1 lds
WO_NO2_123:
WO_EPI_117:
  s_nop 7
  s_cmp_eq_u32 s78, 1
  s_cbranch_scc1 WO_PS_124
  s_add_u32 s5, s35, 0
  buffer_store_dwordx4 v[128:131], v1, s[8:11], s5 offen sc1
  s_add_u32 s5, s35, 4096
  buffer_store_dwordx4 v[132:135], v1, s[8:11], s5 offen sc1
  s_add_u32 s5, s35, 8192
  buffer_store_dwordx4 v[136:139], v1, s[8:11], s5 offen sc1
  s_add_u32 s5, s35, 12288
  buffer_store_dwordx4 v[140:143], v1, s[8:11], s5 offen sc1
  s_branch WO_PD_125
WO_PS_124:
  s_add_u32 s5, s35, 0
  buffer_store_dwordx4 v[128:131], v1, s[8:11], s5 offen
  s_add_u32 s5, s35, 4096
  buffer_store_dwordx4 v[132:135], v1, s[8:11], s5 offen
  s_add_u32 s5, s35, 8192
  buffer_store_dwordx4 v[136:139], v1, s[8:11], s5 offen
  s_add_u32 s5, s35, 12288
  buffer_store_dwordx4 v[140:143], v1, s[8:11], s5 offen
WO_PD_125:
  s_add_u32 s32, s32, 1
  s_add_u32 s33, s33, 262144
  s_add_u32 s35, s35, 327680
  s_xor_b32 s64, s64, 65536
  v_xor_b32 v18, 65536, v18
  s_cmp_lt_u32 s32, 64
  s_cbranch_scc1 WO_LOOP_106
  s_mov_b32 s55, 0
  s_mov_b32 s56, 63
  v_mov_b32 v11, s56
  v_mov_b32 v16, s55
  v_cndmask_b32 v11, v11, v16, s[60:61]
  s_mov_b32 s7, 0
  s_mov_b64 exec, 0xfff
WO_P1_126:
  buffer_load_dword v15, v10, s[8:11], 0 offen sc1
  s_add_u32 s7, s7, 1
  s_cmp_gt_u32 s7, 0x40000
  s_cbranch_scc1 WO_P1X_127
  s_waitcnt vmcnt(0)
  v_cmp_gt_u32 vcc, v11, v15
  s_cbranch_vccz WO_P1X_127
  s_sleep 1
  s_branch WO_P1_126
WO_P1X_127:
  s_waitcnt vmcnt(0)
  s_mov_b64 exec, -1
  s_barrier
  s_cmp_lg_u32 s28, 0
  s_cbranch_scc1 WO_NF_128
  v_mov_b32 v16, 64
  v_mov_b32 v17, 0
  s_mov_b64 exec, 1
  s_cmp_eq_u32 s78, 1
  s_cbranch_scc1 WO_FS_129
  buffer_store_dword v16, v17, s[8:11], s59 offen sc1
  s_branch WO_FD_130
WO_FS_129:
  buffer_store_dword v16, v17, s[8:11], s59 offen
WO_FD_130:
  s_mov_b64 exec, -1
WO_NF_128:
  buffer_load_dwordx4 v[176:179], v1, s[8:11], s36 offen offset:0 sc1
  buffer_load_dwordx4 v[180:183], v1, s[8:11], s36 offen offset:1024 sc1
  buffer_load_dwordx4 v[184:187], v1, s[8:11], s36 offen offset:2048 sc1
  buffer_load_dwordx4 v[188:191], v1, s[8:11], s36 offen offset:3072 sc1
  s_add_u32 s67, s36, 327680
  buffer_load_dwordx4 v[192:195], v1, s[8:11], s67 offen offset:0 sc1
  buffer_load_dwordx4 v[196:199], v1, s[8:11], s67 offen offset:1024 sc1
  buffer_load_dwordx4 v[200:203], v1, s[8:11], s67 offen offset:2048 sc1
  buffer_load_dwordx4 v[204:207], v1, s[8:11], s67 offen offset:3072 sc1
  s_mov_b32 s56, 64
  v_mov_b32 v11, s56
  v_mov_b32 v16, s55
  v_cndmask_b32 v11, v11, v16, s[60:61]
  s_mov_b32 s7, 0
  s_mov_b64 exec, 0xfff
WO_P2_131:
  buffer_load_dword v15, v10, s[8:11], 0 offen sc1
  s_add_u32 s7, s7, 1
  s_cmp_gt_u32 s7, 0x40000
  s_cbranch_scc1 WO_P2X_132
  s_waitcnt vmcnt(0)
  v_cmp_gt_u32 vcc, v11, v15
  s_cbranch_vccz WO_P2X_132
  s_sleep 1
  s_branch WO_P2_131
WO_P2X_132:
  s_waitcnt vmcnt(0)
  s_mov_b64 exec, -1
  v_add_f32 v176, v176, v180
  v_add_f32 v184, v184, v188
  v_add_f32 v177, v177, v181
  v_add_f32 v185, v185, v189
  v_add_f32 v178, v178, v182
  v_add_f32 v186, v186, v190
  v_add_f32 v179, v179, v183
  v_add_f32 v187, v187, v191
  v_add_f32 v176, v176, v184
  v_add_f32 v177, v177, v185
  v_add_f32 v178, v178, v186
  v_add_f32 v179, v179, v187
  v_cvt_pk_bf16_f32 v180, v176, v177
  v_cvt_pk_bf16_f32 v181, v178, v179
  buffer_store_dwordx2 v[180:181], v7, s[12:15], s37 offen
  s_add_u32 s36, s36, 327680
  s_add_u32 s37, s37, 81920
  v_add_f32 v192, v192, v196
  v_add_f32 v200, v200, v204
  v_add_f32 v193, v193, v197
  v_add_f32 v201, v201, v205
  v_add_f32 v194, v194, v198
  v_add_f32 v202, v202, v206
  v_add_f32 v195, v195, v199
  v_add_f32 v203, v203, v207
  v_add_f32 v192, v192, v200
  v_add_f32 v193, v193, v201
  v_add_f32 v194, v194, v202
  v_add_f32 v195, v195, v203
  v_cvt_pk_bf16_f32 v196, v192, v193
  v_cvt_pk_bf16_f32 v197, v194, v195
  buffer_store_dwordx2 v[196:197], v7, s[12:15], s37 offen
  s_add_u32 s36, s36, 327680
  s_add_u32 s37, s37, 81920
  buffer_load_dwordx4 v[176:179], v1, s[8:11], s36 offen offset:0 sc1
  buffer_load_dwordx4 v[180:183], v1, s[8:11], s36 offen offset:1024 sc1
  buffer_load_dwordx4 v[184:187], v1, s[8:11], s36 offen offset:2048 sc1
  buffer_load_dwordx4 v[188:191], v1, s[8:11], s36 offen offset:3072 sc1
  s_waitcnt vmcnt(0)
  v_add_f32 v176, v176, v180
  v_add_f32 v184, v184, v188
  v_add_f32 v177, v177, v181
  v_add_f32 v185, v185, v189
  v_add_f32 v178, v178, v182
  v_add_f32 v186, v186, v190
  v_add_f32 v179, v179, v183
  v_add_f32 v187, v187, v191
  v_add_f32 v176, v176, v184
  v_add_f32 v177, v177, v185
  v_add_f32 v178, v178, v186
  v_add_f32 v179, v179, v187
  v_cvt_pk_bf16_f32 v180, v176, v177
  v_cvt_pk_bf16_f32 v181, v178, v179
  buffer_store_dwordx2 v[180:181], v7, s[12:15], s37 offen
  s_add_u32 s36, s36, 327680
  s_add_u32 s37, s37, 81920
  s_waitcnt vmcnt(0)
L_END:
  s_endpgm

.section .rodata,"a"
.p2align 6
.amdhsa_kernel concat_heads__memory_aug_recurrent_mem_tr__memory_aug_recurrent_mem_tr__prompt_kernel
  .amdhsa_next_free_vgpr 512
  .amdhsa_next_free_sgpr 102
  .amdhsa_accum_offset 256
  .amdhsa_group_segment_fixed_size 0
  .amdhsa_kernarg_size 136
  .amdhsa_user_sgpr_count 2
  .amdhsa_user_sgpr_kernarg_segment_ptr 1
  .amdhsa_system_sgpr_workgroup_id_x 1
.end_amdhsa_kernel
```
